```python
import torch

def _softmax(x, axis=-1):
    return torch.softmax(x, dim=axis)

def _gelu(x):
    return torch.nn.functional.gelu(x, approximate='tanh')

def _silu(x):
    return torch.nn.functional.silu(x)

def _sigmoid(x):
    return torch.sigmoid(x)

def _layernorm(x, axis=-1, eps=1e-05):
    m = x.mean(dim=axis, keepdim=True)
    v = x.var(dim=axis, keepdim=True, unbiased=False)
    return (x - m) / torch.sqrt(v + eps)

def _scatter_add(tgt, idx, src, axis=0):
    return tgt.clone().index_add_(axis, idx, src)

def _segment_sum(src, seg, n):
    out = torch.zeros((n,) + src.shape[1:], dtype=src.dtype)
    return out.index_add_(0, seg, src)

def _pad(x, pw):
    flat = tuple((v for pair in reversed(pw) for v in pair))
    return torch.nn.functional.pad(x, flat)
kernel_name = 'adaLN_cond__gqa_block_cached__glu_gated_geglu__prompt'

def setup_inputs():

    _w = lambda a: (lambda t: t.to(torch.bfloat16) if t.is_floating_point() else t)(torch.as_tensor(a))

    def _A_setup():
        B, Sq, D = (1, 2048, 512)
        Hq, Hkv, Sk, Dh = (32, 32, 2048, 128)
        assert Hq % Hkv == 0, (Hq, Hkv)
        return {'x': _w((lambda *s: torch.randn(*s, dtype=torch.bfloat16) * 0.05)(B, Sq, D)), 'k_cache': _w((lambda *s: torch.randn(*s, dtype=torch.bfloat16) * 0.8)(B, Hkv, Sk, Dh)), 'v_cache': _w((lambda *s: torch.randn(*s, dtype=torch.bfloat16) * 3.2)(B, Hkv, Sk, Dh)), 'wq': _w((lambda *s: torch.randn(*s, dtype=torch.bfloat16) * 0.8)(D, Hq * Dh) * D ** (-0.5)), 'wo': _w((lambda *s: torch.randn(*s, dtype=torch.bfloat16) * 3.2)(Hq * Dh, D) * (Hq * Dh) ** (-0.5))}
    _A_in = _A_setup()

    def _B_setup():
        B, S, Dm, Df = (1, 2048, 512, 1376)
        return {'x': _w((lambda *s: torch.randn(*s, dtype=torch.bfloat16) * 0.05)(B, S, Dm)), 'w_gate': _w((lambda *s: torch.randn(*s, dtype=torch.bfloat16) * 3.2)(Dm, Df) * Dm ** (-0.5)), 'w_up': _w((lambda *s: torch.randn(*s, dtype=torch.bfloat16) * 3.2)(Dm, Df) * Dm ** (-0.5)), 'w_down': _w((lambda *s: torch.randn(*s, dtype=torch.bfloat16) * 3.2)(Df, Dm) * Df ** (-0.5))}
    _B_in = _B_setup()
    return {'A_x': _A_in['x'], 'A_k_cache': _A_in['k_cache'], 'A_v_cache': _A_in['v_cache'], 'A_wq': _A_in['wq'], 'A_wo': _A_in['wo'], 'B_x': _B_in['x'], 'B_w_gate': _B_in['w_gate'], 'B_w_up': _B_in['w_up'], 'B_w_down': _B_in['w_down'], 'c': _w((lambda *s: torch.randn(*s, dtype=torch.bfloat16) * 0.4)(1, 512) * 8.0), 'w_mod': _w((lambda *s: torch.randn(*s, dtype=torch.bfloat16) * 0.4)(512, 6 * 512) * 512 ** (-0.5) * 8.0)}

def reference(A_x, A_k_cache, A_v_cache, A_wq, A_wo, B_x, B_w_gate, B_w_up, B_w_down, c, w_mod):

    def _A_ref(x, k_cache, v_cache, wq, wo):
        B, Sq, D = x.shape
        Hq, Dh = (32, 128)
        Hkv = k_cache.shape[1]
        rep = Hq // Hkv
        q = (lambda x, *d: x.permute(*d))((x @ wq).reshape(B, Sq, Hq, Dh), 0, 2, 1, 3)
        k = (lambda x, n, axis: torch.repeat_interleave(x, n, dim=axis))(k_cache, rep, axis=1)
        v = (lambda x, n, axis: torch.repeat_interleave(x, n, dim=axis))(v_cache, rep, axis=1)
        scores = torch.einsum('bhqd,bhkd->bhqk', q, k) * Dh ** (-0.5)
        p = _softmax(scores, axis=-1)
        o = torch.einsum('bhqk,bhkd->bhqd', p, v)
        return (lambda x, *d: x.permute(*d))(o, 0, 2, 1, 3).reshape(B, Sq, Hq * Dh) @ wo

    def _B_ref(x, w_gate, w_up, w_down):
        g = torch.einsum('bsd,df->bsf', x, w_gate)
        u = torch.einsum('bsd,df->bsf', x, w_up)
        h = _gelu(g) * u
        return torch.einsum('bsf,fd->bsd', h, w_down)
    x = A_x
    mod = (_silu(c) @ w_mod).reshape(c.shape[0], 6, 1, -1)
    sa, ca, ga, sb, cb, gb = (mod[:, 0].clone(), mod[:, 1].clone(), mod[:, 2].clone(), mod[:, 3].clone(), mod[:, 4].clone(), mod[:, 5].clone())
    h = _layernorm(x, axis=-1) * (1 + ca) + sa
    x = x + ga * _A_ref(h, A_k_cache, A_v_cache, A_wq, A_wo)
    h = _layernorm(x, axis=-1) * (1 + cb) + sb
    x = x + gb * _B_ref(h, B_w_gate, B_w_up, B_w_down)
    return x
```

```asm
; @launch kernel=pre_kernel grid=(128,1,1) block=(256,1,1) lds=8192
; @launch kernel=attn_kernel grid=(256,1,1) block=(256,1,1) lds=163840
; @launch kernel=oproj_kernel grid=(256,1,1) block=(256,1,1) lds=65536
; @launch kernel=ln2_kernel grid=(512,1,1) block=(256,1,1) lds=0
; @launch kernel=gateup_kernel grid=(352,1,1) block=(256,1,1) lds=49152
; @launch kernel=down_kernel grid=(256,1,1) block=(256,1,1) lds=40960
.amdgcn_target "amdgcn-amd-amdhsa--gfx950"
.text
.globl pre_kernel
.p2align 8
.type pre_kernel,@function
pre_kernel:
    s_cmp_ge_u32 s2, 128
    s_cbranch_scc1 pre_kernel_done
    s_load_dwordx2 s[4:5], s[0:1], 0
    s_load_dwordx2 s[8:9], s[0:1], 104
    s_load_dwordx2 s[44:45], s[0:1], 72
    s_load_dwordx2 s[46:47], s[0:1], 80
    s_load_dwordx2 s[48:49], s[0:1], 96
    s_load_dwordx2 s[50:51], s[0:1], 24
    s_waitcnt lgkmcnt(0)
    s_mov_b32 s64, s50
    s_and_b32 s65, s51, 0xffff
    s_mov_b32 s66, 4194304
    s_mov_b32 s67, 0x20000
    s_mov_b32 s12, s4
    s_and_b32 s13, s5, 0xffff
    s_mov_b32 s14, 2097152
    s_mov_b32 s15, 0x20000
    s_mov_b32 s16, s8
    s_and_b32 s17, s9, 0xffff
    s_mov_b32 s18, 12288
    s_mov_b32 s19, 0x20000
    s_add_u32 s20, s8, 65536
    s_addc_u32 s21, s9, 0
    s_and_b32 s21, s21, 0xffff
    s_mov_b32 s22, 2097152
    s_mov_b32 s23, 0x20000
    s_mov_b32 s52, s44
    s_and_b32 s53, s45, 0xffff
    s_mov_b32 s54, 1024
    s_mov_b32 s55, 0x20000
    s_mov_b32 s56, s46
    s_and_b32 s57, s47, 0xffff
    s_mov_b32 s58, 3145728
    s_mov_b32 s59, 0x20000
    s_mov_b32 s60, s48
    s_and_b32 s61, s49, 0xffff
    s_mov_b32 s62, 256
    s_mov_b32 s63, 0x20000
    s_lshl_b32 s3, s2, 14
    v_lshrrev_b32 v2, 6, v0
    v_lshlrev_b32 v2, 12, v2
    v_and_b32 v3, 63, v0
    v_lshl_add_u32 v1, v3, 4, v2
    v_add_u32 v1, s3, v1
    buffer_load_dwordx4 v[132:135], v1, s[12:15], 0 offen offset:0
    buffer_load_dwordx4 v[136:139], v1, s[12:15], 0 offen offset:1024
    buffer_load_dwordx4 v[140:143], v1, s[12:15], 0 offen offset:2048
    buffer_load_dwordx4 v[144:147], v1, s[12:15], 0 offen offset:3072
    s_cmp_lt_u32 s2, 48
    s_cbranch_scc1 pre_kernel_isprod
    s_sub_u32 s25, s2, 48
    s_mul_i32 s25, s25, 53248
    v_lshlrev_b32 v50, 4, v0
    buffer_load_dwordx4 v[64:67], v50, s[64:67], s25 offen
    s_add_u32 s25, s25, 4096
    buffer_load_dwordx4 v[68:71], v50, s[64:67], s25 offen
    s_add_u32 s25, s25, 4096
    buffer_load_dwordx4 v[72:75], v50, s[64:67], s25 offen
    s_add_u32 s25, s25, 4096
    buffer_load_dwordx4 v[76:79], v50, s[64:67], s25 offen
    s_add_u32 s25, s25, 4096
    buffer_load_dwordx4 v[80:83], v50, s[64:67], s25 offen
    s_add_u32 s25, s25, 4096
    buffer_load_dwordx4 v[84:87], v50, s[64:67], s25 offen
    s_add_u32 s25, s25, 4096
    buffer_load_dwordx4 v[88:91], v50, s[64:67], s25 offen
    s_add_u32 s25, s25, 4096
    buffer_load_dwordx4 v[92:95], v50, s[64:67], s25 offen
    s_add_u32 s25, s25, 4096
    buffer_load_dwordx4 v[96:99], v50, s[64:67], s25 offen
    s_add_u32 s25, s25, 4096
    buffer_load_dwordx4 v[100:103], v50, s[64:67], s25 offen
    s_add_u32 s25, s25, 4096
    buffer_load_dwordx4 v[104:107], v50, s[64:67], s25 offen
    s_add_u32 s25, s25, 4096
    buffer_load_dwordx4 v[108:111], v50, s[64:67], s25 offen
    s_add_u32 s25, s25, 4096
    buffer_load_dwordx4 v[112:115], v50, s[64:67], s25 offen
    s_add_u32 s25, s25, 4096
    s_branch pre_kernel_noprod
pre_kernel_isprod:
    v_lshlrev_b32 v50, 2, v0
    buffer_load_dword v51, v50, s[52:55], 0 offen
    v_and_b32 v52, 15, v0
    v_lshrrev_b32 v53, 4, v0
    s_lshl_b32 s25, s2, 7
    v_lshlrev_b32 v54, 3, v52
    v_add_u32 v54, s25, v54
    s_mov_b32 s26, 6144*32
    v_mul_lo_u32 v55, v53, s26
    v_add_u32 v54, v54, v55
    s_mov_b32 s27, 0
    buffer_load_dwordx2 v[64:65], v54, s[56:59], s27 offen
    s_mov_b32 s27, 6144
    buffer_load_dwordx2 v[66:67], v54, s[56:59], s27 offen
    s_mov_b32 s27, 12288
    buffer_load_dwordx2 v[68:69], v54, s[56:59], s27 offen
    s_mov_b32 s27, 18432
    buffer_load_dwordx2 v[70:71], v54, s[56:59], s27 offen
    s_mov_b32 s27, 24576
    buffer_load_dwordx2 v[72:73], v54, s[56:59], s27 offen
    s_mov_b32 s27, 30720
    buffer_load_dwordx2 v[74:75], v54, s[56:59], s27 offen
    s_mov_b32 s27, 36864
    buffer_load_dwordx2 v[76:77], v54, s[56:59], s27 offen
    s_mov_b32 s27, 43008
    buffer_load_dwordx2 v[78:79], v54, s[56:59], s27 offen
    s_mov_b32 s27, 49152
    buffer_load_dwordx2 v[80:81], v54, s[56:59], s27 offen
    s_mov_b32 s27, 55296
    buffer_load_dwordx2 v[82:83], v54, s[56:59], s27 offen
    s_mov_b32 s27, 61440
    buffer_load_dwordx2 v[84:85], v54, s[56:59], s27 offen
    s_mov_b32 s27, 67584
    buffer_load_dwordx2 v[86:87], v54, s[56:59], s27 offen
    s_mov_b32 s27, 73728
    buffer_load_dwordx2 v[88:89], v54, s[56:59], s27 offen
    s_mov_b32 s27, 79872
    buffer_load_dwordx2 v[90:91], v54, s[56:59], s27 offen
    s_mov_b32 s27, 86016
    buffer_load_dwordx2 v[92:93], v54, s[56:59], s27 offen
    s_mov_b32 s27, 92160
    buffer_load_dwordx2 v[94:95], v54, s[56:59], s27 offen
    s_mov_b32 s27, 98304
    buffer_load_dwordx2 v[96:97], v54, s[56:59], s27 offen
    s_mov_b32 s27, 104448
    buffer_load_dwordx2 v[98:99], v54, s[56:59], s27 offen
    s_mov_b32 s27, 110592
    buffer_load_dwordx2 v[100:101], v54, s[56:59], s27 offen
    s_mov_b32 s27, 116736
    buffer_load_dwordx2 v[102:103], v54, s[56:59], s27 offen
    s_mov_b32 s27, 122880
    buffer_load_dwordx2 v[104:105], v54, s[56:59], s27 offen
    s_mov_b32 s27, 129024
    buffer_load_dwordx2 v[106:107], v54, s[56:59], s27 offen
    s_mov_b32 s27, 135168
    buffer_load_dwordx2 v[108:109], v54, s[56:59], s27 offen
    s_mov_b32 s27, 141312
    buffer_load_dwordx2 v[110:111], v54, s[56:59], s27 offen
    s_mov_b32 s27, 147456
    buffer_load_dwordx2 v[112:113], v54, s[56:59], s27 offen
    s_mov_b32 s27, 153600
    buffer_load_dwordx2 v[114:115], v54, s[56:59], s27 offen
    s_mov_b32 s27, 159744
    buffer_load_dwordx2 v[116:117], v54, s[56:59], s27 offen
    s_mov_b32 s27, 165888
    buffer_load_dwordx2 v[118:119], v54, s[56:59], s27 offen
    s_mov_b32 s27, 172032
    buffer_load_dwordx2 v[120:121], v54, s[56:59], s27 offen
    s_mov_b32 s27, 178176
    buffer_load_dwordx2 v[122:123], v54, s[56:59], s27 offen
    s_mov_b32 s27, 184320
    buffer_load_dwordx2 v[124:125], v54, s[56:59], s27 offen
    s_mov_b32 s27, 190464
    buffer_load_dwordx2 v[126:127], v54, s[56:59], s27 offen
    v_lshlrev_b32 v56, 7, v53
    v_mov_b32 v40, 0
    v_mov_b32 v41, 0
    v_mov_b32 v42, 0
    v_mov_b32 v43, 0
    s_waitcnt vmcnt(32)
    v_lshlrev_b32 v60, 16, v51
    v_and_b32 v61, 0xffff0000, v51
    s_mov_b32 s24, 1069066811
    v_mul_f32 v62, s24, v60
    v_exp_f32 v62, -v62
    s_nop 0
    v_add_f32 v62, 1.0, v62
    v_rcp_f32 v62, v62
    s_nop 0
    v_mul_f32 v60, v60, v62
    v_mul_f32 v63, s24, v61
    v_exp_f32 v63, -v63
    s_nop 0
    v_add_f32 v63, 1.0, v63
    v_rcp_f32 v63, v63
    s_nop 0
    v_mul_f32 v61, v61, v63
    v_cvt_pk_bf16_f32 v62, v60, v61
    v_lshlrev_b32 v60, 16, v62
    v_and_b32 v61, 0xffff0000, v62
    v_lshlrev_b32 v50, 3, v0
    ds_write_b64 v50, v[60:61]
    s_waitcnt lgkmcnt(0)
    s_barrier
    ds_read_b128 v[24:27], v56 offset:0
    ds_read_b128 v[28:31], v56 offset:16
    s_waitcnt vmcnt(24) lgkmcnt(0)
    v_lshlrev_b32 v57, 16, v64
    v_and_b32 v62, 0xffff0000, v64
    v_fmac_f32 v40, v57, v24
    v_fmac_f32 v41, v62, v24
    v_lshlrev_b32 v57, 16, v65
    v_and_b32 v62, 0xffff0000, v65
    v_fmac_f32 v42, v57, v24
    v_fmac_f32 v43, v62, v24
    v_lshlrev_b32 v57, 16, v66
    v_and_b32 v62, 0xffff0000, v66
    v_fmac_f32 v40, v57, v25
    v_fmac_f32 v41, v62, v25
    v_lshlrev_b32 v57, 16, v67
    v_and_b32 v62, 0xffff0000, v67
    v_fmac_f32 v42, v57, v25
    v_fmac_f32 v43, v62, v25
    v_lshlrev_b32 v57, 16, v68
    v_and_b32 v62, 0xffff0000, v68
    v_fmac_f32 v40, v57, v26
    v_fmac_f32 v41, v62, v26
    v_lshlrev_b32 v57, 16, v69
    v_and_b32 v62, 0xffff0000, v69
    v_fmac_f32 v42, v57, v26
    v_fmac_f32 v43, v62, v26
    v_lshlrev_b32 v57, 16, v70
    v_and_b32 v62, 0xffff0000, v70
    v_fmac_f32 v40, v57, v27
    v_fmac_f32 v41, v62, v27
    v_lshlrev_b32 v57, 16, v71
    v_and_b32 v62, 0xffff0000, v71
    v_fmac_f32 v42, v57, v27
    v_fmac_f32 v43, v62, v27
    v_lshlrev_b32 v57, 16, v72
    v_and_b32 v62, 0xffff0000, v72
    v_fmac_f32 v40, v57, v28
    v_fmac_f32 v41, v62, v28
    v_lshlrev_b32 v57, 16, v73
    v_and_b32 v62, 0xffff0000, v73
    v_fmac_f32 v42, v57, v28
    v_fmac_f32 v43, v62, v28
    v_lshlrev_b32 v57, 16, v74
    v_and_b32 v62, 0xffff0000, v74
    v_fmac_f32 v40, v57, v29
    v_fmac_f32 v41, v62, v29
    v_lshlrev_b32 v57, 16, v75
    v_and_b32 v62, 0xffff0000, v75
    v_fmac_f32 v42, v57, v29
    v_fmac_f32 v43, v62, v29
    v_lshlrev_b32 v57, 16, v76
    v_and_b32 v62, 0xffff0000, v76
    v_fmac_f32 v40, v57, v30
    v_fmac_f32 v41, v62, v30
    v_lshlrev_b32 v57, 16, v77
    v_and_b32 v62, 0xffff0000, v77
    v_fmac_f32 v42, v57, v30
    v_fmac_f32 v43, v62, v30
    v_lshlrev_b32 v57, 16, v78
    v_and_b32 v62, 0xffff0000, v78
    v_fmac_f32 v40, v57, v31
    v_fmac_f32 v41, v62, v31
    v_lshlrev_b32 v57, 16, v79
    v_and_b32 v62, 0xffff0000, v79
    v_fmac_f32 v42, v57, v31
    v_fmac_f32 v43, v62, v31
    ds_read_b128 v[24:27], v56 offset:32
    ds_read_b128 v[28:31], v56 offset:48
    s_waitcnt vmcnt(16) lgkmcnt(0)
    v_lshlrev_b32 v57, 16, v80
    v_and_b32 v62, 0xffff0000, v80
    v_fmac_f32 v40, v57, v24
    v_fmac_f32 v41, v62, v24
    v_lshlrev_b32 v57, 16, v81
    v_and_b32 v62, 0xffff0000, v81
    v_fmac_f32 v42, v57, v24
    v_fmac_f32 v43, v62, v24
    v_lshlrev_b32 v57, 16, v82
    v_and_b32 v62, 0xffff0000, v82
    v_fmac_f32 v40, v57, v25
    v_fmac_f32 v41, v62, v25
    v_lshlrev_b32 v57, 16, v83
    v_and_b32 v62, 0xffff0000, v83
    v_fmac_f32 v42, v57, v25
    v_fmac_f32 v43, v62, v25
    v_lshlrev_b32 v57, 16, v84
    v_and_b32 v62, 0xffff0000, v84
    v_fmac_f32 v40, v57, v26
    v_fmac_f32 v41, v62, v26
    v_lshlrev_b32 v57, 16, v85
    v_and_b32 v62, 0xffff0000, v85
    v_fmac_f32 v42, v57, v26
    v_fmac_f32 v43, v62, v26
    v_lshlrev_b32 v57, 16, v86
    v_and_b32 v62, 0xffff0000, v86
    v_fmac_f32 v40, v57, v27
    v_fmac_f32 v41, v62, v27
    v_lshlrev_b32 v57, 16, v87
    v_and_b32 v62, 0xffff0000, v87
    v_fmac_f32 v42, v57, v27
    v_fmac_f32 v43, v62, v27
    v_lshlrev_b32 v57, 16, v88
    v_and_b32 v62, 0xffff0000, v88
    v_fmac_f32 v40, v57, v28
    v_fmac_f32 v41, v62, v28
    v_lshlrev_b32 v57, 16, v89
    v_and_b32 v62, 0xffff0000, v89
    v_fmac_f32 v42, v57, v28
    v_fmac_f32 v43, v62, v28
    v_lshlrev_b32 v57, 16, v90
    v_and_b32 v62, 0xffff0000, v90
    v_fmac_f32 v40, v57, v29
    v_fmac_f32 v41, v62, v29
    v_lshlrev_b32 v57, 16, v91
    v_and_b32 v62, 0xffff0000, v91
    v_fmac_f32 v42, v57, v29
    v_fmac_f32 v43, v62, v29
    v_lshlrev_b32 v57, 16, v92
    v_and_b32 v62, 0xffff0000, v92
    v_fmac_f32 v40, v57, v30
    v_fmac_f32 v41, v62, v30
    v_lshlrev_b32 v57, 16, v93
    v_and_b32 v62, 0xffff0000, v93
    v_fmac_f32 v42, v57, v30
    v_fmac_f32 v43, v62, v30
    v_lshlrev_b32 v57, 16, v94
    v_and_b32 v62, 0xffff0000, v94
    v_fmac_f32 v40, v57, v31
    v_fmac_f32 v41, v62, v31
    v_lshlrev_b32 v57, 16, v95
    v_and_b32 v62, 0xffff0000, v95
    v_fmac_f32 v42, v57, v31
    v_fmac_f32 v43, v62, v31
    ds_read_b128 v[24:27], v56 offset:64
    ds_read_b128 v[28:31], v56 offset:80
    s_waitcnt vmcnt(8) lgkmcnt(0)
    v_lshlrev_b32 v57, 16, v96
    v_and_b32 v62, 0xffff0000, v96
    v_fmac_f32 v40, v57, v24
    v_fmac_f32 v41, v62, v24
    v_lshlrev_b32 v57, 16, v97
    v_and_b32 v62, 0xffff0000, v97
    v_fmac_f32 v42, v57, v24
    v_fmac_f32 v43, v62, v24
    v_lshlrev_b32 v57, 16, v98
    v_and_b32 v62, 0xffff0000, v98
    v_fmac_f32 v40, v57, v25
    v_fmac_f32 v41, v62, v25
    v_lshlrev_b32 v57, 16, v99
    v_and_b32 v62, 0xffff0000, v99
    v_fmac_f32 v42, v57, v25
    v_fmac_f32 v43, v62, v25
    v_lshlrev_b32 v57, 16, v100
    v_and_b32 v62, 0xffff0000, v100
    v_fmac_f32 v40, v57, v26
    v_fmac_f32 v41, v62, v26
    v_lshlrev_b32 v57, 16, v101
    v_and_b32 v62, 0xffff0000, v101
    v_fmac_f32 v42, v57, v26
    v_fmac_f32 v43, v62, v26
    v_lshlrev_b32 v57, 16, v102
    v_and_b32 v62, 0xffff0000, v102
    v_fmac_f32 v40, v57, v27
    v_fmac_f32 v41, v62, v27
    v_lshlrev_b32 v57, 16, v103
    v_and_b32 v62, 0xffff0000, v103
    v_fmac_f32 v42, v57, v27
    v_fmac_f32 v43, v62, v27
    v_lshlrev_b32 v57, 16, v104
    v_and_b32 v62, 0xffff0000, v104
    v_fmac_f32 v40, v57, v28
    v_fmac_f32 v41, v62, v28
    v_lshlrev_b32 v57, 16, v105
    v_and_b32 v62, 0xffff0000, v105
    v_fmac_f32 v42, v57, v28
    v_fmac_f32 v43, v62, v28
    v_lshlrev_b32 v57, 16, v106
    v_and_b32 v62, 0xffff0000, v106
    v_fmac_f32 v40, v57, v29
    v_fmac_f32 v41, v62, v29
    v_lshlrev_b32 v57, 16, v107
    v_and_b32 v62, 0xffff0000, v107
    v_fmac_f32 v42, v57, v29
    v_fmac_f32 v43, v62, v29
    v_lshlrev_b32 v57, 16, v108
    v_and_b32 v62, 0xffff0000, v108
    v_fmac_f32 v40, v57, v30
    v_fmac_f32 v41, v62, v30
    v_lshlrev_b32 v57, 16, v109
    v_and_b32 v62, 0xffff0000, v109
    v_fmac_f32 v42, v57, v30
    v_fmac_f32 v43, v62, v30
    v_lshlrev_b32 v57, 16, v110
    v_and_b32 v62, 0xffff0000, v110
    v_fmac_f32 v40, v57, v31
    v_fmac_f32 v41, v62, v31
    v_lshlrev_b32 v57, 16, v111
    v_and_b32 v62, 0xffff0000, v111
    v_fmac_f32 v42, v57, v31
    v_fmac_f32 v43, v62, v31
    ds_read_b128 v[24:27], v56 offset:96
    ds_read_b128 v[28:31], v56 offset:112
    s_waitcnt vmcnt(0) lgkmcnt(0)
    v_lshlrev_b32 v57, 16, v112
    v_and_b32 v62, 0xffff0000, v112
    v_fmac_f32 v40, v57, v24
    v_fmac_f32 v41, v62, v24
    v_lshlrev_b32 v57, 16, v113
    v_and_b32 v62, 0xffff0000, v113
    v_fmac_f32 v42, v57, v24
    v_fmac_f32 v43, v62, v24
    v_lshlrev_b32 v57, 16, v114
    v_and_b32 v62, 0xffff0000, v114
    v_fmac_f32 v40, v57, v25
    v_fmac_f32 v41, v62, v25
    v_lshlrev_b32 v57, 16, v115
    v_and_b32 v62, 0xffff0000, v115
    v_fmac_f32 v42, v57, v25
    v_fmac_f32 v43, v62, v25
    v_lshlrev_b32 v57, 16, v116
    v_and_b32 v62, 0xffff0000, v116
    v_fmac_f32 v40, v57, v26
    v_fmac_f32 v41, v62, v26
    v_lshlrev_b32 v57, 16, v117
    v_and_b32 v62, 0xffff0000, v117
    v_fmac_f32 v42, v57, v26
    v_fmac_f32 v43, v62, v26
    v_lshlrev_b32 v57, 16, v118
    v_and_b32 v62, 0xffff0000, v118
    v_fmac_f32 v40, v57, v27
    v_fmac_f32 v41, v62, v27
    v_lshlrev_b32 v57, 16, v119
    v_and_b32 v62, 0xffff0000, v119
    v_fmac_f32 v42, v57, v27
    v_fmac_f32 v43, v62, v27
    v_lshlrev_b32 v57, 16, v120
    v_and_b32 v62, 0xffff0000, v120
    v_fmac_f32 v40, v57, v28
    v_fmac_f32 v41, v62, v28
    v_lshlrev_b32 v57, 16, v121
    v_and_b32 v62, 0xffff0000, v121
    v_fmac_f32 v42, v57, v28
    v_fmac_f32 v43, v62, v28
    v_lshlrev_b32 v57, 16, v122
    v_and_b32 v62, 0xffff0000, v122
    v_fmac_f32 v40, v57, v29
    v_fmac_f32 v41, v62, v29
    v_lshlrev_b32 v57, 16, v123
    v_and_b32 v62, 0xffff0000, v123
    v_fmac_f32 v42, v57, v29
    v_fmac_f32 v43, v62, v29
    v_lshlrev_b32 v57, 16, v124
    v_and_b32 v62, 0xffff0000, v124
    v_fmac_f32 v40, v57, v30
    v_fmac_f32 v41, v62, v30
    v_lshlrev_b32 v57, 16, v125
    v_and_b32 v62, 0xffff0000, v125
    v_fmac_f32 v42, v57, v30
    v_fmac_f32 v43, v62, v30
    v_lshlrev_b32 v57, 16, v126
    v_and_b32 v62, 0xffff0000, v126
    v_fmac_f32 v40, v57, v31
    v_fmac_f32 v41, v62, v31
    v_lshlrev_b32 v57, 16, v127
    v_and_b32 v62, 0xffff0000, v127
    v_fmac_f32 v42, v57, v31
    v_fmac_f32 v43, v62, v31
    v_lshlrev_b32 v57, 8, v53
    v_lshl_add_u32 v57, v52, 4, v57
    ds_write_b128 v57, v[40:43] offset:2048
    s_waitcnt lgkmcnt(0)
    s_barrier
    v_cmp_gt_u32 vcc, 64, v0
    s_and_saveexec_b64 s[28:29], vcc
    s_cbranch_execz pre_kernel_prodend
    v_lshlrev_b32 v50, 2, v0
    ds_read_b32 v64, v50 offset:2048
    ds_read_b32 v65, v50 offset:2304
    ds_read_b32 v66, v50 offset:2560
    ds_read_b32 v67, v50 offset:2816
    ds_read_b32 v68, v50 offset:3072
    ds_read_b32 v69, v50 offset:3328
    ds_read_b32 v70, v50 offset:3584
    ds_read_b32 v71, v50 offset:3840
    ds_read_b32 v72, v50 offset:4096
    ds_read_b32 v73, v50 offset:4352
    ds_read_b32 v74, v50 offset:4608
    ds_read_b32 v75, v50 offset:4864
    ds_read_b32 v76, v50 offset:5120
    ds_read_b32 v77, v50 offset:5376
    ds_read_b32 v78, v50 offset:5632
    ds_read_b32 v79, v50 offset:5888
    s_waitcnt lgkmcnt(0)
    v_add_f32 v64, v64, v65
    v_add_f32 v64, v64, v66
    v_add_f32 v64, v64, v67
    v_add_f32 v64, v64, v68
    v_add_f32 v64, v64, v69
    v_add_f32 v64, v64, v70
    v_add_f32 v64, v64, v71
    v_add_f32 v64, v64, v72
    v_add_f32 v64, v64, v73
    v_add_f32 v64, v64, v74
    v_add_f32 v64, v64, v75
    v_add_f32 v64, v64, v76
    v_add_f32 v64, v64, v77
    v_add_f32 v64, v64, v78
    v_add_f32 v64, v64, v79
    v_cvt_pk_bf16_f32 v62, v64, v65
    v_lshlrev_b32 v64, 16, v62
    v_and_b32 v65, 0xffff0000, v62
    s_lshl_b32 s25, s2, 8
    v_add_u32 v50, s25, v50
    buffer_store_dword v64, v50, s[16:19], 0 offen sc0 sc1
    s_waitcnt vmcnt(0)
    v_cmp_eq_u32 vcc, 0, v0
    s_and_b64 exec, exec, vcc
    v_mov_b32 v50, 0
    v_mov_b32 v51, 1
    buffer_atomic_add v51, v50, s[60:63], 0 offen sc1
pre_kernel_prodend:
    s_mov_b64 exec, s[28:29]
pre_kernel_noprod:
    s_waitcnt vmcnt(13)
    v_lshlrev_b32 v148, 16, v132
    v_and_b32 v149, 0xffff0000, v132
    v_lshlrev_b32 v150, 16, v133
    v_and_b32 v151, 0xffff0000, v133
    v_lshlrev_b32 v152, 16, v134
    v_and_b32 v153, 0xffff0000, v134
    v_lshlrev_b32 v154, 16, v135
    v_and_b32 v155, 0xffff0000, v135
    v_add_f32 v24, v148, v149
    v_add_f32 v24, v24, v150
    v_add_f32 v24, v24, v151
    v_add_f32 v24, v24, v152
    v_add_f32 v24, v24, v153
    v_add_f32 v24, v24, v154
    v_add_f32 v24, v24, v155
    s_nop 1
    v_add_f32_dpp v26, v24, v24 quad_perm:[1,0,3,2] row_mask:0xf bank_mask:0xf
    v_mov_b32 v24, v26
    s_nop 1
    v_add_f32_dpp v26, v24, v24 quad_perm:[2,3,0,1] row_mask:0xf bank_mask:0xf
    v_mov_b32 v24, v26
    s_nop 1
    v_add_f32_dpp v26, v24, v24 row_half_mirror row_mask:0xf bank_mask:0xf
    v_mov_b32 v24, v26
    s_nop 1
    v_add_f32_dpp v26, v24, v24 row_mirror row_mask:0xf bank_mask:0xf
    v_mov_b32 v24, v26
    s_nop 1
    v_readlane_b32 s24, v24, 0
    v_readlane_b32 s25, v24, 16
    v_readlane_b32 s26, v24, 32
    v_readlane_b32 s27, v24, 48
    s_nop 1
    v_mov_b32 v24, s24
    v_add_f32 v24, s25, v24
    v_add_f32 v24, s26, v24
    v_add_f32 v24, s27, v24
    v_mul_f32 v24, 0x3b000000, v24
    v_mov_b32 v25, 0
    v_sub_f32 v26, v148, v24
    v_fmac_f32 v25, v26, v26
    v_sub_f32 v26, v149, v24
    v_fmac_f32 v25, v26, v26
    v_sub_f32 v26, v150, v24
    v_fmac_f32 v25, v26, v26
    v_sub_f32 v26, v151, v24
    v_fmac_f32 v25, v26, v26
    v_sub_f32 v26, v152, v24
    v_fmac_f32 v25, v26, v26
    v_sub_f32 v26, v153, v24
    v_fmac_f32 v25, v26, v26
    v_sub_f32 v26, v154, v24
    v_fmac_f32 v25, v26, v26
    v_sub_f32 v26, v155, v24
    v_fmac_f32 v25, v26, v26
    s_nop 1
    v_add_f32_dpp v26, v25, v25 quad_perm:[1,0,3,2] row_mask:0xf bank_mask:0xf
    v_mov_b32 v25, v26
    s_nop 1
    v_add_f32_dpp v26, v25, v25 quad_perm:[2,3,0,1] row_mask:0xf bank_mask:0xf
    v_mov_b32 v25, v26
    s_nop 1
    v_add_f32_dpp v26, v25, v25 row_half_mirror row_mask:0xf bank_mask:0xf
    v_mov_b32 v25, v26
    s_nop 1
    v_add_f32_dpp v26, v25, v25 row_mirror row_mask:0xf bank_mask:0xf
    v_mov_b32 v25, v26
    s_nop 1
    v_readlane_b32 s24, v25, 0
    v_readlane_b32 s25, v25, 16
    v_readlane_b32 s26, v25, 32
    v_readlane_b32 s27, v25, 48
    s_nop 1
    v_mov_b32 v25, s24
    v_add_f32 v25, s25, v25
    v_add_f32 v25, s26, v25
    v_add_f32 v25, s27, v25
    v_mul_f32 v25, 0x3b000000, v25
    v_cvt_pk_bf16_f32 v26, v24, v25
    v_lshlrev_b32 v24, 16, v26
    v_and_b32 v25, 0xffff0000, v26
    v_add_f32 v25, 0x3727c5ac, v25
    v_cvt_pk_bf16_f32 v26, v25, v25
    v_lshlrev_b32 v25, 16, v26
    v_and_b32 v25, 0xffff0000, v26
    v_sqrt_f32 v25, v25
    s_nop 0
    v_cvt_pk_bf16_f32 v26, v25, v25
    v_lshlrev_b32 v25, 16, v26
    v_and_b32 v25, 0xffff0000, v26
    v_rcp_f32 v27, v25
    s_nop 0
    v_mov_b32 v180, v24
    v_mov_b32 v181, v25
    v_mov_b32 v183, v27
    v_lshlrev_b32 v156, 16, v136
    v_and_b32 v157, 0xffff0000, v136
    v_lshlrev_b32 v158, 16, v137
    v_and_b32 v159, 0xffff0000, v137
    v_lshlrev_b32 v160, 16, v138
    v_and_b32 v161, 0xffff0000, v138
    v_lshlrev_b32 v162, 16, v139
    v_and_b32 v163, 0xffff0000, v139
    v_add_f32 v24, v156, v157
    v_add_f32 v24, v24, v158
    v_add_f32 v24, v24, v159
    v_add_f32 v24, v24, v160
    v_add_f32 v24, v24, v161
    v_add_f32 v24, v24, v162
    v_add_f32 v24, v24, v163
    s_nop 1
    v_add_f32_dpp v26, v24, v24 quad_perm:[1,0,3,2] row_mask:0xf bank_mask:0xf
    v_mov_b32 v24, v26
    s_nop 1
    v_add_f32_dpp v26, v24, v24 quad_perm:[2,3,0,1] row_mask:0xf bank_mask:0xf
    v_mov_b32 v24, v26
    s_nop 1
    v_add_f32_dpp v26, v24, v24 row_half_mirror row_mask:0xf bank_mask:0xf
    v_mov_b32 v24, v26
    s_nop 1
    v_add_f32_dpp v26, v24, v24 row_mirror row_mask:0xf bank_mask:0xf
    v_mov_b32 v24, v26
    s_nop 1
    v_readlane_b32 s24, v24, 0
    v_readlane_b32 s25, v24, 16
    v_readlane_b32 s26, v24, 32
    v_readlane_b32 s27, v24, 48
    s_nop 1
    v_mov_b32 v24, s24
    v_add_f32 v24, s25, v24
    v_add_f32 v24, s26, v24
    v_add_f32 v24, s27, v24
    v_mul_f32 v24, 0x3b000000, v24
    v_mov_b32 v25, 0
    v_sub_f32 v26, v156, v24
    v_fmac_f32 v25, v26, v26
    v_sub_f32 v26, v157, v24
    v_fmac_f32 v25, v26, v26
    v_sub_f32 v26, v158, v24
    v_fmac_f32 v25, v26, v26
    v_sub_f32 v26, v159, v24
    v_fmac_f32 v25, v26, v26
    v_sub_f32 v26, v160, v24
    v_fmac_f32 v25, v26, v26
    v_sub_f32 v26, v161, v24
    v_fmac_f32 v25, v26, v26
    v_sub_f32 v26, v162, v24
    v_fmac_f32 v25, v26, v26
    v_sub_f32 v26, v163, v24
    v_fmac_f32 v25, v26, v26
    s_nop 1
    v_add_f32_dpp v26, v25, v25 quad_perm:[1,0,3,2] row_mask:0xf bank_mask:0xf
    v_mov_b32 v25, v26
    s_nop 1
    v_add_f32_dpp v26, v25, v25 quad_perm:[2,3,0,1] row_mask:0xf bank_mask:0xf
    v_mov_b32 v25, v26
    s_nop 1
    v_add_f32_dpp v26, v25, v25 row_half_mirror row_mask:0xf bank_mask:0xf
    v_mov_b32 v25, v26
    s_nop 1
    v_add_f32_dpp v26, v25, v25 row_mirror row_mask:0xf bank_mask:0xf
    v_mov_b32 v25, v26
    s_nop 1
    v_readlane_b32 s24, v25, 0
    v_readlane_b32 s25, v25, 16
    v_readlane_b32 s26, v25, 32
    v_readlane_b32 s27, v25, 48
    s_nop 1
    v_mov_b32 v25, s24
    v_add_f32 v25, s25, v25
    v_add_f32 v25, s26, v25
    v_add_f32 v25, s27, v25
    v_mul_f32 v25, 0x3b000000, v25
    v_cvt_pk_bf16_f32 v26, v24, v25
    v_lshlrev_b32 v24, 16, v26
    v_and_b32 v25, 0xffff0000, v26
    v_add_f32 v25, 0x3727c5ac, v25
    v_cvt_pk_bf16_f32 v26, v25, v25
    v_lshlrev_b32 v25, 16, v26
    v_and_b32 v25, 0xffff0000, v26
    v_sqrt_f32 v25, v25
    s_nop 0
    v_cvt_pk_bf16_f32 v26, v25, v25
    v_lshlrev_b32 v25, 16, v26
    v_and_b32 v25, 0xffff0000, v26
    v_rcp_f32 v27, v25
    s_nop 0
    v_mov_b32 v184, v24
    v_mov_b32 v185, v25
    v_mov_b32 v187, v27
    v_lshlrev_b32 v164, 16, v140
    v_and_b32 v165, 0xffff0000, v140
    v_lshlrev_b32 v166, 16, v141
    v_and_b32 v167, 0xffff0000, v141
    v_lshlrev_b32 v168, 16, v142
    v_and_b32 v169, 0xffff0000, v142
    v_lshlrev_b32 v170, 16, v143
    v_and_b32 v171, 0xffff0000, v143
    v_add_f32 v24, v164, v165
    v_add_f32 v24, v24, v166
    v_add_f32 v24, v24, v167
    v_add_f32 v24, v24, v168
    v_add_f32 v24, v24, v169
    v_add_f32 v24, v24, v170
    v_add_f32 v24, v24, v171
    s_nop 1
    v_add_f32_dpp v26, v24, v24 quad_perm:[1,0,3,2] row_mask:0xf bank_mask:0xf
    v_mov_b32 v24, v26
    s_nop 1
    v_add_f32_dpp v26, v24, v24 quad_perm:[2,3,0,1] row_mask:0xf bank_mask:0xf
    v_mov_b32 v24, v26
    s_nop 1
    v_add_f32_dpp v26, v24, v24 row_half_mirror row_mask:0xf bank_mask:0xf
    v_mov_b32 v24, v26
    s_nop 1
    v_add_f32_dpp v26, v24, v24 row_mirror row_mask:0xf bank_mask:0xf
    v_mov_b32 v24, v26
    s_nop 1
    v_readlane_b32 s24, v24, 0
    v_readlane_b32 s25, v24, 16
    v_readlane_b32 s26, v24, 32
    v_readlane_b32 s27, v24, 48
    s_nop 1
    v_mov_b32 v24, s24
    v_add_f32 v24, s25, v24
    v_add_f32 v24, s26, v24
    v_add_f32 v24, s27, v24
    v_mul_f32 v24, 0x3b000000, v24
    v_mov_b32 v25, 0
    v_sub_f32 v26, v164, v24
    v_fmac_f32 v25, v26, v26
    v_sub_f32 v26, v165, v24
    v_fmac_f32 v25, v26, v26
    v_sub_f32 v26, v166, v24
    v_fmac_f32 v25, v26, v26
    v_sub_f32 v26, v167, v24
    v_fmac_f32 v25, v26, v26
    v_sub_f32 v26, v168, v24
    v_fmac_f32 v25, v26, v26
    v_sub_f32 v26, v169, v24
    v_fmac_f32 v25, v26, v26
    v_sub_f32 v26, v170, v24
    v_fmac_f32 v25, v26, v26
    v_sub_f32 v26, v171, v24
    v_fmac_f32 v25, v26, v26
    s_nop 1
    v_add_f32_dpp v26, v25, v25 quad_perm:[1,0,3,2] row_mask:0xf bank_mask:0xf
    v_mov_b32 v25, v26
    s_nop 1
    v_add_f32_dpp v26, v25, v25 quad_perm:[2,3,0,1] row_mask:0xf bank_mask:0xf
    v_mov_b32 v25, v26
    s_nop 1
    v_add_f32_dpp v26, v25, v25 row_half_mirror row_mask:0xf bank_mask:0xf
    v_mov_b32 v25, v26
    s_nop 1
    v_add_f32_dpp v26, v25, v25 row_mirror row_mask:0xf bank_mask:0xf
    v_mov_b32 v25, v26
    s_nop 1
    v_readlane_b32 s24, v25, 0
    v_readlane_b32 s25, v25, 16
    v_readlane_b32 s26, v25, 32
    v_readlane_b32 s27, v25, 48
    s_nop 1
    v_mov_b32 v25, s24
    v_add_f32 v25, s25, v25
    v_add_f32 v25, s26, v25
    v_add_f32 v25, s27, v25
    v_mul_f32 v25, 0x3b000000, v25
    v_cvt_pk_bf16_f32 v26, v24, v25
    v_lshlrev_b32 v24, 16, v26
    v_and_b32 v25, 0xffff0000, v26
    v_add_f32 v25, 0x3727c5ac, v25
    v_cvt_pk_bf16_f32 v26, v25, v25
    v_lshlrev_b32 v25, 16, v26
    v_and_b32 v25, 0xffff0000, v26
    v_sqrt_f32 v25, v25
    s_nop 0
    v_cvt_pk_bf16_f32 v26, v25, v25
    v_lshlrev_b32 v25, 16, v26
    v_and_b32 v25, 0xffff0000, v26
    v_rcp_f32 v27, v25
    s_nop 0
    v_mov_b32 v188, v24
    v_mov_b32 v189, v25
    v_mov_b32 v191, v27
    v_lshlrev_b32 v172, 16, v144
    v_and_b32 v173, 0xffff0000, v144
    v_lshlrev_b32 v174, 16, v145
    v_and_b32 v175, 0xffff0000, v145
    v_lshlrev_b32 v176, 16, v146
    v_and_b32 v177, 0xffff0000, v146
    v_lshlrev_b32 v178, 16, v147
    v_and_b32 v179, 0xffff0000, v147
    v_add_f32 v24, v172, v173
    v_add_f32 v24, v24, v174
    v_add_f32 v24, v24, v175
    v_add_f32 v24, v24, v176
    v_add_f32 v24, v24, v177
    v_add_f32 v24, v24, v178
    v_add_f32 v24, v24, v179
    s_nop 1
    v_add_f32_dpp v26, v24, v24 quad_perm:[1,0,3,2] row_mask:0xf bank_mask:0xf
    v_mov_b32 v24, v26
    s_nop 1
    v_add_f32_dpp v26, v24, v24 quad_perm:[2,3,0,1] row_mask:0xf bank_mask:0xf
    v_mov_b32 v24, v26
    s_nop 1
    v_add_f32_dpp v26, v24, v24 row_half_mirror row_mask:0xf bank_mask:0xf
    v_mov_b32 v24, v26
    s_nop 1
    v_add_f32_dpp v26, v24, v24 row_mirror row_mask:0xf bank_mask:0xf
    v_mov_b32 v24, v26
    s_nop 1
    v_readlane_b32 s24, v24, 0
    v_readlane_b32 s25, v24, 16
    v_readlane_b32 s26, v24, 32
    v_readlane_b32 s27, v24, 48
    s_nop 1
    v_mov_b32 v24, s24
    v_add_f32 v24, s25, v24
    v_add_f32 v24, s26, v24
    v_add_f32 v24, s27, v24
    v_mul_f32 v24, 0x3b000000, v24
    v_mov_b32 v25, 0
    v_sub_f32 v26, v172, v24
    v_fmac_f32 v25, v26, v26
    v_sub_f32 v26, v173, v24
    v_fmac_f32 v25, v26, v26
    v_sub_f32 v26, v174, v24
    v_fmac_f32 v25, v26, v26
    v_sub_f32 v26, v175, v24
    v_fmac_f32 v25, v26, v26
    v_sub_f32 v26, v176, v24
    v_fmac_f32 v25, v26, v26
    v_sub_f32 v26, v177, v24
    v_fmac_f32 v25, v26, v26
    v_sub_f32 v26, v178, v24
    v_fmac_f32 v25, v26, v26
    v_sub_f32 v26, v179, v24
    v_fmac_f32 v25, v26, v26
    s_nop 1
    v_add_f32_dpp v26, v25, v25 quad_perm:[1,0,3,2] row_mask:0xf bank_mask:0xf
    v_mov_b32 v25, v26
    s_nop 1
    v_add_f32_dpp v26, v25, v25 quad_perm:[2,3,0,1] row_mask:0xf bank_mask:0xf
    v_mov_b32 v25, v26
    s_nop 1
    v_add_f32_dpp v26, v25, v25 row_half_mirror row_mask:0xf bank_mask:0xf
    v_mov_b32 v25, v26
    s_nop 1
    v_add_f32_dpp v26, v25, v25 row_mirror row_mask:0xf bank_mask:0xf
    v_mov_b32 v25, v26
    s_nop 1
    v_readlane_b32 s24, v25, 0
    v_readlane_b32 s25, v25, 16
    v_readlane_b32 s26, v25, 32
    v_readlane_b32 s27, v25, 48
    s_nop 1
    v_mov_b32 v25, s24
    v_add_f32 v25, s25, v25
    v_add_f32 v25, s26, v25
    v_add_f32 v25, s27, v25
    v_mul_f32 v25, 0x3b000000, v25
    v_cvt_pk_bf16_f32 v26, v24, v25
    v_lshlrev_b32 v24, 16, v26
    v_and_b32 v25, 0xffff0000, v26
    v_add_f32 v25, 0x3727c5ac, v25
    v_cvt_pk_bf16_f32 v26, v25, v25
    v_lshlrev_b32 v25, 16, v26
    v_and_b32 v25, 0xffff0000, v26
    v_sqrt_f32 v25, v25
    s_nop 0
    v_cvt_pk_bf16_f32 v26, v25, v25
    v_lshlrev_b32 v25, 16, v26
    v_and_b32 v25, 0xffff0000, v26
    v_rcp_f32 v27, v25
    s_nop 0
    v_mov_b32 v192, v24
    v_mov_b32 v193, v25
    v_mov_b32 v195, v27
    v_lshrrev_b32 v50, 6, v0
    v_lshlrev_b32 v50, 2, v50
    s_lshl_b32 s41, s2, 4
    v_add_u32 v50, s41, v50
    v_lshrrev_b32 v2, 5, v50
    v_lshlrev_b32 v2, 15, v2
    v_and_b32 v50, 31, v50
    v_lshl_add_u32 v2, v50, 4, v2
    v_and_b32 v50, 63, v0
    v_lshrrev_b32 v51, 1, v50
    v_lshl_add_u32 v2, v51, 10, v2
    v_and_b32 v50, 1, v50
    v_lshl_add_u32 v2, v50, 9, v2
    v_lshrrev_b32 v50, 6, v0
    s_nop 0
    v_readfirstlane_b32 s42, v50
    s_cmp_lg_u32 s42, 0
    s_cbranch_scc1 pre_kernel_ready
    v_mov_b32 v50, 0
pre_kernel_poll:
    buffer_load_dword v51, v50, s[60:63], 0 offen sc0 sc1
    s_waitcnt vmcnt(0)
    v_readfirstlane_b32 s42, v51
    s_cmp_ge_u32 s42, 48
    s_cbranch_scc1 pre_kernel_ready
    s_sleep 2
    s_branch pre_kernel_poll
pre_kernel_ready:
    s_barrier
    v_mbcnt_lo_u32_b32 v46, -1, 0
    v_mbcnt_hi_u32_b32 v46, -1, v46
    v_lshlrev_b32 v46, 5, v46
    s_mov_b32 s29, 0
    s_mov_b32 s30, 2048
    buffer_load_dwordx4 v[28:31], v46, s[16:19], s29 offen sc0 sc1
    buffer_load_dwordx4 v[32:35], v46, s[16:19], s29 offen offset:16 sc0 sc1
    buffer_load_dwordx4 v[36:39], v46, s[16:19], s30 offen sc0 sc1
    buffer_load_dwordx4 v[40:43], v46, s[16:19], s30 offen offset:16 sc0 sc1
    s_waitcnt vmcnt(0)
    v_mov_b32 v64, v36
    v_mov_b32 v65, v37
    v_mov_b32 v66, v38
    v_mov_b32 v67, v39
    v_mov_b32 v68, v40
    v_mov_b32 v69, v41
    v_mov_b32 v70, v42
    v_mov_b32 v71, v43
    v_mov_b32 v24, v180
    v_mov_b32 v25, v181
    v_mov_b32 v27, v183
    v_mov_b32 v36, v64
    v_mov_b32 v37, v65
    v_mov_b32 v38, v66
    v_mov_b32 v39, v67
    v_mov_b32 v40, v68
    v_mov_b32 v41, v69
    v_mov_b32 v42, v70
    v_mov_b32 v43, v71
    v_mov_b32 v8, v148
    v_mov_b32 v9, v149
    v_mov_b32 v10, v150
    v_mov_b32 v11, v151
    v_mov_b32 v12, v152
    v_mov_b32 v13, v153
    v_mov_b32 v14, v154
    v_mov_b32 v15, v155
    v_sub_f32 v8, v8, v24
    v_sub_f32 v9, v9, v24
    v_cvt_pk_bf16_f32 v26, v8, v9
    v_lshlrev_b32 v8, 16, v26
    v_and_b32 v9, 0xffff0000, v26
    v_mul_f32 v44, v8, v27
    v_fma_f32 v45, -v44, v25, v8
    v_fma_f32 v8, v45, v27, v44
    v_mul_f32 v44, v9, v27
    v_fma_f32 v45, -v44, v25, v9
    v_fma_f32 v9, v45, v27, v44
    v_cvt_pk_bf16_f32 v26, v8, v9
    v_lshlrev_b32 v8, 16, v26
    v_and_b32 v9, 0xffff0000, v26
    v_add_f32 v36, 1.0, v36
    v_add_f32 v37, 1.0, v37
    v_cvt_pk_bf16_f32 v26, v36, v37
    v_lshlrev_b32 v36, 16, v26
    v_and_b32 v37, 0xffff0000, v26
    v_mul_f32 v8, v8, v36
    v_mul_f32 v9, v9, v37
    v_cvt_pk_bf16_f32 v26, v8, v9
    v_lshlrev_b32 v8, 16, v26
    v_and_b32 v9, 0xffff0000, v26
    v_add_f32 v8, v8, v28
    v_add_f32 v9, v9, v29
    v_cvt_pk_bf16_f32 v16, v8, v9
    v_sub_f32 v10, v10, v24
    v_sub_f32 v11, v11, v24
    v_cvt_pk_bf16_f32 v26, v10, v11
    v_lshlrev_b32 v10, 16, v26
    v_and_b32 v11, 0xffff0000, v26
    v_mul_f32 v44, v10, v27
    v_fma_f32 v45, -v44, v25, v10
    v_fma_f32 v10, v45, v27, v44
    v_mul_f32 v44, v11, v27
    v_fma_f32 v45, -v44, v25, v11
    v_fma_f32 v11, v45, v27, v44
    v_cvt_pk_bf16_f32 v26, v10, v11
    v_lshlrev_b32 v10, 16, v26
    v_and_b32 v11, 0xffff0000, v26
    v_add_f32 v38, 1.0, v38
    v_add_f32 v39, 1.0, v39
    v_cvt_pk_bf16_f32 v26, v38, v39
    v_lshlrev_b32 v38, 16, v26
    v_and_b32 v39, 0xffff0000, v26
    v_mul_f32 v10, v10, v38
    v_mul_f32 v11, v11, v39
    v_cvt_pk_bf16_f32 v26, v10, v11
    v_lshlrev_b32 v10, 16, v26
    v_and_b32 v11, 0xffff0000, v26
    v_add_f32 v10, v10, v30
    v_add_f32 v11, v11, v31
    v_cvt_pk_bf16_f32 v17, v10, v11
    v_sub_f32 v12, v12, v24
    v_sub_f32 v13, v13, v24
    v_cvt_pk_bf16_f32 v26, v12, v13
    v_lshlrev_b32 v12, 16, v26
    v_and_b32 v13, 0xffff0000, v26
    v_mul_f32 v44, v12, v27
    v_fma_f32 v45, -v44, v25, v12
    v_fma_f32 v12, v45, v27, v44
    v_mul_f32 v44, v13, v27
    v_fma_f32 v45, -v44, v25, v13
    v_fma_f32 v13, v45, v27, v44
    v_cvt_pk_bf16_f32 v26, v12, v13
    v_lshlrev_b32 v12, 16, v26
    v_and_b32 v13, 0xffff0000, v26
    v_add_f32 v40, 1.0, v40
    v_add_f32 v41, 1.0, v41
    v_cvt_pk_bf16_f32 v26, v40, v41
    v_lshlrev_b32 v40, 16, v26
    v_and_b32 v41, 0xffff0000, v26
    v_mul_f32 v12, v12, v40
    v_mul_f32 v13, v13, v41
    v_cvt_pk_bf16_f32 v26, v12, v13
    v_lshlrev_b32 v12, 16, v26
    v_and_b32 v13, 0xffff0000, v26
    v_add_f32 v12, v12, v32
    v_add_f32 v13, v13, v33
    v_cvt_pk_bf16_f32 v18, v12, v13
    v_sub_f32 v14, v14, v24
    v_sub_f32 v15, v15, v24
    v_cvt_pk_bf16_f32 v26, v14, v15
    v_lshlrev_b32 v14, 16, v26
    v_and_b32 v15, 0xffff0000, v26
    v_mul_f32 v44, v14, v27
    v_fma_f32 v45, -v44, v25, v14
    v_fma_f32 v14, v45, v27, v44
    v_mul_f32 v44, v15, v27
    v_fma_f32 v45, -v44, v25, v15
    v_fma_f32 v15, v45, v27, v44
    v_cvt_pk_bf16_f32 v26, v14, v15
    v_lshlrev_b32 v14, 16, v26
    v_and_b32 v15, 0xffff0000, v26
    v_add_f32 v42, 1.0, v42
    v_add_f32 v43, 1.0, v43
    v_cvt_pk_bf16_f32 v26, v42, v43
    v_lshlrev_b32 v42, 16, v26
    v_and_b32 v43, 0xffff0000, v26
    v_mul_f32 v14, v14, v42
    v_mul_f32 v15, v15, v43
    v_cvt_pk_bf16_f32 v26, v14, v15
    v_lshlrev_b32 v14, 16, v26
    v_and_b32 v15, 0xffff0000, v26
    v_add_f32 v14, v14, v34
    v_add_f32 v15, v15, v35
    v_cvt_pk_bf16_f32 v19, v14, v15
    buffer_store_dwordx4 v[16:19], v2, s[20:23], 0 offen offset:0
    s_nop 1
    v_mov_b32 v24, v184
    v_mov_b32 v25, v185
    v_mov_b32 v27, v187
    v_mov_b32 v36, v64
    v_mov_b32 v37, v65
    v_mov_b32 v38, v66
    v_mov_b32 v39, v67
    v_mov_b32 v40, v68
    v_mov_b32 v41, v69
    v_mov_b32 v42, v70
    v_mov_b32 v43, v71
    v_mov_b32 v8, v156
    v_mov_b32 v9, v157
    v_mov_b32 v10, v158
    v_mov_b32 v11, v159
    v_mov_b32 v12, v160
    v_mov_b32 v13, v161
    v_mov_b32 v14, v162
    v_mov_b32 v15, v163
    v_sub_f32 v8, v8, v24
    v_sub_f32 v9, v9, v24
    v_cvt_pk_bf16_f32 v26, v8, v9
    v_lshlrev_b32 v8, 16, v26
    v_and_b32 v9, 0xffff0000, v26
    v_mul_f32 v44, v8, v27
    v_fma_f32 v45, -v44, v25, v8
    v_fma_f32 v8, v45, v27, v44
    v_mul_f32 v44, v9, v27
    v_fma_f32 v45, -v44, v25, v9
    v_fma_f32 v9, v45, v27, v44
    v_cvt_pk_bf16_f32 v26, v8, v9
    v_lshlrev_b32 v8, 16, v26
    v_and_b32 v9, 0xffff0000, v26
    v_add_f32 v36, 1.0, v36
    v_add_f32 v37, 1.0, v37
    v_cvt_pk_bf16_f32 v26, v36, v37
    v_lshlrev_b32 v36, 16, v26
    v_and_b32 v37, 0xffff0000, v26
    v_mul_f32 v8, v8, v36
    v_mul_f32 v9, v9, v37
    v_cvt_pk_bf16_f32 v26, v8, v9
    v_lshlrev_b32 v8, 16, v26
    v_and_b32 v9, 0xffff0000, v26
    v_add_f32 v8, v8, v28
    v_add_f32 v9, v9, v29
    v_cvt_pk_bf16_f32 v16, v8, v9
    v_sub_f32 v10, v10, v24
    v_sub_f32 v11, v11, v24
    v_cvt_pk_bf16_f32 v26, v10, v11
    v_lshlrev_b32 v10, 16, v26
    v_and_b32 v11, 0xffff0000, v26
    v_mul_f32 v44, v10, v27
    v_fma_f32 v45, -v44, v25, v10
    v_fma_f32 v10, v45, v27, v44
    v_mul_f32 v44, v11, v27
    v_fma_f32 v45, -v44, v25, v11
    v_fma_f32 v11, v45, v27, v44
    v_cvt_pk_bf16_f32 v26, v10, v11
    v_lshlrev_b32 v10, 16, v26
    v_and_b32 v11, 0xffff0000, v26
    v_add_f32 v38, 1.0, v38
    v_add_f32 v39, 1.0, v39
    v_cvt_pk_bf16_f32 v26, v38, v39
    v_lshlrev_b32 v38, 16, v26
    v_and_b32 v39, 0xffff0000, v26
    v_mul_f32 v10, v10, v38
    v_mul_f32 v11, v11, v39
    v_cvt_pk_bf16_f32 v26, v10, v11
    v_lshlrev_b32 v10, 16, v26
    v_and_b32 v11, 0xffff0000, v26
    v_add_f32 v10, v10, v30
    v_add_f32 v11, v11, v31
    v_cvt_pk_bf16_f32 v17, v10, v11
    v_sub_f32 v12, v12, v24
    v_sub_f32 v13, v13, v24
    v_cvt_pk_bf16_f32 v26, v12, v13
    v_lshlrev_b32 v12, 16, v26
    v_and_b32 v13, 0xffff0000, v26
    v_mul_f32 v44, v12, v27
    v_fma_f32 v45, -v44, v25, v12
    v_fma_f32 v12, v45, v27, v44
    v_mul_f32 v44, v13, v27
    v_fma_f32 v45, -v44, v25, v13
    v_fma_f32 v13, v45, v27, v44
    v_cvt_pk_bf16_f32 v26, v12, v13
    v_lshlrev_b32 v12, 16, v26
    v_and_b32 v13, 0xffff0000, v26
    v_add_f32 v40, 1.0, v40
    v_add_f32 v41, 1.0, v41
    v_cvt_pk_bf16_f32 v26, v40, v41
    v_lshlrev_b32 v40, 16, v26
    v_and_b32 v41, 0xffff0000, v26
    v_mul_f32 v12, v12, v40
    v_mul_f32 v13, v13, v41
    v_cvt_pk_bf16_f32 v26, v12, v13
    v_lshlrev_b32 v12, 16, v26
    v_and_b32 v13, 0xffff0000, v26
    v_add_f32 v12, v12, v32
    v_add_f32 v13, v13, v33
    v_cvt_pk_bf16_f32 v18, v12, v13
    v_sub_f32 v14, v14, v24
    v_sub_f32 v15, v15, v24
    v_cvt_pk_bf16_f32 v26, v14, v15
    v_lshlrev_b32 v14, 16, v26
    v_and_b32 v15, 0xffff0000, v26
    v_mul_f32 v44, v14, v27
    v_fma_f32 v45, -v44, v25, v14
    v_fma_f32 v14, v45, v27, v44
    v_mul_f32 v44, v15, v27
    v_fma_f32 v45, -v44, v25, v15
    v_fma_f32 v15, v45, v27, v44
    v_cvt_pk_bf16_f32 v26, v14, v15
    v_lshlrev_b32 v14, 16, v26
    v_and_b32 v15, 0xffff0000, v26
    v_add_f32 v42, 1.0, v42
    v_add_f32 v43, 1.0, v43
    v_cvt_pk_bf16_f32 v26, v42, v43
    v_lshlrev_b32 v42, 16, v26
    v_and_b32 v43, 0xffff0000, v26
    v_mul_f32 v14, v14, v42
    v_mul_f32 v15, v15, v43
    v_cvt_pk_bf16_f32 v26, v14, v15
    v_lshlrev_b32 v14, 16, v26
    v_and_b32 v15, 0xffff0000, v26
    v_add_f32 v14, v14, v34
    v_add_f32 v15, v15, v35
    v_cvt_pk_bf16_f32 v19, v14, v15
    buffer_store_dwordx4 v[16:19], v2, s[20:23], 0 offen offset:16
    s_nop 1
    v_mov_b32 v24, v188
    v_mov_b32 v25, v189
    v_mov_b32 v27, v191
    v_mov_b32 v36, v64
    v_mov_b32 v37, v65
    v_mov_b32 v38, v66
    v_mov_b32 v39, v67
    v_mov_b32 v40, v68
    v_mov_b32 v41, v69
    v_mov_b32 v42, v70
    v_mov_b32 v43, v71
    v_mov_b32 v8, v164
    v_mov_b32 v9, v165
    v_mov_b32 v10, v166
    v_mov_b32 v11, v167
    v_mov_b32 v12, v168
    v_mov_b32 v13, v169
    v_mov_b32 v14, v170
    v_mov_b32 v15, v171
    v_sub_f32 v8, v8, v24
    v_sub_f32 v9, v9, v24
    v_cvt_pk_bf16_f32 v26, v8, v9
    v_lshlrev_b32 v8, 16, v26
    v_and_b32 v9, 0xffff0000, v26
    v_mul_f32 v44, v8, v27
    v_fma_f32 v45, -v44, v25, v8
    v_fma_f32 v8, v45, v27, v44
    v_mul_f32 v44, v9, v27
    v_fma_f32 v45, -v44, v25, v9
    v_fma_f32 v9, v45, v27, v44
    v_cvt_pk_bf16_f32 v26, v8, v9
    v_lshlrev_b32 v8, 16, v26
    v_and_b32 v9, 0xffff0000, v26
    v_add_f32 v36, 1.0, v36
    v_add_f32 v37, 1.0, v37
    v_cvt_pk_bf16_f32 v26, v36, v37
    v_lshlrev_b32 v36, 16, v26
    v_and_b32 v37, 0xffff0000, v26
    v_mul_f32 v8, v8, v36
    v_mul_f32 v9, v9, v37
    v_cvt_pk_bf16_f32 v26, v8, v9
    v_lshlrev_b32 v8, 16, v26
    v_and_b32 v9, 0xffff0000, v26
    v_add_f32 v8, v8, v28
    v_add_f32 v9, v9, v29
    v_cvt_pk_bf16_f32 v16, v8, v9
    v_sub_f32 v10, v10, v24
    v_sub_f32 v11, v11, v24
    v_cvt_pk_bf16_f32 v26, v10, v11
    v_lshlrev_b32 v10, 16, v26
    v_and_b32 v11, 0xffff0000, v26
    v_mul_f32 v44, v10, v27
    v_fma_f32 v45, -v44, v25, v10
    v_fma_f32 v10, v45, v27, v44
    v_mul_f32 v44, v11, v27
    v_fma_f32 v45, -v44, v25, v11
    v_fma_f32 v11, v45, v27, v44
    v_cvt_pk_bf16_f32 v26, v10, v11
    v_lshlrev_b32 v10, 16, v26
    v_and_b32 v11, 0xffff0000, v26
    v_add_f32 v38, 1.0, v38
    v_add_f32 v39, 1.0, v39
    v_cvt_pk_bf16_f32 v26, v38, v39
    v_lshlrev_b32 v38, 16, v26
    v_and_b32 v39, 0xffff0000, v26
    v_mul_f32 v10, v10, v38
    v_mul_f32 v11, v11, v39
    v_cvt_pk_bf16_f32 v26, v10, v11
    v_lshlrev_b32 v10, 16, v26
    v_and_b32 v11, 0xffff0000, v26
    v_add_f32 v10, v10, v30
    v_add_f32 v11, v11, v31
    v_cvt_pk_bf16_f32 v17, v10, v11
    v_sub_f32 v12, v12, v24
    v_sub_f32 v13, v13, v24
    v_cvt_pk_bf16_f32 v26, v12, v13
    v_lshlrev_b32 v12, 16, v26
    v_and_b32 v13, 0xffff0000, v26
    v_mul_f32 v44, v12, v27
    v_fma_f32 v45, -v44, v25, v12
    v_fma_f32 v12, v45, v27, v44
    v_mul_f32 v44, v13, v27
    v_fma_f32 v45, -v44, v25, v13
    v_fma_f32 v13, v45, v27, v44
    v_cvt_pk_bf16_f32 v26, v12, v13
    v_lshlrev_b32 v12, 16, v26
    v_and_b32 v13, 0xffff0000, v26
    v_add_f32 v40, 1.0, v40
    v_add_f32 v41, 1.0, v41
    v_cvt_pk_bf16_f32 v26, v40, v41
    v_lshlrev_b32 v40, 16, v26
    v_and_b32 v41, 0xffff0000, v26
    v_mul_f32 v12, v12, v40
    v_mul_f32 v13, v13, v41
    v_cvt_pk_bf16_f32 v26, v12, v13
    v_lshlrev_b32 v12, 16, v26
    v_and_b32 v13, 0xffff0000, v26
    v_add_f32 v12, v12, v32
    v_add_f32 v13, v13, v33
    v_cvt_pk_bf16_f32 v18, v12, v13
    v_sub_f32 v14, v14, v24
    v_sub_f32 v15, v15, v24
    v_cvt_pk_bf16_f32 v26, v14, v15
    v_lshlrev_b32 v14, 16, v26
    v_and_b32 v15, 0xffff0000, v26
    v_mul_f32 v44, v14, v27
    v_fma_f32 v45, -v44, v25, v14
    v_fma_f32 v14, v45, v27, v44
    v_mul_f32 v44, v15, v27
    v_fma_f32 v45, -v44, v25, v15
    v_fma_f32 v15, v45, v27, v44
    v_cvt_pk_bf16_f32 v26, v14, v15
    v_lshlrev_b32 v14, 16, v26
    v_and_b32 v15, 0xffff0000, v26
    v_add_f32 v42, 1.0, v42
    v_add_f32 v43, 1.0, v43
    v_cvt_pk_bf16_f32 v26, v42, v43
    v_lshlrev_b32 v42, 16, v26
    v_and_b32 v43, 0xffff0000, v26
    v_mul_f32 v14, v14, v42
    v_mul_f32 v15, v15, v43
    v_cvt_pk_bf16_f32 v26, v14, v15
    v_lshlrev_b32 v14, 16, v26
    v_and_b32 v15, 0xffff0000, v26
    v_add_f32 v14, v14, v34
    v_add_f32 v15, v15, v35
    v_cvt_pk_bf16_f32 v19, v14, v15
    buffer_store_dwordx4 v[16:19], v2, s[20:23], 0 offen offset:32
    s_nop 1
    v_mov_b32 v24, v192
    v_mov_b32 v25, v193
    v_mov_b32 v27, v195
    v_mov_b32 v36, v64
    v_mov_b32 v37, v65
    v_mov_b32 v38, v66
    v_mov_b32 v39, v67
    v_mov_b32 v40, v68
    v_mov_b32 v41, v69
    v_mov_b32 v42, v70
    v_mov_b32 v43, v71
    v_mov_b32 v8, v172
    v_mov_b32 v9, v173
    v_mov_b32 v10, v174
    v_mov_b32 v11, v175
    v_mov_b32 v12, v176
    v_mov_b32 v13, v177
    v_mov_b32 v14, v178
    v_mov_b32 v15, v179
    v_sub_f32 v8, v8, v24
    v_sub_f32 v9, v9, v24
    v_cvt_pk_bf16_f32 v26, v8, v9
    v_lshlrev_b32 v8, 16, v26
    v_and_b32 v9, 0xffff0000, v26
    v_mul_f32 v44, v8, v27
    v_fma_f32 v45, -v44, v25, v8
    v_fma_f32 v8, v45, v27, v44
    v_mul_f32 v44, v9, v27
    v_fma_f32 v45, -v44, v25, v9
    v_fma_f32 v9, v45, v27, v44
    v_cvt_pk_bf16_f32 v26, v8, v9
    v_lshlrev_b32 v8, 16, v26
    v_and_b32 v9, 0xffff0000, v26
    v_add_f32 v36, 1.0, v36
    v_add_f32 v37, 1.0, v37
    v_cvt_pk_bf16_f32 v26, v36, v37
    v_lshlrev_b32 v36, 16, v26
    v_and_b32 v37, 0xffff0000, v26
    v_mul_f32 v8, v8, v36
    v_mul_f32 v9, v9, v37
    v_cvt_pk_bf16_f32 v26, v8, v9
    v_lshlrev_b32 v8, 16, v26
    v_and_b32 v9, 0xffff0000, v26
    v_add_f32 v8, v8, v28
    v_add_f32 v9, v9, v29
    v_cvt_pk_bf16_f32 v16, v8, v9
    v_sub_f32 v10, v10, v24
    v_sub_f32 v11, v11, v24
    v_cvt_pk_bf16_f32 v26, v10, v11
    v_lshlrev_b32 v10, 16, v26
    v_and_b32 v11, 0xffff0000, v26
    v_mul_f32 v44, v10, v27
    v_fma_f32 v45, -v44, v25, v10
    v_fma_f32 v10, v45, v27, v44
    v_mul_f32 v44, v11, v27
    v_fma_f32 v45, -v44, v25, v11
    v_fma_f32 v11, v45, v27, v44
    v_cvt_pk_bf16_f32 v26, v10, v11
    v_lshlrev_b32 v10, 16, v26
    v_and_b32 v11, 0xffff0000, v26
    v_add_f32 v38, 1.0, v38
    v_add_f32 v39, 1.0, v39
    v_cvt_pk_bf16_f32 v26, v38, v39
    v_lshlrev_b32 v38, 16, v26
    v_and_b32 v39, 0xffff0000, v26
    v_mul_f32 v10, v10, v38
    v_mul_f32 v11, v11, v39
    v_cvt_pk_bf16_f32 v26, v10, v11
    v_lshlrev_b32 v10, 16, v26
    v_and_b32 v11, 0xffff0000, v26
    v_add_f32 v10, v10, v30
    v_add_f32 v11, v11, v31
    v_cvt_pk_bf16_f32 v17, v10, v11
    v_sub_f32 v12, v12, v24
    v_sub_f32 v13, v13, v24
    v_cvt_pk_bf16_f32 v26, v12, v13
    v_lshlrev_b32 v12, 16, v26
    v_and_b32 v13, 0xffff0000, v26
    v_mul_f32 v44, v12, v27
    v_fma_f32 v45, -v44, v25, v12
    v_fma_f32 v12, v45, v27, v44
    v_mul_f32 v44, v13, v27
    v_fma_f32 v45, -v44, v25, v13
    v_fma_f32 v13, v45, v27, v44
    v_cvt_pk_bf16_f32 v26, v12, v13
    v_lshlrev_b32 v12, 16, v26
    v_and_b32 v13, 0xffff0000, v26
    v_add_f32 v40, 1.0, v40
    v_add_f32 v41, 1.0, v41
    v_cvt_pk_bf16_f32 v26, v40, v41
    v_lshlrev_b32 v40, 16, v26
    v_and_b32 v41, 0xffff0000, v26
    v_mul_f32 v12, v12, v40
    v_mul_f32 v13, v13, v41
    v_cvt_pk_bf16_f32 v26, v12, v13
    v_lshlrev_b32 v12, 16, v26
    v_and_b32 v13, 0xffff0000, v26
    v_add_f32 v12, v12, v32
    v_add_f32 v13, v13, v33
    v_cvt_pk_bf16_f32 v18, v12, v13
    v_sub_f32 v14, v14, v24
    v_sub_f32 v15, v15, v24
    v_cvt_pk_bf16_f32 v26, v14, v15
    v_lshlrev_b32 v14, 16, v26
    v_and_b32 v15, 0xffff0000, v26
    v_mul_f32 v44, v14, v27
    v_fma_f32 v45, -v44, v25, v14
    v_fma_f32 v14, v45, v27, v44
    v_mul_f32 v44, v15, v27
    v_fma_f32 v45, -v44, v25, v15
    v_fma_f32 v15, v45, v27, v44
    v_cvt_pk_bf16_f32 v26, v14, v15
    v_lshlrev_b32 v14, 16, v26
    v_and_b32 v15, 0xffff0000, v26
    v_add_f32 v42, 1.0, v42
    v_add_f32 v43, 1.0, v43
    v_cvt_pk_bf16_f32 v26, v42, v43
    v_lshlrev_b32 v42, 16, v26
    v_and_b32 v43, 0xffff0000, v26
    v_mul_f32 v14, v14, v42
    v_mul_f32 v15, v15, v43
    v_cvt_pk_bf16_f32 v26, v14, v15
    v_lshlrev_b32 v14, 16, v26
    v_and_b32 v15, 0xffff0000, v26
    v_add_f32 v14, v14, v34
    v_add_f32 v15, v15, v35
    v_cvt_pk_bf16_f32 v19, v14, v15
    buffer_store_dwordx4 v[16:19], v2, s[20:23], 0 offen offset:48
    s_nop 1
pre_kernel_done:
    s_endpgm
.section .rodata,"a"
.p2align 6
.amdhsa_kernel pre_kernel
  .amdhsa_next_free_vgpr 200
  .amdhsa_next_free_sgpr 102
  .amdhsa_accum_offset 200
  .amdhsa_group_segment_fixed_size 0
  .amdhsa_kernarg_size 112
  .amdhsa_user_sgpr_count 2
  .amdhsa_user_sgpr_kernarg_segment_ptr 1
  .amdhsa_system_sgpr_workgroup_id_x 1
  .amdhsa_float_denorm_mode_32 3
.end_amdhsa_kernel
.text
.globl attn_kernel
.p2align 8
.type attn_kernel,@function
attn_kernel:
    s_cmp_ge_u32 s2, 256
    s_cbranch_scc1 attn_kernel_done
    s_load_dwordx2 s[4:5], s[0:1], 8
    s_load_dwordx2 s[6:7], s[0:1], 16
    s_load_dwordx2 s[8:9], s[0:1], 24
    s_load_dwordx2 s[10:11], s[0:1], 104
    s_load_dwordx2 s[56:57], s[0:1], 32
    s_load_dwordx2 s[58:59], s[0:1], 48
    s_load_dwordx2 s[60:61], s[0:1], 56
    s_load_dwordx2 s[62:63], s[0:1], 64
    s_and_b32 s44, s2, 7
    s_lshr_b32 s45, s2, 3
    s_lshl_b32 s44, s44, 2
    s_lshr_b32 s46, s45, 3
    s_add_u32 s44, s44, s46
    s_and_b32 s45, s45, 7
    s_waitcnt lgkmcnt(0)
    s_lshl_b32 s46, s44, 19
    s_add_u32 s4, s4, s46
    s_addc_u32 s5, s5, 0
    s_add_u32 s6, s6, s46
    s_addc_u32 s7, s7, 0
    s_mov_b32 s12, s4
    s_and_b32 s13, s5, 0xffff
    s_mov_b32 s14, 524288
    s_mov_b32 s15, 0x20000
    s_mov_b32 s16, s6
    s_and_b32 s17, s7, 0xffff
    s_mov_b32 s18, 524288
    s_mov_b32 s19, 0x20000
    s_mov_b32 s20, s8
    s_and_b32 s21, s9, 0xffff
    s_mov_b32 s22, 4194304
    s_mov_b32 s23, 0x20000
    s_add_u32 s24, s10, 65536
    s_addc_u32 s25, s11, 0
    s_and_b32 s25, s25, 0xffff
    s_mov_b32 s26, 2097152
    s_mov_b32 s27, 0x20000
    s_add_u32 s28, s10, 4194304
    s_addc_u32 s29, s11, 0
    s_and_b32 s29, s29, 0xffff
    s_mov_b32 s30, 16777216
    s_mov_b32 s31, 0x20000
    v_lshrrev_b32 v1, 6, v0
    s_nop 0
    v_readfirstlane_b32 s40, v1
    v_and_b32 v1, 63, v0
    s_lshl_b32 s43, s40, 12
    v_lshrrev_b32 v2, 4, v1
    v_and_b32 v3, 15, v1
    s_lshl_b32 s46, s40, 4
    v_add_u32 v4, s46, v2
    v_lshlrev_b32 v5, 8, v4
    v_add_u32 v6, 0, v2
    v_xor_b32 v6, v3, v6
    v_lshl_add_u32 v28, v6, 4, v5
    v_add_u32 v6, 4, v2
    v_xor_b32 v6, v3, v6
    v_lshl_add_u32 v29, v6, 4, v5
    v_add_u32 v6, 8, v2
    v_xor_b32 v6, v3, v6
    v_lshl_add_u32 v30, v6, 4, v5
    v_add_u32 v6, 12, v2
    v_xor_b32 v6, v3, v6
    v_lshl_add_u32 v31, v6, 4, v5
    v_lshlrev_b32 v6, 2, v2
    v_xor_b32 v6, v3, v6
    v_lshl_add_u32 v32, v6, 4, v5
    v_lshlrev_b32 v7, 13, v4
    v_lshl_add_u32 v7, v6, 4, v7
    v_and_b32 v8, 31, v1
    v_lshrrev_b32 v9, 5, v1
    v_and_b32 v10, 15, v8
    v_lshlrev_b32 v11, 8, v8
    v_add_u32 v12, 0, v9
    v_xor_b32 v12, v12, v10
    v_lshl_add_u32 v16, v12, 4, v11
    v_add_u32 v12, 2, v9
    v_xor_b32 v12, v12, v10
    v_lshl_add_u32 v17, v12, 4, v11
    v_add_u32 v12, 4, v9
    v_xor_b32 v12, v12, v10
    v_lshl_add_u32 v18, v12, 4, v11
    v_add_u32 v12, 6, v9
    v_xor_b32 v12, v12, v10
    v_lshl_add_u32 v19, v12, 4, v11
    v_add_u32 v12, 8, v9
    v_xor_b32 v12, v12, v10
    v_lshl_add_u32 v20, v12, 4, v11
    v_add_u32 v12, 10, v9
    v_xor_b32 v12, v12, v10
    v_lshl_add_u32 v21, v12, 4, v11
    v_add_u32 v12, 12, v9
    v_xor_b32 v12, v12, v10
    v_lshl_add_u32 v22, v12, 4, v11
    v_add_u32 v12, 14, v9
    v_xor_b32 v12, v12, v10
    v_lshl_add_u32 v23, v12, 4, v11
    v_lshrrev_b32 v12, 4, v1
    v_and_b32 v12, 1, v12
    v_lshrrev_b32 v13, 2, v1
    v_and_b32 v13, 3, v13
    v_and_b32 v14, 3, v1
    v_lshlrev_b32 v15, 2, v9
    v_add_u32 v15, v15, v13
    v_lshlrev_b32 v15, 8, v15
    v_lshl_add_u32 v15, v12, 5, v15
    v_lshl_add_u32 v15, v14, 3, v15
    v_xor_b32 v12, 0, v13
    v_lshl_add_u32 v24, v12, 6, v15
    v_add_u32 v24, 65536, v24
    v_xor_b32 v12, 1, v13
    v_lshl_add_u32 v25, v12, 6, v15
    v_add_u32 v25, 65536, v25
    v_xor_b32 v12, 2, v13
    v_lshl_add_u32 v26, v12, 6, v15
    v_add_u32 v26, 65536, v26
    v_xor_b32 v12, 3, v13
    v_lshl_add_u32 v27, v12, 6, v15
    v_add_u32 v27, 65536, v27
    v_lshlrev_b32 v12, 10, v9
    v_add_u32 v240, v12, v24
    v_add_u32 v240, 32768, v240
    v_add_u32 v241, v12, v25
    v_add_u32 v241, 32768, v241
    v_add_u32 v242, v12, v26
    v_add_u32 v242, 32768, v242
    v_add_u32 v243, v12, v27
    v_add_u32 v243, 32768, v243
    s_lshl_b32 s46, s45, 3
    s_lshl_b32 s47, s40, 1
    s_add_u32 s46, s46, s47
    s_lshl_b32 s46, s46, 15
    v_lshlrev_b32 v12, 4, v1
    v_add_u32 v12, s46, v12
    s_lshl_b32 s47, s44, 8
    s_add_u32 m0, s43, 98304
    s_add_u32 s48, s47, 0
    buffer_load_dwordx4 v7, s[20:23], s48 offen lds
    s_add_u32 m0, s43, 99328
    s_add_u32 s48, s47, 32768
    buffer_load_dwordx4 v7, s[20:23], s48 offen lds
    s_add_u32 m0, s43, 100352
    s_add_u32 s48, s47, 65536
    buffer_load_dwordx4 v7, s[20:23], s48 offen lds
    s_add_u32 m0, s43, 101376
    s_add_u32 s48, s47, 98304
    buffer_load_dwordx4 v7, s[20:23], s48 offen lds
    s_mov_b32 s48, 0
    buffer_load_dwordx4 a[0:3], v12, s[24:27], s48 offen offset:0
    buffer_load_dwordx4 a[4:7], v12, s[24:27], s48 offen offset:1024
    buffer_load_dwordx4 a[8:11], v12, s[24:27], s48 offen offset:2048
    buffer_load_dwordx4 a[12:15], v12, s[24:27], s48 offen offset:3072
    s_mov_b32 s48, 32768
    buffer_load_dwordx4 a[16:19], v12, s[24:27], s48 offen offset:0
    buffer_load_dwordx4 a[20:23], v12, s[24:27], s48 offen offset:1024
    buffer_load_dwordx4 a[24:27], v12, s[24:27], s48 offen offset:2048
    buffer_load_dwordx4 a[28:31], v12, s[24:27], s48 offen offset:3072
    s_add_u32 m0, s43, 114688
    s_add_u32 s48, s47, 524288
    buffer_load_dwordx4 v7, s[20:23], s48 offen lds
    s_add_u32 m0, s43, 115712
    s_add_u32 s48, s47, 557056
    buffer_load_dwordx4 v7, s[20:23], s48 offen lds
    s_add_u32 m0, s43, 116736
    s_add_u32 s48, s47, 589824
    buffer_load_dwordx4 v7, s[20:23], s48 offen lds
    s_add_u32 m0, s43, 117760
    s_add_u32 s48, s47, 622592
    buffer_load_dwordx4 v7, s[20:23], s48 offen lds
    s_mov_b32 s48, 4096
    buffer_load_dwordx4 a[32:35], v12, s[24:27], s48 offen offset:0
    buffer_load_dwordx4 a[36:39], v12, s[24:27], s48 offen offset:1024
    buffer_load_dwordx4 a[40:43], v12, s[24:27], s48 offen offset:2048
    buffer_load_dwordx4 a[44:47], v12, s[24:27], s48 offen offset:3072
    s_mov_b32 s48, 36864
    buffer_load_dwordx4 a[48:51], v12, s[24:27], s48 offen offset:0
    buffer_load_dwordx4 a[52:55], v12, s[24:27], s48 offen offset:1024
    buffer_load_dwordx4 a[56:59], v12, s[24:27], s48 offen offset:2048
    buffer_load_dwordx4 a[60:63], v12, s[24:27], s48 offen offset:3072
    s_add_u32 m0, s43, 131072
    s_add_u32 s48, s47, 1048576
    buffer_load_dwordx4 v7, s[20:23], s48 offen lds
    s_add_u32 m0, s43, 132096
    s_add_u32 s48, s47, 1081344
    buffer_load_dwordx4 v7, s[20:23], s48 offen lds
    s_add_u32 m0, s43, 133120
    s_add_u32 s48, s47, 1114112
    buffer_load_dwordx4 v7, s[20:23], s48 offen lds
    s_add_u32 m0, s43, 134144
    s_add_u32 s48, s47, 1146880
    buffer_load_dwordx4 v7, s[20:23], s48 offen lds
    s_mov_b32 s48, 8192
    buffer_load_dwordx4 a[64:67], v12, s[24:27], s48 offen offset:0
    buffer_load_dwordx4 a[68:71], v12, s[24:27], s48 offen offset:1024
    buffer_load_dwordx4 a[72:75], v12, s[24:27], s48 offen offset:2048
    buffer_load_dwordx4 a[76:79], v12, s[24:27], s48 offen offset:3072
    s_mov_b32 s48, 40960
    buffer_load_dwordx4 a[80:83], v12, s[24:27], s48 offen offset:0
    buffer_load_dwordx4 a[84:87], v12, s[24:27], s48 offen offset:1024
    buffer_load_dwordx4 a[88:91], v12, s[24:27], s48 offen offset:2048
    buffer_load_dwordx4 a[92:95], v12, s[24:27], s48 offen offset:3072
    v_mov_b32 v48, 0
    v_mov_b32 v49, 0
    v_mov_b32 v50, 0
    v_mov_b32 v51, 0
    v_mov_b32 v52, 0
    v_mov_b32 v53, 0
    v_mov_b32 v54, 0
    v_mov_b32 v55, 0
    v_mov_b32 v56, 0
    v_mov_b32 v57, 0
    v_mov_b32 v58, 0
    v_mov_b32 v59, 0
    v_mov_b32 v60, 0
    v_mov_b32 v61, 0
    v_mov_b32 v62, 0
    v_mov_b32 v63, 0
    v_mov_b32 v64, 0
    v_mov_b32 v65, 0
    v_mov_b32 v66, 0
    v_mov_b32 v67, 0
    v_mov_b32 v68, 0
    v_mov_b32 v69, 0
    v_mov_b32 v70, 0
    v_mov_b32 v71, 0
    v_mov_b32 v72, 0
    v_mov_b32 v73, 0
    v_mov_b32 v74, 0
    v_mov_b32 v75, 0
    v_mov_b32 v76, 0
    v_mov_b32 v77, 0
    v_mov_b32 v78, 0
    v_mov_b32 v79, 0
    v_mov_b32 v80, 0
    v_mov_b32 v81, 0
    v_mov_b32 v82, 0
    v_mov_b32 v83, 0
    v_mov_b32 v84, 0
    v_mov_b32 v85, 0
    v_mov_b32 v86, 0
    v_mov_b32 v87, 0
    v_mov_b32 v88, 0
    v_mov_b32 v89, 0
    v_mov_b32 v90, 0
    v_mov_b32 v91, 0
    v_mov_b32 v92, 0
    v_mov_b32 v93, 0
    v_mov_b32 v94, 0
    v_mov_b32 v95, 0
    v_mov_b32 v96, 0
    v_mov_b32 v97, 0
    v_mov_b32 v98, 0
    v_mov_b32 v99, 0
    v_mov_b32 v100, 0
    v_mov_b32 v101, 0
    v_mov_b32 v102, 0
    v_mov_b32 v103, 0
    v_mov_b32 v104, 0
    v_mov_b32 v105, 0
    v_mov_b32 v106, 0
    v_mov_b32 v107, 0
    v_mov_b32 v108, 0
    v_mov_b32 v109, 0
    v_mov_b32 v110, 0
    v_mov_b32 v111, 0
    v_mov_b32 v112, 0
    v_mov_b32 v113, 0
    v_mov_b32 v114, 0
    v_mov_b32 v115, 0
    v_mov_b32 v116, 0
    v_mov_b32 v117, 0
    v_mov_b32 v118, 0
    v_mov_b32 v119, 0
    v_mov_b32 v120, 0
    v_mov_b32 v121, 0
    v_mov_b32 v122, 0
    v_mov_b32 v123, 0
    v_mov_b32 v124, 0
    v_mov_b32 v125, 0
    v_mov_b32 v126, 0
    v_mov_b32 v127, 0
    v_mov_b32 v128, 0
    v_mov_b32 v129, 0
    v_mov_b32 v130, 0
    v_mov_b32 v131, 0
    v_mov_b32 v132, 0
    v_mov_b32 v133, 0
    v_mov_b32 v134, 0
    v_mov_b32 v135, 0
    v_mov_b32 v136, 0
    v_mov_b32 v137, 0
    v_mov_b32 v138, 0
    v_mov_b32 v139, 0
    v_mov_b32 v140, 0
    v_mov_b32 v141, 0
    v_mov_b32 v142, 0
    v_mov_b32 v143, 0
    v_mov_b32 v144, 0
    v_mov_b32 v145, 0
    v_mov_b32 v146, 0
    v_mov_b32 v147, 0
    v_mov_b32 v148, 0
    v_mov_b32 v149, 0
    v_mov_b32 v150, 0
    v_mov_b32 v151, 0
    v_mov_b32 v152, 0
    v_mov_b32 v153, 0
    v_mov_b32 v154, 0
    v_mov_b32 v155, 0
    v_mov_b32 v156, 0
    v_mov_b32 v157, 0
    v_mov_b32 v158, 0
    v_mov_b32 v159, 0
    v_mov_b32 v160, 0
    v_mov_b32 v161, 0
    v_mov_b32 v162, 0
    v_mov_b32 v163, 0
    v_mov_b32 v164, 0
    v_mov_b32 v165, 0
    v_mov_b32 v166, 0
    v_mov_b32 v167, 0
    v_mov_b32 v168, 0
    v_mov_b32 v169, 0
    v_mov_b32 v170, 0
    v_mov_b32 v171, 0
    v_mov_b32 v172, 0
    v_mov_b32 v173, 0
    v_mov_b32 v174, 0
    v_mov_b32 v175, 0
    s_waitcnt vmcnt(24)
    s_barrier
    ds_read_b64_tr_b16 a[192:193], v240 offset:0
    ds_read_b64_tr_b16 a[194:195], v240 offset:1024
    ds_read_b64_tr_b16 a[196:197], v241 offset:0
    ds_read_b64_tr_b16 a[198:199], v241 offset:1024
    ds_read_b64_tr_b16 a[200:201], v242 offset:0
    ds_read_b64_tr_b16 a[202:203], v242 offset:1024
    ds_read_b64_tr_b16 a[204:205], v243 offset:0
    ds_read_b64_tr_b16 a[206:207], v243 offset:1024
    ds_read_b64_tr_b16 a[208:209], v240 offset:4096
    ds_read_b64_tr_b16 a[210:211], v240 offset:5120
    s_waitcnt lgkmcnt(8)
    v_mfma_f32_32x32x16_bf16 v[48:63], a[192:195], a[0:3], v[48:63]
    v_mfma_f32_32x32x16_bf16 v[64:79], a[192:195], a[16:19], v[64:79]
    ds_read_b64_tr_b16 a[212:213], v241 offset:4096
    ds_read_b64_tr_b16 a[214:215], v241 offset:5120
    s_waitcnt lgkmcnt(8)
    v_mfma_f32_32x32x16_bf16 v[80:95], a[196:199], a[0:3], v[80:95]
    v_mfma_f32_32x32x16_bf16 v[96:111], a[196:199], a[16:19], v[96:111]
    ds_read_b64_tr_b16 a[216:217], v242 offset:4096
    ds_read_b64_tr_b16 a[218:219], v242 offset:5120
    s_waitcnt lgkmcnt(8)
    v_mfma_f32_32x32x16_bf16 v[112:127], a[200:203], a[0:3], v[112:127]
    v_mfma_f32_32x32x16_bf16 v[128:143], a[200:203], a[16:19], v[128:143]
    ds_read_b64_tr_b16 a[220:221], v243 offset:4096
    ds_read_b64_tr_b16 a[222:223], v243 offset:5120
    s_waitcnt lgkmcnt(8)
    v_mfma_f32_32x32x16_bf16 v[144:159], a[204:207], a[0:3], v[144:159]
    v_mfma_f32_32x32x16_bf16 v[160:175], a[204:207], a[16:19], v[160:175]
    ds_read_b64_tr_b16 a[224:225], v240 offset:8192
    ds_read_b64_tr_b16 a[226:227], v240 offset:9216
    s_waitcnt lgkmcnt(8)
    v_mfma_f32_32x32x16_bf16 v[48:63], a[208:211], a[4:7], v[48:63]
    v_mfma_f32_32x32x16_bf16 v[64:79], a[208:211], a[20:23], v[64:79]
    ds_read_b64_tr_b16 a[228:229], v241 offset:8192
    ds_read_b64_tr_b16 a[230:231], v241 offset:9216
    s_waitcnt lgkmcnt(8)
    v_mfma_f32_32x32x16_bf16 v[80:95], a[212:215], a[4:7], v[80:95]
    v_mfma_f32_32x32x16_bf16 v[96:111], a[212:215], a[20:23], v[96:111]
    ds_read_b64_tr_b16 a[232:233], v242 offset:8192
    ds_read_b64_tr_b16 a[234:235], v242 offset:9216
    s_waitcnt lgkmcnt(8)
    v_mfma_f32_32x32x16_bf16 v[112:127], a[216:219], a[4:7], v[112:127]
    v_mfma_f32_32x32x16_bf16 v[128:143], a[216:219], a[20:23], v[128:143]
    ds_read_b64_tr_b16 a[236:237], v243 offset:8192
    ds_read_b64_tr_b16 a[238:239], v243 offset:9216
    s_waitcnt lgkmcnt(8)
    v_mfma_f32_32x32x16_bf16 v[144:159], a[220:223], a[4:7], v[144:159]
    v_mfma_f32_32x32x16_bf16 v[160:175], a[220:223], a[20:23], v[160:175]
    s_waitcnt vmcnt(12)
    s_barrier
    s_add_u32 m0, s43, 147456
    s_add_u32 s48, s47, 1572864
    buffer_load_dwordx4 v7, s[20:23], s48 offen lds
    s_add_u32 m0, s43, 148480
    s_add_u32 s48, s47, 1605632
    buffer_load_dwordx4 v7, s[20:23], s48 offen lds
    s_add_u32 m0, s43, 149504
    s_add_u32 s48, s47, 1638400
    buffer_load_dwordx4 v7, s[20:23], s48 offen lds
    s_add_u32 m0, s43, 150528
    s_add_u32 s48, s47, 1671168
    buffer_load_dwordx4 v7, s[20:23], s48 offen lds
    s_mov_b32 s48, 12288
    buffer_load_dwordx4 a[96:99], v12, s[24:27], s48 offen offset:0
    buffer_load_dwordx4 a[100:103], v12, s[24:27], s48 offen offset:1024
    buffer_load_dwordx4 a[104:107], v12, s[24:27], s48 offen offset:2048
    buffer_load_dwordx4 a[108:111], v12, s[24:27], s48 offen offset:3072
    s_mov_b32 s48, 45056
    buffer_load_dwordx4 a[112:115], v12, s[24:27], s48 offen offset:0
    buffer_load_dwordx4 a[116:119], v12, s[24:27], s48 offen offset:1024
    buffer_load_dwordx4 a[120:123], v12, s[24:27], s48 offen offset:2048
    buffer_load_dwordx4 a[124:127], v12, s[24:27], s48 offen offset:3072
    ds_read_b64_tr_b16 a[240:241], v240 offset:12288
    ds_read_b64_tr_b16 a[242:243], v240 offset:13312
    s_waitcnt lgkmcnt(8)
    v_mfma_f32_32x32x16_bf16 v[48:63], a[224:227], a[8:11], v[48:63]
    v_mfma_f32_32x32x16_bf16 v[64:79], a[224:227], a[24:27], v[64:79]
    ds_read_b64_tr_b16 a[244:245], v241 offset:12288
    ds_read_b64_tr_b16 a[246:247], v241 offset:13312
    s_waitcnt lgkmcnt(8)
    v_mfma_f32_32x32x16_bf16 v[80:95], a[228:231], a[8:11], v[80:95]
    v_mfma_f32_32x32x16_bf16 v[96:111], a[228:231], a[24:27], v[96:111]
    ds_read_b64_tr_b16 a[248:249], v242 offset:12288
    ds_read_b64_tr_b16 a[250:251], v242 offset:13312
    s_waitcnt lgkmcnt(8)
    v_mfma_f32_32x32x16_bf16 v[112:127], a[232:235], a[8:11], v[112:127]
    v_mfma_f32_32x32x16_bf16 v[128:143], a[232:235], a[24:27], v[128:143]
    ds_read_b64_tr_b16 a[252:253], v243 offset:12288
    ds_read_b64_tr_b16 a[254:255], v243 offset:13312
    s_waitcnt lgkmcnt(8)
    v_mfma_f32_32x32x16_bf16 v[144:159], a[236:239], a[8:11], v[144:159]
    v_mfma_f32_32x32x16_bf16 v[160:175], a[236:239], a[24:27], v[160:175]
    ds_read_b64_tr_b16 a[192:193], v240 offset:16384
    ds_read_b64_tr_b16 a[194:195], v240 offset:17408
    s_waitcnt lgkmcnt(8)
    v_mfma_f32_32x32x16_bf16 v[48:63], a[240:243], a[12:15], v[48:63]
    v_mfma_f32_32x32x16_bf16 v[64:79], a[240:243], a[28:31], v[64:79]
    ds_read_b64_tr_b16 a[196:197], v241 offset:16384
    ds_read_b64_tr_b16 a[198:199], v241 offset:17408
    s_waitcnt lgkmcnt(8)
    v_mfma_f32_32x32x16_bf16 v[80:95], a[244:247], a[12:15], v[80:95]
    v_mfma_f32_32x32x16_bf16 v[96:111], a[244:247], a[28:31], v[96:111]
    ds_read_b64_tr_b16 a[200:201], v242 offset:16384
    ds_read_b64_tr_b16 a[202:203], v242 offset:17408
    s_waitcnt lgkmcnt(8)
    v_mfma_f32_32x32x16_bf16 v[112:127], a[248:251], a[12:15], v[112:127]
    v_mfma_f32_32x32x16_bf16 v[128:143], a[248:251], a[28:31], v[128:143]
    ds_read_b64_tr_b16 a[204:205], v243 offset:16384
    ds_read_b64_tr_b16 a[206:207], v243 offset:17408
    s_waitcnt lgkmcnt(8)
    v_mfma_f32_32x32x16_bf16 v[144:159], a[252:255], a[12:15], v[144:159]
    v_mfma_f32_32x32x16_bf16 v[160:175], a[252:255], a[28:31], v[160:175]
    ds_read_b64_tr_b16 a[208:209], v240 offset:20480
    ds_read_b64_tr_b16 a[210:211], v240 offset:21504
    s_waitcnt lgkmcnt(8)
    v_mfma_f32_32x32x16_bf16 v[48:63], a[192:195], a[32:35], v[48:63]
    v_mfma_f32_32x32x16_bf16 v[64:79], a[192:195], a[48:51], v[64:79]
    ds_read_b64_tr_b16 a[212:213], v241 offset:20480
    ds_read_b64_tr_b16 a[214:215], v241 offset:21504
    s_waitcnt lgkmcnt(8)
    v_mfma_f32_32x32x16_bf16 v[80:95], a[196:199], a[32:35], v[80:95]
    v_mfma_f32_32x32x16_bf16 v[96:111], a[196:199], a[48:51], v[96:111]
    ds_read_b64_tr_b16 a[216:217], v242 offset:20480
    ds_read_b64_tr_b16 a[218:219], v242 offset:21504
    s_waitcnt lgkmcnt(8)
    v_mfma_f32_32x32x16_bf16 v[112:127], a[200:203], a[32:35], v[112:127]
    v_mfma_f32_32x32x16_bf16 v[128:143], a[200:203], a[48:51], v[128:143]
    ds_read_b64_tr_b16 a[220:221], v243 offset:20480
    ds_read_b64_tr_b16 a[222:223], v243 offset:21504
    s_waitcnt lgkmcnt(8)
    v_mfma_f32_32x32x16_bf16 v[144:159], a[204:207], a[32:35], v[144:159]
    v_mfma_f32_32x32x16_bf16 v[160:175], a[204:207], a[48:51], v[160:175]
    ds_read_b64_tr_b16 a[224:225], v240 offset:24576
    ds_read_b64_tr_b16 a[226:227], v240 offset:25600
    s_waitcnt lgkmcnt(8)
    v_mfma_f32_32x32x16_bf16 v[48:63], a[208:211], a[36:39], v[48:63]
    v_mfma_f32_32x32x16_bf16 v[64:79], a[208:211], a[52:55], v[64:79]
    ds_read_b64_tr_b16 a[228:229], v241 offset:24576
    ds_read_b64_tr_b16 a[230:231], v241 offset:25600
    s_waitcnt lgkmcnt(8)
    v_mfma_f32_32x32x16_bf16 v[80:95], a[212:215], a[36:39], v[80:95]
    v_mfma_f32_32x32x16_bf16 v[96:111], a[212:215], a[52:55], v[96:111]
    ds_read_b64_tr_b16 a[232:233], v242 offset:24576
    ds_read_b64_tr_b16 a[234:235], v242 offset:25600
    s_waitcnt lgkmcnt(8)
    v_mfma_f32_32x32x16_bf16 v[112:127], a[216:219], a[36:39], v[112:127]
    v_mfma_f32_32x32x16_bf16 v[128:143], a[216:219], a[52:55], v[128:143]
    ds_read_b64_tr_b16 a[236:237], v243 offset:24576
    ds_read_b64_tr_b16 a[238:239], v243 offset:25600
    s_waitcnt lgkmcnt(8)
    v_mfma_f32_32x32x16_bf16 v[144:159], a[220:223], a[36:39], v[144:159]
    v_mfma_f32_32x32x16_bf16 v[160:175], a[220:223], a[52:55], v[160:175]
    s_waitcnt vmcnt(12)
    s_barrier
    s_add_u32 m0, s43, 98304
    s_add_u32 s48, s47, 2097152
    buffer_load_dwordx4 v7, s[20:23], s48 offen lds
    s_add_u32 m0, s43, 99328
    s_add_u32 s48, s47, 2129920
    buffer_load_dwordx4 v7, s[20:23], s48 offen lds
    s_add_u32 m0, s43, 100352
    s_add_u32 s48, s47, 2162688
    buffer_load_dwordx4 v7, s[20:23], s48 offen lds
    s_add_u32 m0, s43, 101376
    s_add_u32 s48, s47, 2195456
    buffer_load_dwordx4 v7, s[20:23], s48 offen lds
    s_mov_b32 s48, 16384
    buffer_load_dwordx4 a[0:3], v12, s[24:27], s48 offen offset:0
    buffer_load_dwordx4 a[4:7], v12, s[24:27], s48 offen offset:1024
    buffer_load_dwordx4 a[8:11], v12, s[24:27], s48 offen offset:2048
    buffer_load_dwordx4 a[12:15], v12, s[24:27], s48 offen offset:3072
    s_mov_b32 s48, 49152
    buffer_load_dwordx4 a[16:19], v12, s[24:27], s48 offen offset:0
    buffer_load_dwordx4 a[20:23], v12, s[24:27], s48 offen offset:1024
    buffer_load_dwordx4 a[24:27], v12, s[24:27], s48 offen offset:2048
    buffer_load_dwordx4 a[28:31], v12, s[24:27], s48 offen offset:3072
    ds_read_b64_tr_b16 a[240:241], v240 offset:28672
    ds_read_b64_tr_b16 a[242:243], v240 offset:29696
    s_waitcnt lgkmcnt(8)
    v_mfma_f32_32x32x16_bf16 v[48:63], a[224:227], a[40:43], v[48:63]
    v_mfma_f32_32x32x16_bf16 v[64:79], a[224:227], a[56:59], v[64:79]
    ds_read_b64_tr_b16 a[244:245], v241 offset:28672
    ds_read_b64_tr_b16 a[246:247], v241 offset:29696
    s_waitcnt lgkmcnt(8)
    v_mfma_f32_32x32x16_bf16 v[80:95], a[228:231], a[40:43], v[80:95]
    v_mfma_f32_32x32x16_bf16 v[96:111], a[228:231], a[56:59], v[96:111]
    ds_read_b64_tr_b16 a[248:249], v242 offset:28672
    ds_read_b64_tr_b16 a[250:251], v242 offset:29696
    s_waitcnt lgkmcnt(8)
    v_mfma_f32_32x32x16_bf16 v[112:127], a[232:235], a[40:43], v[112:127]
    v_mfma_f32_32x32x16_bf16 v[128:143], a[232:235], a[56:59], v[128:143]
    ds_read_b64_tr_b16 a[252:253], v243 offset:28672
    ds_read_b64_tr_b16 a[254:255], v243 offset:29696
    s_waitcnt lgkmcnt(8)
    v_mfma_f32_32x32x16_bf16 v[144:159], a[236:239], a[40:43], v[144:159]
    v_mfma_f32_32x32x16_bf16 v[160:175], a[236:239], a[56:59], v[160:175]
    ds_read_b64_tr_b16 a[192:193], v240 offset:32768
    ds_read_b64_tr_b16 a[194:195], v240 offset:33792
    s_waitcnt lgkmcnt(8)
    v_mfma_f32_32x32x16_bf16 v[48:63], a[240:243], a[44:47], v[48:63]
    v_mfma_f32_32x32x16_bf16 v[64:79], a[240:243], a[60:63], v[64:79]
    ds_read_b64_tr_b16 a[196:197], v241 offset:32768
    ds_read_b64_tr_b16 a[198:199], v241 offset:33792
    s_waitcnt lgkmcnt(8)
    v_mfma_f32_32x32x16_bf16 v[80:95], a[244:247], a[44:47], v[80:95]
    v_mfma_f32_32x32x16_bf16 v[96:111], a[244:247], a[60:63], v[96:111]
    ds_read_b64_tr_b16 a[200:201], v242 offset:32768
    ds_read_b64_tr_b16 a[202:203], v242 offset:33792
    s_waitcnt lgkmcnt(8)
    v_mfma_f32_32x32x16_bf16 v[112:127], a[248:251], a[44:47], v[112:127]
    v_mfma_f32_32x32x16_bf16 v[128:143], a[248:251], a[60:63], v[128:143]
    ds_read_b64_tr_b16 a[204:205], v243 offset:32768
    ds_read_b64_tr_b16 a[206:207], v243 offset:33792
    s_waitcnt lgkmcnt(8)
    v_mfma_f32_32x32x16_bf16 v[144:159], a[252:255], a[44:47], v[144:159]
    v_mfma_f32_32x32x16_bf16 v[160:175], a[252:255], a[60:63], v[160:175]
    ds_read_b64_tr_b16 a[208:209], v240 offset:36864
    ds_read_b64_tr_b16 a[210:211], v240 offset:37888
    s_waitcnt lgkmcnt(8)
    v_mfma_f32_32x32x16_bf16 v[48:63], a[192:195], a[64:67], v[48:63]
    v_mfma_f32_32x32x16_bf16 v[64:79], a[192:195], a[80:83], v[64:79]
    ds_read_b64_tr_b16 a[212:213], v241 offset:36864
    ds_read_b64_tr_b16 a[214:215], v241 offset:37888
    s_waitcnt lgkmcnt(8)
    v_mfma_f32_32x32x16_bf16 v[80:95], a[196:199], a[64:67], v[80:95]
    v_mfma_f32_32x32x16_bf16 v[96:111], a[196:199], a[80:83], v[96:111]
    ds_read_b64_tr_b16 a[216:217], v242 offset:36864
    ds_read_b64_tr_b16 a[218:219], v242 offset:37888
    s_waitcnt lgkmcnt(8)
    v_mfma_f32_32x32x16_bf16 v[112:127], a[200:203], a[64:67], v[112:127]
    v_mfma_f32_32x32x16_bf16 v[128:143], a[200:203], a[80:83], v[128:143]
    ds_read_b64_tr_b16 a[220:221], v243 offset:36864
    ds_read_b64_tr_b16 a[222:223], v243 offset:37888
    s_waitcnt lgkmcnt(8)
    v_mfma_f32_32x32x16_bf16 v[144:159], a[204:207], a[64:67], v[144:159]
    v_mfma_f32_32x32x16_bf16 v[160:175], a[204:207], a[80:83], v[160:175]
    ds_read_b64_tr_b16 a[224:225], v240 offset:40960
    ds_read_b64_tr_b16 a[226:227], v240 offset:41984
    s_waitcnt lgkmcnt(8)
    v_mfma_f32_32x32x16_bf16 v[48:63], a[208:211], a[68:71], v[48:63]
    v_mfma_f32_32x32x16_bf16 v[64:79], a[208:211], a[84:87], v[64:79]
    ds_read_b64_tr_b16 a[228:229], v241 offset:40960
    ds_read_b64_tr_b16 a[230:231], v241 offset:41984
    s_waitcnt lgkmcnt(8)
    v_mfma_f32_32x32x16_bf16 v[80:95], a[212:215], a[68:71], v[80:95]
    v_mfma_f32_32x32x16_bf16 v[96:111], a[212:215], a[84:87], v[96:111]
    ds_read_b64_tr_b16 a[232:233], v242 offset:40960
    ds_read_b64_tr_b16 a[234:235], v242 offset:41984
    s_waitcnt lgkmcnt(8)
    v_mfma_f32_32x32x16_bf16 v[112:127], a[216:219], a[68:71], v[112:127]
    v_mfma_f32_32x32x16_bf16 v[128:143], a[216:219], a[84:87], v[128:143]
    ds_read_b64_tr_b16 a[236:237], v243 offset:40960
    ds_read_b64_tr_b16 a[238:239], v243 offset:41984
    s_waitcnt lgkmcnt(8)
    v_mfma_f32_32x32x16_bf16 v[144:159], a[220:223], a[68:71], v[144:159]
    v_mfma_f32_32x32x16_bf16 v[160:175], a[220:223], a[84:87], v[160:175]
    s_waitcnt vmcnt(12)
    s_barrier
    s_add_u32 m0, s43, 114688
    s_add_u32 s48, s47, 2621440
    buffer_load_dwordx4 v7, s[20:23], s48 offen lds
    s_add_u32 m0, s43, 115712
    s_add_u32 s48, s47, 2654208
    buffer_load_dwordx4 v7, s[20:23], s48 offen lds
    s_add_u32 m0, s43, 116736
    s_add_u32 s48, s47, 2686976
    buffer_load_dwordx4 v7, s[20:23], s48 offen lds
    s_add_u32 m0, s43, 117760
    s_add_u32 s48, s47, 2719744
    buffer_load_dwordx4 v7, s[20:23], s48 offen lds
    s_mov_b32 s48, 20480
    buffer_load_dwordx4 a[32:35], v12, s[24:27], s48 offen offset:0
    buffer_load_dwordx4 a[36:39], v12, s[24:27], s48 offen offset:1024
    buffer_load_dwordx4 a[40:43], v12, s[24:27], s48 offen offset:2048
    buffer_load_dwordx4 a[44:47], v12, s[24:27], s48 offen offset:3072
    s_mov_b32 s48, 53248
    buffer_load_dwordx4 a[48:51], v12, s[24:27], s48 offen offset:0
    buffer_load_dwordx4 a[52:55], v12, s[24:27], s48 offen offset:1024
    buffer_load_dwordx4 a[56:59], v12, s[24:27], s48 offen offset:2048
    buffer_load_dwordx4 a[60:63], v12, s[24:27], s48 offen offset:3072
    ds_read_b64_tr_b16 a[240:241], v240 offset:45056
    ds_read_b64_tr_b16 a[242:243], v240 offset:46080
    s_waitcnt lgkmcnt(8)
    v_mfma_f32_32x32x16_bf16 v[48:63], a[224:227], a[72:75], v[48:63]
    v_mfma_f32_32x32x16_bf16 v[64:79], a[224:227], a[88:91], v[64:79]
    ds_read_b64_tr_b16 a[244:245], v241 offset:45056
    ds_read_b64_tr_b16 a[246:247], v241 offset:46080
    s_waitcnt lgkmcnt(8)
    v_mfma_f32_32x32x16_bf16 v[80:95], a[228:231], a[72:75], v[80:95]
    v_mfma_f32_32x32x16_bf16 v[96:111], a[228:231], a[88:91], v[96:111]
    ds_read_b64_tr_b16 a[248:249], v242 offset:45056
    ds_read_b64_tr_b16 a[250:251], v242 offset:46080
    s_waitcnt lgkmcnt(8)
    v_mfma_f32_32x32x16_bf16 v[112:127], a[232:235], a[72:75], v[112:127]
    v_mfma_f32_32x32x16_bf16 v[128:143], a[232:235], a[88:91], v[128:143]
    ds_read_b64_tr_b16 a[252:253], v243 offset:45056
    ds_read_b64_tr_b16 a[254:255], v243 offset:46080
    s_waitcnt lgkmcnt(8)
    v_mfma_f32_32x32x16_bf16 v[144:159], a[236:239], a[72:75], v[144:159]
    v_mfma_f32_32x32x16_bf16 v[160:175], a[236:239], a[88:91], v[160:175]
    ds_read_b64_tr_b16 a[192:193], v240 offset:49152
    ds_read_b64_tr_b16 a[194:195], v240 offset:50176
    s_waitcnt lgkmcnt(8)
    v_mfma_f32_32x32x16_bf16 v[48:63], a[240:243], a[76:79], v[48:63]
    v_mfma_f32_32x32x16_bf16 v[64:79], a[240:243], a[92:95], v[64:79]
    ds_read_b64_tr_b16 a[196:197], v241 offset:49152
    ds_read_b64_tr_b16 a[198:199], v241 offset:50176
    s_waitcnt lgkmcnt(8)
    v_mfma_f32_32x32x16_bf16 v[80:95], a[244:247], a[76:79], v[80:95]
    v_mfma_f32_32x32x16_bf16 v[96:111], a[244:247], a[92:95], v[96:111]
    ds_read_b64_tr_b16 a[200:201], v242 offset:49152
    ds_read_b64_tr_b16 a[202:203], v242 offset:50176
    s_waitcnt lgkmcnt(8)
    v_mfma_f32_32x32x16_bf16 v[112:127], a[248:251], a[76:79], v[112:127]
    v_mfma_f32_32x32x16_bf16 v[128:143], a[248:251], a[92:95], v[128:143]
    ds_read_b64_tr_b16 a[204:205], v243 offset:49152
    ds_read_b64_tr_b16 a[206:207], v243 offset:50176
    s_waitcnt lgkmcnt(8)
    v_mfma_f32_32x32x16_bf16 v[144:159], a[252:255], a[76:79], v[144:159]
    v_mfma_f32_32x32x16_bf16 v[160:175], a[252:255], a[92:95], v[160:175]
    ds_read_b64_tr_b16 a[208:209], v240 offset:53248
    ds_read_b64_tr_b16 a[210:211], v240 offset:54272
    s_waitcnt lgkmcnt(8)
    v_mfma_f32_32x32x16_bf16 v[48:63], a[192:195], a[96:99], v[48:63]
    v_mfma_f32_32x32x16_bf16 v[64:79], a[192:195], a[112:115], v[64:79]
    ds_read_b64_tr_b16 a[212:213], v241 offset:53248
    ds_read_b64_tr_b16 a[214:215], v241 offset:54272
    s_waitcnt lgkmcnt(8)
    v_mfma_f32_32x32x16_bf16 v[80:95], a[196:199], a[96:99], v[80:95]
    v_mfma_f32_32x32x16_bf16 v[96:111], a[196:199], a[112:115], v[96:111]
    ds_read_b64_tr_b16 a[216:217], v242 offset:53248
    ds_read_b64_tr_b16 a[218:219], v242 offset:54272
    s_waitcnt lgkmcnt(8)
    v_mfma_f32_32x32x16_bf16 v[112:127], a[200:203], a[96:99], v[112:127]
    v_mfma_f32_32x32x16_bf16 v[128:143], a[200:203], a[112:115], v[128:143]
    ds_read_b64_tr_b16 a[220:221], v243 offset:53248
    ds_read_b64_tr_b16 a[222:223], v243 offset:54272
    s_waitcnt lgkmcnt(8)
    v_mfma_f32_32x32x16_bf16 v[144:159], a[204:207], a[96:99], v[144:159]
    v_mfma_f32_32x32x16_bf16 v[160:175], a[204:207], a[112:115], v[160:175]
    ds_read_b64_tr_b16 a[224:225], v240 offset:57344
    ds_read_b64_tr_b16 a[226:227], v240 offset:58368
    s_waitcnt lgkmcnt(8)
    v_mfma_f32_32x32x16_bf16 v[48:63], a[208:211], a[100:103], v[48:63]
    v_mfma_f32_32x32x16_bf16 v[64:79], a[208:211], a[116:119], v[64:79]
    ds_read_b64_tr_b16 a[228:229], v241 offset:57344
    ds_read_b64_tr_b16 a[230:231], v241 offset:58368
    s_waitcnt lgkmcnt(8)
    v_mfma_f32_32x32x16_bf16 v[80:95], a[212:215], a[100:103], v[80:95]
    v_mfma_f32_32x32x16_bf16 v[96:111], a[212:215], a[116:119], v[96:111]
    ds_read_b64_tr_b16 a[232:233], v242 offset:57344
    ds_read_b64_tr_b16 a[234:235], v242 offset:58368
    s_waitcnt lgkmcnt(8)
    v_mfma_f32_32x32x16_bf16 v[112:127], a[216:219], a[100:103], v[112:127]
    v_mfma_f32_32x32x16_bf16 v[128:143], a[216:219], a[116:119], v[128:143]
    ds_read_b64_tr_b16 a[236:237], v243 offset:57344
    ds_read_b64_tr_b16 a[238:239], v243 offset:58368
    s_waitcnt lgkmcnt(8)
    v_mfma_f32_32x32x16_bf16 v[144:159], a[220:223], a[100:103], v[144:159]
    v_mfma_f32_32x32x16_bf16 v[160:175], a[220:223], a[116:119], v[160:175]
    s_waitcnt vmcnt(12)
    s_barrier
    s_add_u32 m0, s43, 131072
    s_add_u32 s48, s47, 3145728
    buffer_load_dwordx4 v7, s[20:23], s48 offen lds
    s_add_u32 m0, s43, 132096
    s_add_u32 s48, s47, 3178496
    buffer_load_dwordx4 v7, s[20:23], s48 offen lds
    s_add_u32 m0, s43, 133120
    s_add_u32 s48, s47, 3211264
    buffer_load_dwordx4 v7, s[20:23], s48 offen lds
    s_add_u32 m0, s43, 134144
    s_add_u32 s48, s47, 3244032
    buffer_load_dwordx4 v7, s[20:23], s48 offen lds
    s_mov_b32 s48, 24576
    buffer_load_dwordx4 a[64:67], v12, s[24:27], s48 offen offset:0
    buffer_load_dwordx4 a[68:71], v12, s[24:27], s48 offen offset:1024
    buffer_load_dwordx4 a[72:75], v12, s[24:27], s48 offen offset:2048
    buffer_load_dwordx4 a[76:79], v12, s[24:27], s48 offen offset:3072
    s_mov_b32 s48, 57344
    buffer_load_dwordx4 a[80:83], v12, s[24:27], s48 offen offset:0
    buffer_load_dwordx4 a[84:87], v12, s[24:27], s48 offen offset:1024
    buffer_load_dwordx4 a[88:91], v12, s[24:27], s48 offen offset:2048
    buffer_load_dwordx4 a[92:95], v12, s[24:27], s48 offen offset:3072
    ds_read_b64_tr_b16 a[240:241], v240 offset:61440
    ds_read_b64_tr_b16 a[242:243], v240 offset:62464
    s_waitcnt lgkmcnt(8)
    v_mfma_f32_32x32x16_bf16 v[48:63], a[224:227], a[104:107], v[48:63]
    v_mfma_f32_32x32x16_bf16 v[64:79], a[224:227], a[120:123], v[64:79]
    ds_read_b64_tr_b16 a[244:245], v241 offset:61440
    ds_read_b64_tr_b16 a[246:247], v241 offset:62464
    s_waitcnt lgkmcnt(8)
    v_mfma_f32_32x32x16_bf16 v[80:95], a[228:231], a[104:107], v[80:95]
    v_mfma_f32_32x32x16_bf16 v[96:111], a[228:231], a[120:123], v[96:111]
    ds_read_b64_tr_b16 a[248:249], v242 offset:61440
    ds_read_b64_tr_b16 a[250:251], v242 offset:62464
    s_waitcnt lgkmcnt(8)
    v_mfma_f32_32x32x16_bf16 v[112:127], a[232:235], a[104:107], v[112:127]
    v_mfma_f32_32x32x16_bf16 v[128:143], a[232:235], a[120:123], v[128:143]
    ds_read_b64_tr_b16 a[252:253], v243 offset:61440
    ds_read_b64_tr_b16 a[254:255], v243 offset:62464
    s_waitcnt lgkmcnt(8)
    v_mfma_f32_32x32x16_bf16 v[144:159], a[236:239], a[104:107], v[144:159]
    v_mfma_f32_32x32x16_bf16 v[160:175], a[236:239], a[120:123], v[160:175]
    ds_read_b64_tr_b16 a[192:193], v240 offset:0
    ds_read_b64_tr_b16 a[194:195], v240 offset:1024
    s_waitcnt lgkmcnt(8)
    v_mfma_f32_32x32x16_bf16 v[48:63], a[240:243], a[108:111], v[48:63]
    v_mfma_f32_32x32x16_bf16 v[64:79], a[240:243], a[124:127], v[64:79]
    ds_read_b64_tr_b16 a[196:197], v241 offset:0
    ds_read_b64_tr_b16 a[198:199], v241 offset:1024
    s_waitcnt lgkmcnt(8)
    v_mfma_f32_32x32x16_bf16 v[80:95], a[244:247], a[108:111], v[80:95]
    v_mfma_f32_32x32x16_bf16 v[96:111], a[244:247], a[124:127], v[96:111]
    ds_read_b64_tr_b16 a[200:201], v242 offset:0
    ds_read_b64_tr_b16 a[202:203], v242 offset:1024
    s_waitcnt lgkmcnt(8)
    v_mfma_f32_32x32x16_bf16 v[112:127], a[248:251], a[108:111], v[112:127]
    v_mfma_f32_32x32x16_bf16 v[128:143], a[248:251], a[124:127], v[128:143]
    ds_read_b64_tr_b16 a[204:205], v243 offset:0
    ds_read_b64_tr_b16 a[206:207], v243 offset:1024
    s_waitcnt lgkmcnt(8)
    v_mfma_f32_32x32x16_bf16 v[144:159], a[252:255], a[108:111], v[144:159]
    v_mfma_f32_32x32x16_bf16 v[160:175], a[252:255], a[124:127], v[160:175]
    ds_read_b64_tr_b16 a[208:209], v240 offset:4096
    ds_read_b64_tr_b16 a[210:211], v240 offset:5120
    s_waitcnt lgkmcnt(8)
    v_mfma_f32_32x32x16_bf16 v[48:63], a[192:195], a[0:3], v[48:63]
    v_mfma_f32_32x32x16_bf16 v[64:79], a[192:195], a[16:19], v[64:79]
    ds_read_b64_tr_b16 a[212:213], v241 offset:4096
    ds_read_b64_tr_b16 a[214:215], v241 offset:5120
    s_waitcnt lgkmcnt(8)
    v_mfma_f32_32x32x16_bf16 v[80:95], a[196:199], a[0:3], v[80:95]
    v_mfma_f32_32x32x16_bf16 v[96:111], a[196:199], a[16:19], v[96:111]
    ds_read_b64_tr_b16 a[216:217], v242 offset:4096
    ds_read_b64_tr_b16 a[218:219], v242 offset:5120
    s_waitcnt lgkmcnt(8)
    v_mfma_f32_32x32x16_bf16 v[112:127], a[200:203], a[0:3], v[112:127]
    v_mfma_f32_32x32x16_bf16 v[128:143], a[200:203], a[16:19], v[128:143]
    ds_read_b64_tr_b16 a[220:221], v243 offset:4096
    ds_read_b64_tr_b16 a[222:223], v243 offset:5120
    s_waitcnt lgkmcnt(8)
    v_mfma_f32_32x32x16_bf16 v[144:159], a[204:207], a[0:3], v[144:159]
    v_mfma_f32_32x32x16_bf16 v[160:175], a[204:207], a[16:19], v[160:175]
    ds_read_b64_tr_b16 a[224:225], v240 offset:8192
    ds_read_b64_tr_b16 a[226:227], v240 offset:9216
    s_waitcnt lgkmcnt(8)
    v_mfma_f32_32x32x16_bf16 v[48:63], a[208:211], a[4:7], v[48:63]
    v_mfma_f32_32x32x16_bf16 v[64:79], a[208:211], a[20:23], v[64:79]
    ds_read_b64_tr_b16 a[228:229], v241 offset:8192
    ds_read_b64_tr_b16 a[230:231], v241 offset:9216
    s_waitcnt lgkmcnt(8)
    v_mfma_f32_32x32x16_bf16 v[80:95], a[212:215], a[4:7], v[80:95]
    v_mfma_f32_32x32x16_bf16 v[96:111], a[212:215], a[20:23], v[96:111]
    ds_read_b64_tr_b16 a[232:233], v242 offset:8192
    ds_read_b64_tr_b16 a[234:235], v242 offset:9216
    s_waitcnt lgkmcnt(8)
    v_mfma_f32_32x32x16_bf16 v[112:127], a[216:219], a[4:7], v[112:127]
    v_mfma_f32_32x32x16_bf16 v[128:143], a[216:219], a[20:23], v[128:143]
    ds_read_b64_tr_b16 a[236:237], v243 offset:8192
    ds_read_b64_tr_b16 a[238:239], v243 offset:9216
    s_waitcnt lgkmcnt(8)
    v_mfma_f32_32x32x16_bf16 v[144:159], a[220:223], a[4:7], v[144:159]
    v_mfma_f32_32x32x16_bf16 v[160:175], a[220:223], a[20:23], v[160:175]
    s_waitcnt vmcnt(12)
    s_barrier
    s_add_u32 m0, s43, 147456
    s_add_u32 s48, s47, 3670016
    buffer_load_dwordx4 v7, s[20:23], s48 offen lds
    s_add_u32 m0, s43, 148480
    s_add_u32 s48, s47, 3702784
    buffer_load_dwordx4 v7, s[20:23], s48 offen lds
    s_add_u32 m0, s43, 149504
    s_add_u32 s48, s47, 3735552
    buffer_load_dwordx4 v7, s[20:23], s48 offen lds
    s_add_u32 m0, s43, 150528
    s_add_u32 s48, s47, 3768320
    buffer_load_dwordx4 v7, s[20:23], s48 offen lds
    s_mov_b32 s48, 28672
    buffer_load_dwordx4 a[96:99], v12, s[24:27], s48 offen offset:0
    buffer_load_dwordx4 a[100:103], v12, s[24:27], s48 offen offset:1024
    buffer_load_dwordx4 a[104:107], v12, s[24:27], s48 offen offset:2048
    buffer_load_dwordx4 a[108:111], v12, s[24:27], s48 offen offset:3072
    s_mov_b32 s48, 61440
    buffer_load_dwordx4 a[112:115], v12, s[24:27], s48 offen offset:0
    buffer_load_dwordx4 a[116:119], v12, s[24:27], s48 offen offset:1024
    buffer_load_dwordx4 a[120:123], v12, s[24:27], s48 offen offset:2048
    buffer_load_dwordx4 a[124:127], v12, s[24:27], s48 offen offset:3072
    ds_read_b64_tr_b16 a[240:241], v240 offset:12288
    ds_read_b64_tr_b16 a[242:243], v240 offset:13312
    s_waitcnt lgkmcnt(8)
    v_mfma_f32_32x32x16_bf16 v[48:63], a[224:227], a[8:11], v[48:63]
    v_mfma_f32_32x32x16_bf16 v[64:79], a[224:227], a[24:27], v[64:79]
    ds_read_b64_tr_b16 a[244:245], v241 offset:12288
    ds_read_b64_tr_b16 a[246:247], v241 offset:13312
    s_waitcnt lgkmcnt(8)
    v_mfma_f32_32x32x16_bf16 v[80:95], a[228:231], a[8:11], v[80:95]
    v_mfma_f32_32x32x16_bf16 v[96:111], a[228:231], a[24:27], v[96:111]
    ds_read_b64_tr_b16 a[248:249], v242 offset:12288
    ds_read_b64_tr_b16 a[250:251], v242 offset:13312
    s_waitcnt lgkmcnt(8)
    v_mfma_f32_32x32x16_bf16 v[112:127], a[232:235], a[8:11], v[112:127]
    v_mfma_f32_32x32x16_bf16 v[128:143], a[232:235], a[24:27], v[128:143]
    ds_read_b64_tr_b16 a[252:253], v243 offset:12288
    ds_read_b64_tr_b16 a[254:255], v243 offset:13312
    s_waitcnt lgkmcnt(8)
    v_mfma_f32_32x32x16_bf16 v[144:159], a[236:239], a[8:11], v[144:159]
    v_mfma_f32_32x32x16_bf16 v[160:175], a[236:239], a[24:27], v[160:175]
    ds_read_b64_tr_b16 a[192:193], v240 offset:16384
    ds_read_b64_tr_b16 a[194:195], v240 offset:17408
    s_waitcnt lgkmcnt(8)
    v_mfma_f32_32x32x16_bf16 v[48:63], a[240:243], a[12:15], v[48:63]
    v_mfma_f32_32x32x16_bf16 v[64:79], a[240:243], a[28:31], v[64:79]
    ds_read_b64_tr_b16 a[196:197], v241 offset:16384
    ds_read_b64_tr_b16 a[198:199], v241 offset:17408
    s_waitcnt lgkmcnt(8)
    v_mfma_f32_32x32x16_bf16 v[80:95], a[244:247], a[12:15], v[80:95]
    v_mfma_f32_32x32x16_bf16 v[96:111], a[244:247], a[28:31], v[96:111]
    ds_read_b64_tr_b16 a[200:201], v242 offset:16384
    ds_read_b64_tr_b16 a[202:203], v242 offset:17408
    s_waitcnt lgkmcnt(8)
    v_mfma_f32_32x32x16_bf16 v[112:127], a[248:251], a[12:15], v[112:127]
    v_mfma_f32_32x32x16_bf16 v[128:143], a[248:251], a[28:31], v[128:143]
    ds_read_b64_tr_b16 a[204:205], v243 offset:16384
    ds_read_b64_tr_b16 a[206:207], v243 offset:17408
    s_waitcnt lgkmcnt(8)
    v_mfma_f32_32x32x16_bf16 v[144:159], a[252:255], a[12:15], v[144:159]
    v_mfma_f32_32x32x16_bf16 v[160:175], a[252:255], a[28:31], v[160:175]
    ds_read_b64_tr_b16 a[208:209], v240 offset:20480
    ds_read_b64_tr_b16 a[210:211], v240 offset:21504
    s_waitcnt lgkmcnt(8)
    v_mfma_f32_32x32x16_bf16 v[48:63], a[192:195], a[32:35], v[48:63]
    v_mfma_f32_32x32x16_bf16 v[64:79], a[192:195], a[48:51], v[64:79]
    ds_read_b64_tr_b16 a[212:213], v241 offset:20480
    ds_read_b64_tr_b16 a[214:215], v241 offset:21504
    s_waitcnt lgkmcnt(8)
    v_mfma_f32_32x32x16_bf16 v[80:95], a[196:199], a[32:35], v[80:95]
    v_mfma_f32_32x32x16_bf16 v[96:111], a[196:199], a[48:51], v[96:111]
    ds_read_b64_tr_b16 a[216:217], v242 offset:20480
    ds_read_b64_tr_b16 a[218:219], v242 offset:21504
    s_waitcnt lgkmcnt(8)
    v_mfma_f32_32x32x16_bf16 v[112:127], a[200:203], a[32:35], v[112:127]
    v_mfma_f32_32x32x16_bf16 v[128:143], a[200:203], a[48:51], v[128:143]
    ds_read_b64_tr_b16 a[220:221], v243 offset:20480
    ds_read_b64_tr_b16 a[222:223], v243 offset:21504
    s_waitcnt lgkmcnt(8)
    v_mfma_f32_32x32x16_bf16 v[144:159], a[204:207], a[32:35], v[144:159]
    v_mfma_f32_32x32x16_bf16 v[160:175], a[204:207], a[48:51], v[160:175]
    ds_read_b64_tr_b16 a[224:225], v240 offset:24576
    ds_read_b64_tr_b16 a[226:227], v240 offset:25600
    s_waitcnt lgkmcnt(8)
    v_mfma_f32_32x32x16_bf16 v[48:63], a[208:211], a[36:39], v[48:63]
    v_mfma_f32_32x32x16_bf16 v[64:79], a[208:211], a[52:55], v[64:79]
    ds_read_b64_tr_b16 a[228:229], v241 offset:24576
    ds_read_b64_tr_b16 a[230:231], v241 offset:25600
    s_waitcnt lgkmcnt(8)
    v_mfma_f32_32x32x16_bf16 v[80:95], a[212:215], a[36:39], v[80:95]
    v_mfma_f32_32x32x16_bf16 v[96:111], a[212:215], a[52:55], v[96:111]
    ds_read_b64_tr_b16 a[232:233], v242 offset:24576
    ds_read_b64_tr_b16 a[234:235], v242 offset:25600
    s_waitcnt lgkmcnt(8)
    v_mfma_f32_32x32x16_bf16 v[112:127], a[216:219], a[36:39], v[112:127]
    v_mfma_f32_32x32x16_bf16 v[128:143], a[216:219], a[52:55], v[128:143]
    ds_read_b64_tr_b16 a[236:237], v243 offset:24576
    ds_read_b64_tr_b16 a[238:239], v243 offset:25600
    s_waitcnt lgkmcnt(8)
    v_mfma_f32_32x32x16_bf16 v[144:159], a[220:223], a[36:39], v[144:159]
    v_mfma_f32_32x32x16_bf16 v[160:175], a[220:223], a[52:55], v[160:175]
    s_waitcnt vmcnt(12)
    s_barrier
    s_mov_b32 s50, 0
    s_add_u32 m0, s43, 0
    s_nop 0
    buffer_load_dwordx4 v28, s[12:15], s50 offen offset:0 lds
    buffer_load_dwordx4 v29, s[12:15], s50 offen offset:1024 lds
    buffer_load_dwordx4 v30, s[12:15], s50 offen offset:2048 lds
    buffer_load_dwordx4 v31, s[12:15], s50 offen offset:3072 lds
    s_mov_b32 s50, 16384
    s_add_u32 m0, s43, 16384
    s_nop 0
    buffer_load_dwordx4 v28, s[12:15], s50 offen offset:0 lds
    buffer_load_dwordx4 v29, s[12:15], s50 offen offset:1024 lds
    buffer_load_dwordx4 v30, s[12:15], s50 offen offset:2048 lds
    buffer_load_dwordx4 v31, s[12:15], s50 offen offset:3072 lds
    s_mov_b32 s50, 32768
    s_add_u32 m0, s43, 32768
    s_nop 0
    buffer_load_dwordx4 v28, s[12:15], s50 offen offset:0 lds
    buffer_load_dwordx4 v29, s[12:15], s50 offen offset:1024 lds
    buffer_load_dwordx4 v30, s[12:15], s50 offen offset:2048 lds
    buffer_load_dwordx4 v31, s[12:15], s50 offen offset:3072 lds
    ds_read_b64_tr_b16 a[240:241], v240 offset:28672
    ds_read_b64_tr_b16 a[242:243], v240 offset:29696
    s_waitcnt lgkmcnt(8)
    v_mfma_f32_32x32x16_bf16 v[48:63], a[224:227], a[40:43], v[48:63]
    v_mfma_f32_32x32x16_bf16 v[64:79], a[224:227], a[56:59], v[64:79]
    ds_read_b64_tr_b16 a[244:245], v241 offset:28672
    ds_read_b64_tr_b16 a[246:247], v241 offset:29696
    s_waitcnt lgkmcnt(8)
    v_mfma_f32_32x32x16_bf16 v[80:95], a[228:231], a[40:43], v[80:95]
    v_mfma_f32_32x32x16_bf16 v[96:111], a[228:231], a[56:59], v[96:111]
    ds_read_b64_tr_b16 a[248:249], v242 offset:28672
    ds_read_b64_tr_b16 a[250:251], v242 offset:29696
    s_waitcnt lgkmcnt(8)
    v_mfma_f32_32x32x16_bf16 v[112:127], a[232:235], a[40:43], v[112:127]
    v_mfma_f32_32x32x16_bf16 v[128:143], a[232:235], a[56:59], v[128:143]
    ds_read_b64_tr_b16 a[252:253], v243 offset:28672
    ds_read_b64_tr_b16 a[254:255], v243 offset:29696
    s_waitcnt lgkmcnt(8)
    v_mfma_f32_32x32x16_bf16 v[144:159], a[236:239], a[40:43], v[144:159]
    v_mfma_f32_32x32x16_bf16 v[160:175], a[236:239], a[56:59], v[160:175]
    ds_read_b64_tr_b16 a[192:193], v240 offset:32768
    ds_read_b64_tr_b16 a[194:195], v240 offset:33792
    s_waitcnt lgkmcnt(8)
    v_mfma_f32_32x32x16_bf16 v[48:63], a[240:243], a[44:47], v[48:63]
    v_mfma_f32_32x32x16_bf16 v[64:79], a[240:243], a[60:63], v[64:79]
    ds_read_b64_tr_b16 a[196:197], v241 offset:32768
    ds_read_b64_tr_b16 a[198:199], v241 offset:33792
    s_waitcnt lgkmcnt(8)
    v_mfma_f32_32x32x16_bf16 v[80:95], a[244:247], a[44:47], v[80:95]
    v_mfma_f32_32x32x16_bf16 v[96:111], a[244:247], a[60:63], v[96:111]
    ds_read_b64_tr_b16 a[200:201], v242 offset:32768
    ds_read_b64_tr_b16 a[202:203], v242 offset:33792
    s_waitcnt lgkmcnt(8)
    v_mfma_f32_32x32x16_bf16 v[112:127], a[248:251], a[44:47], v[112:127]
    v_mfma_f32_32x32x16_bf16 v[128:143], a[248:251], a[60:63], v[128:143]
    ds_read_b64_tr_b16 a[204:205], v243 offset:32768
    ds_read_b64_tr_b16 a[206:207], v243 offset:33792
    s_waitcnt lgkmcnt(8)
    v_mfma_f32_32x32x16_bf16 v[144:159], a[252:255], a[44:47], v[144:159]
    v_mfma_f32_32x32x16_bf16 v[160:175], a[252:255], a[60:63], v[160:175]
    ds_read_b64_tr_b16 a[208:209], v240 offset:36864
    ds_read_b64_tr_b16 a[210:211], v240 offset:37888
    s_waitcnt lgkmcnt(8)
    v_mfma_f32_32x32x16_bf16 v[48:63], a[192:195], a[64:67], v[48:63]
    v_mfma_f32_32x32x16_bf16 v[64:79], a[192:195], a[80:83], v[64:79]
    ds_read_b64_tr_b16 a[212:213], v241 offset:36864
    ds_read_b64_tr_b16 a[214:215], v241 offset:37888
    s_waitcnt lgkmcnt(8)
    v_mfma_f32_32x32x16_bf16 v[80:95], a[196:199], a[64:67], v[80:95]
    v_mfma_f32_32x32x16_bf16 v[96:111], a[196:199], a[80:83], v[96:111]
    ds_read_b64_tr_b16 a[216:217], v242 offset:36864
    ds_read_b64_tr_b16 a[218:219], v242 offset:37888
    s_waitcnt lgkmcnt(8)
    v_mfma_f32_32x32x16_bf16 v[112:127], a[200:203], a[64:67], v[112:127]
    v_mfma_f32_32x32x16_bf16 v[128:143], a[200:203], a[80:83], v[128:143]
    ds_read_b64_tr_b16 a[220:221], v243 offset:36864
    ds_read_b64_tr_b16 a[222:223], v243 offset:37888
    s_waitcnt lgkmcnt(8)
    v_mfma_f32_32x32x16_bf16 v[144:159], a[204:207], a[64:67], v[144:159]
    v_mfma_f32_32x32x16_bf16 v[160:175], a[204:207], a[80:83], v[160:175]
    ds_read_b64_tr_b16 a[224:225], v240 offset:40960
    ds_read_b64_tr_b16 a[226:227], v240 offset:41984
    s_waitcnt lgkmcnt(8)
    v_mfma_f32_32x32x16_bf16 v[48:63], a[208:211], a[68:71], v[48:63]
    v_mfma_f32_32x32x16_bf16 v[64:79], a[208:211], a[84:87], v[64:79]
    ds_read_b64_tr_b16 a[228:229], v241 offset:40960
    ds_read_b64_tr_b16 a[230:231], v241 offset:41984
    s_waitcnt lgkmcnt(8)
    v_mfma_f32_32x32x16_bf16 v[80:95], a[212:215], a[68:71], v[80:95]
    v_mfma_f32_32x32x16_bf16 v[96:111], a[212:215], a[84:87], v[96:111]
    ds_read_b64_tr_b16 a[232:233], v242 offset:40960
    ds_read_b64_tr_b16 a[234:235], v242 offset:41984
    s_waitcnt lgkmcnt(8)
    v_mfma_f32_32x32x16_bf16 v[112:127], a[216:219], a[68:71], v[112:127]
    v_mfma_f32_32x32x16_bf16 v[128:143], a[216:219], a[84:87], v[128:143]
    ds_read_b64_tr_b16 a[236:237], v243 offset:40960
    ds_read_b64_tr_b16 a[238:239], v243 offset:41984
    s_waitcnt lgkmcnt(8)
    v_mfma_f32_32x32x16_bf16 v[144:159], a[220:223], a[68:71], v[144:159]
    v_mfma_f32_32x32x16_bf16 v[160:175], a[220:223], a[84:87], v[160:175]
    s_waitcnt vmcnt(12)
    s_barrier
    s_mov_b32 s51, 0
    s_add_u32 m0, s43, 65536
    s_nop 0
    buffer_load_dwordx4 v32, s[16:19], s51 offen offset:0 lds
    buffer_load_dwordx4 v32, s[16:19], s51 offen offset:1024 lds
    buffer_load_dwordx4 v32, s[16:19], s51 offen offset:2048 lds
    buffer_load_dwordx4 v32, s[16:19], s51 offen offset:3072 lds
    s_mov_b32 s50, 49152
    s_add_u32 m0, s43, 49152
    s_nop 0
    buffer_load_dwordx4 v28, s[12:15], s50 offen offset:0 lds
    buffer_load_dwordx4 v29, s[12:15], s50 offen offset:1024 lds
    buffer_load_dwordx4 v30, s[12:15], s50 offen offset:2048 lds
    buffer_load_dwordx4 v31, s[12:15], s50 offen offset:3072 lds
    s_mov_b32 s51, 16384
    s_add_u32 m0, s43, 81920
    s_nop 0
    buffer_load_dwordx4 v32, s[16:19], s51 offen offset:0 lds
    buffer_load_dwordx4 v32, s[16:19], s51 offen offset:1024 lds
    buffer_load_dwordx4 v32, s[16:19], s51 offen offset:2048 lds
    buffer_load_dwordx4 v32, s[16:19], s51 offen offset:3072 lds
    ds_read_b64_tr_b16 a[240:241], v240 offset:45056
    ds_read_b64_tr_b16 a[242:243], v240 offset:46080
    s_waitcnt lgkmcnt(8)
    v_mfma_f32_32x32x16_bf16 v[48:63], a[224:227], a[72:75], v[48:63]
    v_mfma_f32_32x32x16_bf16 v[64:79], a[224:227], a[88:91], v[64:79]
    ds_read_b64_tr_b16 a[244:245], v241 offset:45056
    ds_read_b64_tr_b16 a[246:247], v241 offset:46080
    s_waitcnt lgkmcnt(8)
    v_mfma_f32_32x32x16_bf16 v[80:95], a[228:231], a[72:75], v[80:95]
    v_mfma_f32_32x32x16_bf16 v[96:111], a[228:231], a[88:91], v[96:111]
    ds_read_b64_tr_b16 a[248:249], v242 offset:45056
    ds_read_b64_tr_b16 a[250:251], v242 offset:46080
    s_waitcnt lgkmcnt(8)
    v_mfma_f32_32x32x16_bf16 v[112:127], a[232:235], a[72:75], v[112:127]
    v_mfma_f32_32x32x16_bf16 v[128:143], a[232:235], a[88:91], v[128:143]
    ds_read_b64_tr_b16 a[252:253], v243 offset:45056
    ds_read_b64_tr_b16 a[254:255], v243 offset:46080
    s_waitcnt lgkmcnt(8)
    v_mfma_f32_32x32x16_bf16 v[144:159], a[236:239], a[72:75], v[144:159]
    v_mfma_f32_32x32x16_bf16 v[160:175], a[236:239], a[88:91], v[160:175]
    ds_read_b64_tr_b16 a[192:193], v240 offset:49152
    ds_read_b64_tr_b16 a[194:195], v240 offset:50176
    s_waitcnt lgkmcnt(8)
    v_mfma_f32_32x32x16_bf16 v[48:63], a[240:243], a[76:79], v[48:63]
    v_mfma_f32_32x32x16_bf16 v[64:79], a[240:243], a[92:95], v[64:79]
    ds_read_b64_tr_b16 a[196:197], v241 offset:49152
    ds_read_b64_tr_b16 a[198:199], v241 offset:50176
    s_waitcnt lgkmcnt(8)
    v_mfma_f32_32x32x16_bf16 v[80:95], a[244:247], a[76:79], v[80:95]
    v_mfma_f32_32x32x16_bf16 v[96:111], a[244:247], a[92:95], v[96:111]
    ds_read_b64_tr_b16 a[200:201], v242 offset:49152
    ds_read_b64_tr_b16 a[202:203], v242 offset:50176
    s_waitcnt lgkmcnt(8)
    v_mfma_f32_32x32x16_bf16 v[112:127], a[248:251], a[76:79], v[112:127]
    v_mfma_f32_32x32x16_bf16 v[128:143], a[248:251], a[92:95], v[128:143]
    ds_read_b64_tr_b16 a[204:205], v243 offset:49152
    ds_read_b64_tr_b16 a[206:207], v243 offset:50176
    s_waitcnt lgkmcnt(8)
    v_mfma_f32_32x32x16_bf16 v[144:159], a[252:255], a[76:79], v[144:159]
    v_mfma_f32_32x32x16_bf16 v[160:175], a[252:255], a[92:95], v[160:175]
    ds_read_b64_tr_b16 a[208:209], v240 offset:53248
    ds_read_b64_tr_b16 a[210:211], v240 offset:54272
    s_waitcnt lgkmcnt(8)
    v_mfma_f32_32x32x16_bf16 v[48:63], a[192:195], a[96:99], v[48:63]
    v_mfma_f32_32x32x16_bf16 v[64:79], a[192:195], a[112:115], v[64:79]
    ds_read_b64_tr_b16 a[212:213], v241 offset:53248
    ds_read_b64_tr_b16 a[214:215], v241 offset:54272
    s_waitcnt lgkmcnt(8)
    v_mfma_f32_32x32x16_bf16 v[80:95], a[196:199], a[96:99], v[80:95]
    v_mfma_f32_32x32x16_bf16 v[96:111], a[196:199], a[112:115], v[96:111]
    ds_read_b64_tr_b16 a[216:217], v242 offset:53248
    ds_read_b64_tr_b16 a[218:219], v242 offset:54272
    s_waitcnt lgkmcnt(8)
    v_mfma_f32_32x32x16_bf16 v[112:127], a[200:203], a[96:99], v[112:127]
    v_mfma_f32_32x32x16_bf16 v[128:143], a[200:203], a[112:115], v[128:143]
    ds_read_b64_tr_b16 a[220:221], v243 offset:53248
    ds_read_b64_tr_b16 a[222:223], v243 offset:54272
    s_waitcnt lgkmcnt(8)
    v_mfma_f32_32x32x16_bf16 v[144:159], a[204:207], a[96:99], v[144:159]
    v_mfma_f32_32x32x16_bf16 v[160:175], a[204:207], a[112:115], v[160:175]
    ds_read_b64_tr_b16 a[224:225], v240 offset:57344
    ds_read_b64_tr_b16 a[226:227], v240 offset:58368
    s_waitcnt lgkmcnt(8)
    v_mfma_f32_32x32x16_bf16 v[48:63], a[208:211], a[100:103], v[48:63]
    v_mfma_f32_32x32x16_bf16 v[64:79], a[208:211], a[116:119], v[64:79]
    ds_read_b64_tr_b16 a[228:229], v241 offset:57344
    ds_read_b64_tr_b16 a[230:231], v241 offset:58368
    s_waitcnt lgkmcnt(8)
    v_mfma_f32_32x32x16_bf16 v[80:95], a[212:215], a[100:103], v[80:95]
    v_mfma_f32_32x32x16_bf16 v[96:111], a[212:215], a[116:119], v[96:111]
    ds_read_b64_tr_b16 a[232:233], v242 offset:57344
    ds_read_b64_tr_b16 a[234:235], v242 offset:58368
    s_waitcnt lgkmcnt(8)
    v_mfma_f32_32x32x16_bf16 v[112:127], a[216:219], a[100:103], v[112:127]
    v_mfma_f32_32x32x16_bf16 v[128:143], a[216:219], a[116:119], v[128:143]
    ds_read_b64_tr_b16 a[236:237], v243 offset:57344
    ds_read_b64_tr_b16 a[238:239], v243 offset:58368
    s_waitcnt lgkmcnt(8)
    v_mfma_f32_32x32x16_bf16 v[144:159], a[220:223], a[100:103], v[144:159]
    v_mfma_f32_32x32x16_bf16 v[160:175], a[220:223], a[116:119], v[160:175]
    ds_read_b64_tr_b16 a[240:241], v240 offset:61440
    ds_read_b64_tr_b16 a[242:243], v240 offset:62464
    s_waitcnt lgkmcnt(8)
    v_mfma_f32_32x32x16_bf16 v[48:63], a[224:227], a[104:107], v[48:63]
    v_mfma_f32_32x32x16_bf16 v[64:79], a[224:227], a[120:123], v[64:79]
    ds_read_b64_tr_b16 a[244:245], v241 offset:61440
    ds_read_b64_tr_b16 a[246:247], v241 offset:62464
    s_waitcnt lgkmcnt(8)
    v_mfma_f32_32x32x16_bf16 v[80:95], a[228:231], a[104:107], v[80:95]
    v_mfma_f32_32x32x16_bf16 v[96:111], a[228:231], a[120:123], v[96:111]
    ds_read_b64_tr_b16 a[248:249], v242 offset:61440
    ds_read_b64_tr_b16 a[250:251], v242 offset:62464
    s_waitcnt lgkmcnt(8)
    v_mfma_f32_32x32x16_bf16 v[112:127], a[232:235], a[104:107], v[112:127]
    v_mfma_f32_32x32x16_bf16 v[128:143], a[232:235], a[120:123], v[128:143]
    ds_read_b64_tr_b16 a[252:253], v243 offset:61440
    ds_read_b64_tr_b16 a[254:255], v243 offset:62464
    s_waitcnt lgkmcnt(8)
    v_mfma_f32_32x32x16_bf16 v[144:159], a[236:239], a[104:107], v[144:159]
    v_mfma_f32_32x32x16_bf16 v[160:175], a[236:239], a[120:123], v[160:175]
    s_waitcnt lgkmcnt(6)
    v_mfma_f32_32x32x16_bf16 v[48:63], a[240:243], a[108:111], v[48:63]
    v_mfma_f32_32x32x16_bf16 v[64:79], a[240:243], a[124:127], v[64:79]
    s_waitcnt lgkmcnt(4)
    v_mfma_f32_32x32x16_bf16 v[80:95], a[244:247], a[108:111], v[80:95]
    v_mfma_f32_32x32x16_bf16 v[96:111], a[244:247], a[124:127], v[96:111]
    s_waitcnt lgkmcnt(2)
    v_mfma_f32_32x32x16_bf16 v[112:127], a[248:251], a[108:111], v[112:127]
    v_mfma_f32_32x32x16_bf16 v[128:143], a[248:251], a[124:127], v[128:143]
    s_waitcnt lgkmcnt(0)
    v_mfma_f32_32x32x16_bf16 v[144:159], a[252:255], a[108:111], v[144:159]
    v_mfma_f32_32x32x16_bf16 v[160:175], a[252:255], a[124:127], v[160:175]
    s_nop 15
    s_nop 7
    s_mov_b32 s46, 0x3e0293ee
    v_mul_f32 v48, s46, v48
    v_mul_f32 v49, s46, v49
    v_mul_f32 v50, s46, v50
    v_mul_f32 v51, s46, v51
    v_mul_f32 v52, s46, v52
    v_mul_f32 v53, s46, v53
    v_mul_f32 v54, s46, v54
    v_mul_f32 v55, s46, v55
    v_cvt_pk_bf16_f32 v248, v48, v49
    v_cvt_pk_bf16_f32 v249, v50, v51
    v_cvt_pk_bf16_f32 v250, v52, v53
    v_cvt_pk_bf16_f32 v251, v54, v55
    s_nop 1
    v_permlane32_swap_b32 v248, v250
    v_permlane32_swap_b32 v249, v251
    s_nop 1
    v_accvgpr_write_b32 a128, v248
    v_accvgpr_write_b32 a129, v249
    v_accvgpr_write_b32 a130, v250
    v_accvgpr_write_b32 a131, v251
    v_mul_f32 v56, s46, v56
    v_mul_f32 v57, s46, v57
    v_mul_f32 v58, s46, v58
    v_mul_f32 v59, s46, v59
    v_mul_f32 v60, s46, v60
    v_mul_f32 v61, s46, v61
    v_mul_f32 v62, s46, v62
    v_mul_f32 v63, s46, v63
    v_cvt_pk_bf16_f32 v248, v56, v57
    v_cvt_pk_bf16_f32 v249, v58, v59
    v_cvt_pk_bf16_f32 v250, v60, v61
    v_cvt_pk_bf16_f32 v251, v62, v63
    s_nop 1
    v_permlane32_swap_b32 v248, v250
    v_permlane32_swap_b32 v249, v251
    s_nop 1
    v_accvgpr_write_b32 a132, v248
    v_accvgpr_write_b32 a133, v249
    v_accvgpr_write_b32 a134, v250
    v_accvgpr_write_b32 a135, v251
    v_mul_f32 v80, s46, v80
    v_mul_f32 v81, s46, v81
    v_mul_f32 v82, s46, v82
    v_mul_f32 v83, s46, v83
    v_mul_f32 v84, s46, v84
    v_mul_f32 v85, s46, v85
    v_mul_f32 v86, s46, v86
    v_mul_f32 v87, s46, v87
    v_cvt_pk_bf16_f32 v248, v80, v81
    v_cvt_pk_bf16_f32 v249, v82, v83
    v_cvt_pk_bf16_f32 v250, v84, v85
    v_cvt_pk_bf16_f32 v251, v86, v87
    s_nop 1
    v_permlane32_swap_b32 v248, v250
    v_permlane32_swap_b32 v249, v251
    s_nop 1
    v_accvgpr_write_b32 a136, v248
    v_accvgpr_write_b32 a137, v249
    v_accvgpr_write_b32 a138, v250
    v_accvgpr_write_b32 a139, v251
    v_mul_f32 v88, s46, v88
    v_mul_f32 v89, s46, v89
    v_mul_f32 v90, s46, v90
    v_mul_f32 v91, s46, v91
    v_mul_f32 v92, s46, v92
    v_mul_f32 v93, s46, v93
    v_mul_f32 v94, s46, v94
    v_mul_f32 v95, s46, v95
    v_cvt_pk_bf16_f32 v248, v88, v89
    v_cvt_pk_bf16_f32 v249, v90, v91
    v_cvt_pk_bf16_f32 v250, v92, v93
    v_cvt_pk_bf16_f32 v251, v94, v95
    s_nop 1
    v_permlane32_swap_b32 v248, v250
    v_permlane32_swap_b32 v249, v251
    s_nop 1
    v_accvgpr_write_b32 a140, v248
    v_accvgpr_write_b32 a141, v249
    v_accvgpr_write_b32 a142, v250
    v_accvgpr_write_b32 a143, v251
    v_mul_f32 v112, s46, v112
    v_mul_f32 v113, s46, v113
    v_mul_f32 v114, s46, v114
    v_mul_f32 v115, s46, v115
    v_mul_f32 v116, s46, v116
    v_mul_f32 v117, s46, v117
    v_mul_f32 v118, s46, v118
    v_mul_f32 v119, s46, v119
    v_cvt_pk_bf16_f32 v248, v112, v113
    v_cvt_pk_bf16_f32 v249, v114, v115
    v_cvt_pk_bf16_f32 v250, v116, v117
    v_cvt_pk_bf16_f32 v251, v118, v119
    s_nop 1
    v_permlane32_swap_b32 v248, v250
    v_permlane32_swap_b32 v249, v251
    s_nop 1
    v_accvgpr_write_b32 a144, v248
    v_accvgpr_write_b32 a145, v249
    v_accvgpr_write_b32 a146, v250
    v_accvgpr_write_b32 a147, v251
    v_mul_f32 v120, s46, v120
    v_mul_f32 v121, s46, v121
    v_mul_f32 v122, s46, v122
    v_mul_f32 v123, s46, v123
    v_mul_f32 v124, s46, v124
    v_mul_f32 v125, s46, v125
    v_mul_f32 v126, s46, v126
    v_mul_f32 v127, s46, v127
    v_cvt_pk_bf16_f32 v248, v120, v121
    v_cvt_pk_bf16_f32 v249, v122, v123
    v_cvt_pk_bf16_f32 v250, v124, v125
    v_cvt_pk_bf16_f32 v251, v126, v127
    s_nop 1
    v_permlane32_swap_b32 v248, v250
    v_permlane32_swap_b32 v249, v251
    s_nop 1
    v_accvgpr_write_b32 a148, v248
    v_accvgpr_write_b32 a149, v249
    v_accvgpr_write_b32 a150, v250
    v_accvgpr_write_b32 a151, v251
    v_mul_f32 v144, s46, v144
    v_mul_f32 v145, s46, v145
    v_mul_f32 v146, s46, v146
    v_mul_f32 v147, s46, v147
    v_mul_f32 v148, s46, v148
    v_mul_f32 v149, s46, v149
    v_mul_f32 v150, s46, v150
    v_mul_f32 v151, s46, v151
    v_cvt_pk_bf16_f32 v248, v144, v145
    v_cvt_pk_bf16_f32 v249, v146, v147
    v_cvt_pk_bf16_f32 v250, v148, v149
    v_cvt_pk_bf16_f32 v251, v150, v151
    s_nop 1
    v_permlane32_swap_b32 v248, v250
    v_permlane32_swap_b32 v249, v251
    s_nop 1
    v_accvgpr_write_b32 a152, v248
    v_accvgpr_write_b32 a153, v249
    v_accvgpr_write_b32 a154, v250
    v_accvgpr_write_b32 a155, v251
    v_mul_f32 v152, s46, v152
    v_mul_f32 v153, s46, v153
    v_mul_f32 v154, s46, v154
    v_mul_f32 v155, s46, v155
    v_mul_f32 v156, s46, v156
    v_mul_f32 v157, s46, v157
    v_mul_f32 v158, s46, v158
    v_mul_f32 v159, s46, v159
    v_cvt_pk_bf16_f32 v248, v152, v153
    v_cvt_pk_bf16_f32 v249, v154, v155
    v_cvt_pk_bf16_f32 v250, v156, v157
    v_cvt_pk_bf16_f32 v251, v158, v159
    s_nop 1
    v_permlane32_swap_b32 v248, v250
    v_permlane32_swap_b32 v249, v251
    s_nop 1
    v_accvgpr_write_b32 a156, v248
    v_accvgpr_write_b32 a157, v249
    v_accvgpr_write_b32 a158, v250
    v_accvgpr_write_b32 a159, v251
    v_mul_f32 v64, s46, v64
    v_mul_f32 v65, s46, v65
    v_mul_f32 v66, s46, v66
    v_mul_f32 v67, s46, v67
    v_mul_f32 v68, s46, v68
    v_mul_f32 v69, s46, v69
    v_mul_f32 v70, s46, v70
    v_mul_f32 v71, s46, v71
    v_cvt_pk_bf16_f32 v248, v64, v65
    v_cvt_pk_bf16_f32 v249, v66, v67
    v_cvt_pk_bf16_f32 v250, v68, v69
    v_cvt_pk_bf16_f32 v251, v70, v71
    s_nop 1
    v_permlane32_swap_b32 v248, v250
    v_permlane32_swap_b32 v249, v251
    s_nop 1
    v_accvgpr_write_b32 a160, v248
    v_accvgpr_write_b32 a161, v249
    v_accvgpr_write_b32 a162, v250
    v_accvgpr_write_b32 a163, v251
    v_mul_f32 v72, s46, v72
    v_mul_f32 v73, s46, v73
    v_mul_f32 v74, s46, v74
    v_mul_f32 v75, s46, v75
    v_mul_f32 v76, s46, v76
    v_mul_f32 v77, s46, v77
    v_mul_f32 v78, s46, v78
    v_mul_f32 v79, s46, v79
    v_cvt_pk_bf16_f32 v248, v72, v73
    v_cvt_pk_bf16_f32 v249, v74, v75
    v_cvt_pk_bf16_f32 v250, v76, v77
    v_cvt_pk_bf16_f32 v251, v78, v79
    s_nop 1
    v_permlane32_swap_b32 v248, v250
    v_permlane32_swap_b32 v249, v251
    s_nop 1
    v_accvgpr_write_b32 a164, v248
    v_accvgpr_write_b32 a165, v249
    v_accvgpr_write_b32 a166, v250
    v_accvgpr_write_b32 a167, v251
    v_mul_f32 v96, s46, v96
    v_mul_f32 v97, s46, v97
    v_mul_f32 v98, s46, v98
    v_mul_f32 v99, s46, v99
    v_mul_f32 v100, s46, v100
    v_mul_f32 v101, s46, v101
    v_mul_f32 v102, s46, v102
    v_mul_f32 v103, s46, v103
    v_cvt_pk_bf16_f32 v248, v96, v97
    v_cvt_pk_bf16_f32 v249, v98, v99
    v_cvt_pk_bf16_f32 v250, v100, v101
    v_cvt_pk_bf16_f32 v251, v102, v103
    s_nop 1
    v_permlane32_swap_b32 v248, v250
    v_permlane32_swap_b32 v249, v251
    s_nop 1
    v_accvgpr_write_b32 a168, v248
    v_accvgpr_write_b32 a169, v249
    v_accvgpr_write_b32 a170, v250
    v_accvgpr_write_b32 a171, v251
    v_mul_f32 v104, s46, v104
    v_mul_f32 v105, s46, v105
    v_mul_f32 v106, s46, v106
    v_mul_f32 v107, s46, v107
    v_mul_f32 v108, s46, v108
    v_mul_f32 v109, s46, v109
    v_mul_f32 v110, s46, v110
    v_mul_f32 v111, s46, v111
    v_cvt_pk_bf16_f32 v248, v104, v105
    v_cvt_pk_bf16_f32 v249, v106, v107
    v_cvt_pk_bf16_f32 v250, v108, v109
    v_cvt_pk_bf16_f32 v251, v110, v111
    s_nop 1
    v_permlane32_swap_b32 v248, v250
    v_permlane32_swap_b32 v249, v251
    s_nop 1
    v_accvgpr_write_b32 a172, v248
    v_accvgpr_write_b32 a173, v249
    v_accvgpr_write_b32 a174, v250
    v_accvgpr_write_b32 a175, v251
    v_mul_f32 v128, s46, v128
    v_mul_f32 v129, s46, v129
    v_mul_f32 v130, s46, v130
    v_mul_f32 v131, s46, v131
    v_mul_f32 v132, s46, v132
    v_mul_f32 v133, s46, v133
    v_mul_f32 v134, s46, v134
    v_mul_f32 v135, s46, v135
    v_cvt_pk_bf16_f32 v248, v128, v129
    v_cvt_pk_bf16_f32 v249, v130, v131
    v_cvt_pk_bf16_f32 v250, v132, v133
    v_cvt_pk_bf16_f32 v251, v134, v135
    s_nop 1
    v_permlane32_swap_b32 v248, v250
    v_permlane32_swap_b32 v249, v251
    s_nop 1
    v_accvgpr_write_b32 a176, v248
    v_accvgpr_write_b32 a177, v249
    v_accvgpr_write_b32 a178, v250
    v_accvgpr_write_b32 a179, v251
    v_mul_f32 v136, s46, v136
    v_mul_f32 v137, s46, v137
    v_mul_f32 v138, s46, v138
    v_mul_f32 v139, s46, v139
    v_mul_f32 v140, s46, v140
    v_mul_f32 v141, s46, v141
    v_mul_f32 v142, s46, v142
    v_mul_f32 v143, s46, v143
    v_cvt_pk_bf16_f32 v248, v136, v137
    v_cvt_pk_bf16_f32 v249, v138, v139
    v_cvt_pk_bf16_f32 v250, v140, v141
    v_cvt_pk_bf16_f32 v251, v142, v143
    s_nop 1
    v_permlane32_swap_b32 v248, v250
    v_permlane32_swap_b32 v249, v251
    s_nop 1
    v_accvgpr_write_b32 a180, v248
    v_accvgpr_write_b32 a181, v249
    v_accvgpr_write_b32 a182, v250
    v_accvgpr_write_b32 a183, v251
    v_mul_f32 v160, s46, v160
    v_mul_f32 v161, s46, v161
    v_mul_f32 v162, s46, v162
    v_mul_f32 v163, s46, v163
    v_mul_f32 v164, s46, v164
    v_mul_f32 v165, s46, v165
    v_mul_f32 v166, s46, v166
    v_mul_f32 v167, s46, v167
    v_cvt_pk_bf16_f32 v248, v160, v161
    v_cvt_pk_bf16_f32 v249, v162, v163
    v_cvt_pk_bf16_f32 v250, v164, v165
    v_cvt_pk_bf16_f32 v251, v166, v167
    s_nop 1
    v_permlane32_swap_b32 v248, v250
    v_permlane32_swap_b32 v249, v251
    s_nop 1
    v_accvgpr_write_b32 a184, v248
    v_accvgpr_write_b32 a185, v249
    v_accvgpr_write_b32 a186, v250
    v_accvgpr_write_b32 a187, v251
    v_mul_f32 v168, s46, v168
    v_mul_f32 v169, s46, v169
    v_mul_f32 v170, s46, v170
    v_mul_f32 v171, s46, v171
    v_mul_f32 v172, s46, v172
    v_mul_f32 v173, s46, v173
    v_mul_f32 v174, s46, v174
    v_mul_f32 v175, s46, v175
    v_cvt_pk_bf16_f32 v248, v168, v169
    v_cvt_pk_bf16_f32 v249, v170, v171
    v_cvt_pk_bf16_f32 v250, v172, v173
    v_cvt_pk_bf16_f32 v251, v174, v175
    s_nop 1
    v_permlane32_swap_b32 v248, v250
    v_permlane32_swap_b32 v249, v251
    s_nop 1
    v_accvgpr_write_b32 a188, v248
    v_accvgpr_write_b32 a189, v249
    v_accvgpr_write_b32 a190, v250
    v_accvgpr_write_b32 a191, v251
    v_accvgpr_write_b32 a0, 0
    v_accvgpr_write_b32 a1, 0
    v_accvgpr_write_b32 a2, 0
    v_accvgpr_write_b32 a3, 0
    v_accvgpr_write_b32 a4, 0
    v_accvgpr_write_b32 a5, 0
    v_accvgpr_write_b32 a6, 0
    v_accvgpr_write_b32 a7, 0
    v_accvgpr_write_b32 a8, 0
    v_accvgpr_write_b32 a9, 0
    v_accvgpr_write_b32 a10, 0
    v_accvgpr_write_b32 a11, 0
    v_accvgpr_write_b32 a12, 0
    v_accvgpr_write_b32 a13, 0
    v_accvgpr_write_b32 a14, 0
    v_accvgpr_write_b32 a15, 0
    v_accvgpr_write_b32 a16, 0
    v_accvgpr_write_b32 a17, 0
    v_accvgpr_write_b32 a18, 0
    v_accvgpr_write_b32 a19, 0
    v_accvgpr_write_b32 a20, 0
    v_accvgpr_write_b32 a21, 0
    v_accvgpr_write_b32 a22, 0
    v_accvgpr_write_b32 a23, 0
    v_accvgpr_write_b32 a24, 0
    v_accvgpr_write_b32 a25, 0
    v_accvgpr_write_b32 a26, 0
    v_accvgpr_write_b32 a27, 0
    v_accvgpr_write_b32 a28, 0
    v_accvgpr_write_b32 a29, 0
    v_accvgpr_write_b32 a30, 0
    v_accvgpr_write_b32 a31, 0
    v_accvgpr_write_b32 a32, 0
    v_accvgpr_write_b32 a33, 0
    v_accvgpr_write_b32 a34, 0
    v_accvgpr_write_b32 a35, 0
    v_accvgpr_write_b32 a36, 0
    v_accvgpr_write_b32 a37, 0
    v_accvgpr_write_b32 a38, 0
    v_accvgpr_write_b32 a39, 0
    v_accvgpr_write_b32 a40, 0
    v_accvgpr_write_b32 a41, 0
    v_accvgpr_write_b32 a42, 0
    v_accvgpr_write_b32 a43, 0
    v_accvgpr_write_b32 a44, 0
    v_accvgpr_write_b32 a45, 0
    v_accvgpr_write_b32 a46, 0
    v_accvgpr_write_b32 a47, 0
    v_accvgpr_write_b32 a48, 0
    v_accvgpr_write_b32 a49, 0
    v_accvgpr_write_b32 a50, 0
    v_accvgpr_write_b32 a51, 0
    v_accvgpr_write_b32 a52, 0
    v_accvgpr_write_b32 a53, 0
    v_accvgpr_write_b32 a54, 0
    v_accvgpr_write_b32 a55, 0
    v_accvgpr_write_b32 a56, 0
    v_accvgpr_write_b32 a57, 0
    v_accvgpr_write_b32 a58, 0
    v_accvgpr_write_b32 a59, 0
    v_accvgpr_write_b32 a60, 0
    v_accvgpr_write_b32 a61, 0
    v_accvgpr_write_b32 a62, 0
    v_accvgpr_write_b32 a63, 0
    v_accvgpr_write_b32 a64, 0
    v_accvgpr_write_b32 a65, 0
    v_accvgpr_write_b32 a66, 0
    v_accvgpr_write_b32 a67, 0
    v_accvgpr_write_b32 a68, 0
    v_accvgpr_write_b32 a69, 0
    v_accvgpr_write_b32 a70, 0
    v_accvgpr_write_b32 a71, 0
    v_accvgpr_write_b32 a72, 0
    v_accvgpr_write_b32 a73, 0
    v_accvgpr_write_b32 a74, 0
    v_accvgpr_write_b32 a75, 0
    v_accvgpr_write_b32 a76, 0
    v_accvgpr_write_b32 a77, 0
    v_accvgpr_write_b32 a78, 0
    v_accvgpr_write_b32 a79, 0
    v_accvgpr_write_b32 a80, 0
    v_accvgpr_write_b32 a81, 0
    v_accvgpr_write_b32 a82, 0
    v_accvgpr_write_b32 a83, 0
    v_accvgpr_write_b32 a84, 0
    v_accvgpr_write_b32 a85, 0
    v_accvgpr_write_b32 a86, 0
    v_accvgpr_write_b32 a87, 0
    v_accvgpr_write_b32 a88, 0
    v_accvgpr_write_b32 a89, 0
    v_accvgpr_write_b32 a90, 0
    v_accvgpr_write_b32 a91, 0
    v_accvgpr_write_b32 a92, 0
    v_accvgpr_write_b32 a93, 0
    v_accvgpr_write_b32 a94, 0
    v_accvgpr_write_b32 a95, 0
    v_accvgpr_write_b32 a96, 0
    v_accvgpr_write_b32 a97, 0
    v_accvgpr_write_b32 a98, 0
    v_accvgpr_write_b32 a99, 0
    v_accvgpr_write_b32 a100, 0
    v_accvgpr_write_b32 a101, 0
    v_accvgpr_write_b32 a102, 0
    v_accvgpr_write_b32 a103, 0
    v_accvgpr_write_b32 a104, 0
    v_accvgpr_write_b32 a105, 0
    v_accvgpr_write_b32 a106, 0
    v_accvgpr_write_b32 a107, 0
    v_accvgpr_write_b32 a108, 0
    v_accvgpr_write_b32 a109, 0
    v_accvgpr_write_b32 a110, 0
    v_accvgpr_write_b32 a111, 0
    v_accvgpr_write_b32 a112, 0
    v_accvgpr_write_b32 a113, 0
    v_accvgpr_write_b32 a114, 0
    v_accvgpr_write_b32 a115, 0
    v_accvgpr_write_b32 a116, 0
    v_accvgpr_write_b32 a117, 0
    v_accvgpr_write_b32 a118, 0
    v_accvgpr_write_b32 a119, 0
    v_accvgpr_write_b32 a120, 0
    v_accvgpr_write_b32 a121, 0
    v_accvgpr_write_b32 a122, 0
    v_accvgpr_write_b32 a123, 0
    v_accvgpr_write_b32 a124, 0
    v_accvgpr_write_b32 a125, 0
    v_accvgpr_write_b32 a126, 0
    v_accvgpr_write_b32 a127, 0
    v_mov_b32 v33, 0
    v_mov_b32 v34, 0
    v_mov_b32 v35, 0
    v_mov_b32 v36, 0
    v_mov_b32 v208, 0
    v_mov_b32 v209, 0
    v_mov_b32 v210, 0
    v_mov_b32 v211, 0
    v_mov_b32 v212, 0
    v_mov_b32 v213, 0
    v_mov_b32 v214, 0
    v_mov_b32 v215, 0
    v_mov_b32 v216, 0
    v_mov_b32 v217, 0
    v_mov_b32 v218, 0
    v_mov_b32 v219, 0
    v_mov_b32 v220, 0
    v_mov_b32 v221, 0
    v_mov_b32 v222, 0
    v_mov_b32 v223, 0
    v_mov_b32 v224, 0
    v_mov_b32 v225, 0
    v_mov_b32 v226, 0
    v_mov_b32 v227, 0
    v_mov_b32 v228, 0
    v_mov_b32 v229, 0
    v_mov_b32 v230, 0
    v_mov_b32 v231, 0
    v_mov_b32 v232, 0
    v_mov_b32 v233, 0
    v_mov_b32 v234, 0
    v_mov_b32 v235, 0
    v_mov_b32 v236, 0
    v_mov_b32 v237, 0
    v_mov_b32 v238, 0
    v_mov_b32 v239, 0
    s_mov_b32 s52, 0x42000000
    s_mov_b32 s53, 0
    s_waitcnt vmcnt(20)
    s_barrier
    ds_read_b128 a[192:195], v16 offset:0
    ds_read_b128 a[196:199], v16 offset:8192
    ds_read_b128 a[200:203], v17 offset:0
    ds_read_b128 a[204:207], v17 offset:8192
    ds_read_b128 a[208:211], v18 offset:0
    ds_read_b128 a[212:215], v18 offset:8192
    ds_read_b128 a[216:219], v19 offset:0
    ds_read_b128 a[220:223], v19 offset:8192
    ds_read_b128 a[224:227], v20 offset:0
    ds_read_b128 a[228:231], v20 offset:8192
    ds_read_b128 a[232:235], v21 offset:0
    ds_read_b128 a[236:239], v21 offset:8192
    ds_read_b128 a[240:243], v22 offset:0
    ds_read_b128 a[244:247], v22 offset:8192
    ds_read_b128 a[248:251], v23 offset:0
    ds_read_b128 a[252:255], v23 offset:8192
    s_waitcnt lgkmcnt(15)
    v_mfma_f32_32x32x16_bf16 v[48:63], a[192:195], a[128:131], v[208:223]
    v_mfma_f32_32x32x16_bf16 v[64:79], a[192:195], a[160:163], v[224:239]
    s_waitcnt lgkmcnt(14)
    v_mfma_f32_32x32x16_bf16 v[80:95], a[196:199], a[128:131], v[208:223]
    v_mfma_f32_32x32x16_bf16 v[96:111], a[196:199], a[160:163], v[224:239]
    s_waitcnt lgkmcnt(13)
    v_mfma_f32_32x32x16_bf16 v[48:63], a[200:203], a[132:135], v[48:63]
    v_mfma_f32_32x32x16_bf16 v[64:79], a[200:203], a[164:167], v[64:79]
    s_waitcnt lgkmcnt(12)
    v_mfma_f32_32x32x16_bf16 v[80:95], a[204:207], a[132:135], v[80:95]
    v_mfma_f32_32x32x16_bf16 v[96:111], a[204:207], a[164:167], v[96:111]
    s_waitcnt lgkmcnt(11)
    v_mfma_f32_32x32x16_bf16 v[48:63], a[208:211], a[136:139], v[48:63]
    v_mfma_f32_32x32x16_bf16 v[64:79], a[208:211], a[168:171], v[64:79]
    s_waitcnt lgkmcnt(10)
    v_mfma_f32_32x32x16_bf16 v[80:95], a[212:215], a[136:139], v[80:95]
    v_mfma_f32_32x32x16_bf16 v[96:111], a[212:215], a[168:171], v[96:111]
    s_waitcnt lgkmcnt(9)
    v_mfma_f32_32x32x16_bf16 v[48:63], a[216:219], a[140:143], v[48:63]
    v_mfma_f32_32x32x16_bf16 v[64:79], a[216:219], a[172:175], v[64:79]
    s_waitcnt lgkmcnt(8)
    v_mfma_f32_32x32x16_bf16 v[80:95], a[220:223], a[140:143], v[80:95]
    v_mfma_f32_32x32x16_bf16 v[96:111], a[220:223], a[172:175], v[96:111]
    s_waitcnt lgkmcnt(7)
    v_mfma_f32_32x32x16_bf16 v[48:63], a[224:227], a[144:147], v[48:63]
    v_mfma_f32_32x32x16_bf16 v[64:79], a[224:227], a[176:179], v[64:79]
    s_waitcnt lgkmcnt(6)
    v_mfma_f32_32x32x16_bf16 v[80:95], a[228:231], a[144:147], v[80:95]
    v_mfma_f32_32x32x16_bf16 v[96:111], a[228:231], a[176:179], v[96:111]
    s_waitcnt lgkmcnt(5)
    v_mfma_f32_32x32x16_bf16 v[48:63], a[232:235], a[148:151], v[48:63]
    v_mfma_f32_32x32x16_bf16 v[64:79], a[232:235], a[180:183], v[64:79]
    s_waitcnt lgkmcnt(4)
    v_mfma_f32_32x32x16_bf16 v[80:95], a[236:239], a[148:151], v[80:95]
    v_mfma_f32_32x32x16_bf16 v[96:111], a[236:239], a[180:183], v[96:111]
    s_waitcnt lgkmcnt(3)
    v_mfma_f32_32x32x16_bf16 v[48:63], a[240:243], a[152:155], v[48:63]
    v_mfma_f32_32x32x16_bf16 v[64:79], a[240:243], a[184:187], v[64:79]
    s_waitcnt lgkmcnt(2)
    v_mfma_f32_32x32x16_bf16 v[80:95], a[244:247], a[152:155], v[80:95]
    v_mfma_f32_32x32x16_bf16 v[96:111], a[244:247], a[184:187], v[96:111]
    s_waitcnt lgkmcnt(1)
    v_mfma_f32_32x32x16_bf16 v[48:63], a[248:251], a[156:159], v[48:63]
    v_mfma_f32_32x32x16_bf16 v[64:79], a[248:251], a[188:191], v[64:79]
    s_waitcnt lgkmcnt(0)
    v_mfma_f32_32x32x16_bf16 v[80:95], a[252:255], a[156:159], v[80:95]
    v_mfma_f32_32x32x16_bf16 v[96:111], a[252:255], a[188:191], v[96:111]
    s_waitcnt vmcnt(8)
    s_barrier
    s_mov_b32 s50, 65536
    s_add_u32 m0, s43, 0
    s_nop 0
    buffer_load_dwordx4 v28, s[12:15], s50 offen offset:0 lds
    buffer_load_dwordx4 v29, s[12:15], s50 offen offset:1024 lds
    buffer_load_dwordx4 v30, s[12:15], s50 offen offset:2048 lds
    buffer_load_dwordx4 v31, s[12:15], s50 offen offset:3072 lds
    s_mov_b32 s51, 32768
    s_add_u32 m0, s43, 98304
    s_nop 0
    buffer_load_dwordx4 v32, s[16:19], s51 offen offset:0 lds
    buffer_load_dwordx4 v32, s[16:19], s51 offen offset:1024 lds
    buffer_load_dwordx4 v32, s[16:19], s51 offen offset:2048 lds
    buffer_load_dwordx4 v32, s[16:19], s51 offen offset:3072 lds
    s_nop 7
    v_max3_f32 v37, v48, v49, v50
    v_max3_f32 v37, v37, v51, v52
    v_max3_f32 v37, v37, v53, v54
    v_max3_f32 v37, v37, v55, v56
    v_max3_f32 v37, v37, v57, v58
    v_max3_f32 v37, v37, v59, v60
    v_max3_f32 v37, v37, v61, v62
    v_max3_f32 v37, v37, v63, v80
    v_max3_f32 v37, v37, v81, v82
    v_max3_f32 v37, v37, v83, v84
    v_max3_f32 v37, v37, v85, v86
    v_max3_f32 v37, v37, v87, v88
    v_max3_f32 v37, v37, v89, v90
    v_max3_f32 v37, v37, v91, v92
    v_max3_f32 v37, v37, v93, v94
    v_max_f32 v37, v37, v95
    v_max3_f32 v38, v64, v65, v66
    v_max3_f32 v38, v38, v67, v68
    v_max3_f32 v38, v38, v69, v70
    v_max3_f32 v38, v38, v71, v72
    v_max3_f32 v38, v38, v73, v74
    v_max3_f32 v38, v38, v75, v76
    v_max3_f32 v38, v38, v77, v78
    v_max3_f32 v38, v38, v79, v96
    v_max3_f32 v38, v38, v97, v98
    v_max3_f32 v38, v38, v99, v100
    v_max3_f32 v38, v38, v101, v102
    v_max3_f32 v38, v38, v103, v104
    v_max3_f32 v38, v38, v105, v106
    v_max3_f32 v38, v38, v107, v108
    v_max3_f32 v38, v38, v109, v110
    v_max_f32 v38, v38, v111
    v_mov_b32 v39, v37
    v_mov_b32 v40, v38
    s_nop 1
    v_permlane32_swap_b32 v37, v39
    v_permlane32_swap_b32 v38, v40
    s_nop 1
    v_max_f32 v37, v37, v39
    v_max_f32 v38, v38, v40
    v_max_f32 v41, v37, v38
    s_nop 15
    s_nop 15
    v_mov_b32 v42, v37
    v_exp_f32 v44, -v42
    v_mov_b32 v43, v38
    v_exp_f32 v45, -v43
    s_nop 0
    v_sub_f32 v48, v48, v42
    v_sub_f32 v49, v49, v42
    v_sub_f32 v50, v50, v42
    v_sub_f32 v51, v51, v42
    v_sub_f32 v52, v52, v42
    v_sub_f32 v53, v53, v42
    v_sub_f32 v54, v54, v42
    v_sub_f32 v55, v55, v42
    v_sub_f32 v56, v56, v42
    v_sub_f32 v57, v57, v42
    v_sub_f32 v58, v58, v42
    v_sub_f32 v59, v59, v42
    v_sub_f32 v60, v60, v42
    v_sub_f32 v61, v61, v42
    v_sub_f32 v62, v62, v42
    v_sub_f32 v63, v63, v42
    v_sub_f32 v80, v80, v42
    v_sub_f32 v81, v81, v42
    v_sub_f32 v82, v82, v42
    v_sub_f32 v83, v83, v42
    v_sub_f32 v84, v84, v42
    v_sub_f32 v85, v85, v42
    v_sub_f32 v86, v86, v42
    v_sub_f32 v87, v87, v42
    v_sub_f32 v88, v88, v42
    v_sub_f32 v89, v89, v42
    v_sub_f32 v90, v90, v42
    v_sub_f32 v91, v91, v42
    v_sub_f32 v92, v92, v42
    v_sub_f32 v93, v93, v42
    v_sub_f32 v94, v94, v42
    v_sub_f32 v95, v95, v42
    v_sub_f32 v208, v208, v42
    v_sub_f32 v209, v209, v42
    v_sub_f32 v210, v210, v42
    v_sub_f32 v211, v211, v42
    v_sub_f32 v212, v212, v42
    v_sub_f32 v213, v213, v42
    v_sub_f32 v214, v214, v42
    v_sub_f32 v215, v215, v42
    v_sub_f32 v216, v216, v42
    v_sub_f32 v217, v217, v42
    v_sub_f32 v218, v218, v42
    v_sub_f32 v219, v219, v42
    v_sub_f32 v220, v220, v42
    v_sub_f32 v221, v221, v42
    v_sub_f32 v222, v222, v42
    v_sub_f32 v223, v223, v42
    v_sub_f32 v64, v64, v43
    v_sub_f32 v65, v65, v43
    v_sub_f32 v66, v66, v43
    v_sub_f32 v67, v67, v43
    v_sub_f32 v68, v68, v43
    v_sub_f32 v69, v69, v43
    v_sub_f32 v70, v70, v43
    v_sub_f32 v71, v71, v43
    v_sub_f32 v72, v72, v43
    v_sub_f32 v73, v73, v43
    v_sub_f32 v74, v74, v43
    v_sub_f32 v75, v75, v43
    v_sub_f32 v76, v76, v43
    v_sub_f32 v77, v77, v43
    v_sub_f32 v78, v78, v43
    v_sub_f32 v79, v79, v43
    v_sub_f32 v96, v96, v43
    v_sub_f32 v97, v97, v43
    v_sub_f32 v98, v98, v43
    v_sub_f32 v99, v99, v43
    v_sub_f32 v100, v100, v43
    v_sub_f32 v101, v101, v43
    v_sub_f32 v102, v102, v43
    v_sub_f32 v103, v103, v43
    v_sub_f32 v104, v104, v43
    v_sub_f32 v105, v105, v43
    v_sub_f32 v106, v106, v43
    v_sub_f32 v107, v107, v43
    v_sub_f32 v108, v108, v43
    v_sub_f32 v109, v109, v43
    v_sub_f32 v110, v110, v43
    v_sub_f32 v111, v111, v43
    v_sub_f32 v224, v224, v43
    v_sub_f32 v225, v225, v43
    v_sub_f32 v226, v226, v43
    v_sub_f32 v227, v227, v43
    v_sub_f32 v228, v228, v43
    v_sub_f32 v229, v229, v43
    v_sub_f32 v230, v230, v43
    v_sub_f32 v231, v231, v43
    v_sub_f32 v232, v232, v43
    v_sub_f32 v233, v233, v43
    v_sub_f32 v234, v234, v43
    v_sub_f32 v235, v235, v43
    v_sub_f32 v236, v236, v43
    v_sub_f32 v237, v237, v43
    v_sub_f32 v238, v238, v43
    v_sub_f32 v239, v239, v43
    s_nop 3
    ds_read_b128 a[192:195], v16 offset:16384
    ds_read_b128 a[196:199], v16 offset:24576
    ds_read_b128 a[200:203], v17 offset:16384
    s_mov_b32 s54, 0
attn_kernel_loop:
    ds_read_b128 a[204:207], v17 offset:24576
    v_exp_f32 v48, v48
    v_exp_f32 v49, v49
    s_waitcnt lgkmcnt(3)
    v_mfma_f32_32x32x16_bf16 v[112:127], a[192:195], a[128:131], v[208:223]
    v_exp_f32 v50, v50
    v_add_f32 v33, v33, v48
    v_exp_f32 v51, v51
    v_mfma_f32_32x32x16_bf16 v[128:143], a[192:195], a[160:163], v[224:239]
    ds_read_b128 a[208:211], v18 offset:16384
    v_add_f32 v34, v34, v49
    v_cvt_pk_bf16_f32 v176, v48, v49
    v_exp_f32 v52, v52
    s_waitcnt lgkmcnt(3)
    v_mfma_f32_32x32x16_bf16 v[144:159], a[196:199], a[128:131], v[208:223]
    v_add_f32 v33, v33, v50
    v_exp_f32 v53, v53
    v_add_f32 v34, v34, v51
    v_cvt_pk_bf16_f32 v177, v50, v51
    v_mfma_f32_32x32x16_bf16 v[160:175], a[196:199], a[160:163], v[224:239]
    ds_read_b128 a[212:215], v18 offset:24576
    v_exp_f32 v54, v54
    v_add_f32 v33, v33, v52
    s_waitcnt lgkmcnt(3)
    v_mfma_f32_32x32x16_bf16 v[112:127], a[200:203], a[132:135], v[112:127]
    v_exp_f32 v55, v55
    v_add_f32 v34, v34, v53
    v_cvt_pk_bf16_f32 v178, v52, v53
    v_add_f32 v33, v33, v54
    v_mfma_f32_32x32x16_bf16 v[128:143], a[200:203], a[164:167], v[128:143]
    ds_read_b128 a[216:219], v19 offset:16384
    v_add_f32 v34, v34, v55
    v_cvt_pk_bf16_f32 v179, v54, v55
    v_exp_f32 v64, v64
    s_waitcnt lgkmcnt(3)
    v_mfma_f32_32x32x16_bf16 v[144:159], a[204:207], a[132:135], v[144:159]
    v_exp_f32 v65, v65
    v_exp_f32 v66, v66
    v_add_f32 v35, v35, v64
    v_mfma_f32_32x32x16_bf16 v[160:175], a[204:207], a[164:167], v[160:175]
    ds_read_b128 a[220:223], v19 offset:24576
    v_exp_f32 v67, v67
    v_add_f32 v36, v36, v65
    v_cvt_pk_bf16_f32 v180, v64, v65
    s_waitcnt lgkmcnt(3)
    v_mfma_f32_32x32x16_bf16 v[112:127], a[208:211], a[136:139], v[112:127]
    v_exp_f32 v68, v68
    v_add_f32 v35, v35, v66
    v_mfma_f32_32x32x16_bf16 v[128:143], a[208:211], a[168:171], v[128:143]
    ds_read_b128 a[224:227], v20 offset:16384
    v_exp_f32 v69, v69
    v_add_f32 v36, v36, v67
    v_cvt_pk_bf16_f32 v181, v66, v67
    s_waitcnt lgkmcnt(3)
    v_mfma_f32_32x32x16_bf16 v[144:159], a[212:215], a[136:139], v[144:159]
    v_exp_f32 v70, v70
    v_add_f32 v35, v35, v68
    v_exp_f32 v71, v71
    v_add_f32 v36, v36, v69
    v_mfma_f32_32x32x16_bf16 v[160:175], a[212:215], a[168:171], v[160:175]
    ds_read_b128 a[228:231], v20 offset:24576
    v_cvt_pk_bf16_f32 v182, v68, v69
    v_add_f32 v35, v35, v70
    v_add_f32 v36, v36, v71
    v_cvt_pk_bf16_f32 v183, v70, v71
    s_waitcnt lgkmcnt(3)
    v_mfma_f32_32x32x16_bf16 v[112:127], a[216:219], a[140:143], v[112:127]
    v_exp_f32 v56, v56
    v_exp_f32 v57, v57
    v_mfma_f32_32x32x16_bf16 v[128:143], a[216:219], a[172:175], v[128:143]
    ds_read_b128 a[232:235], v21 offset:16384
    v_exp_f32 v58, v58
    v_add_f32 v33, v33, v56
    v_exp_f32 v59, v59
    s_waitcnt lgkmcnt(3)
    v_mfma_f32_32x32x16_bf16 v[144:159], a[220:223], a[140:143], v[144:159]
    v_add_f32 v34, v34, v57
    v_cvt_pk_bf16_f32 v184, v56, v57
    v_exp_f32 v60, v60
    v_mfma_f32_32x32x16_bf16 v[160:175], a[220:223], a[172:175], v[160:175]
    ds_read_b128 a[236:239], v21 offset:24576
    v_add_f32 v33, v33, v58
    v_exp_f32 v61, v61
    v_add_f32 v34, v34, v59
    s_waitcnt lgkmcnt(3)
    v_mfma_f32_32x32x16_bf16 v[112:127], a[224:227], a[144:147], v[112:127]
    v_cvt_pk_bf16_f32 v185, v58, v59
    v_exp_f32 v62, v62
    v_add_f32 v33, v33, v60
    v_mfma_f32_32x32x16_bf16 v[128:143], a[224:227], a[176:179], v[128:143]
    ds_read_b128 a[240:243], v22 offset:16384
    v_exp_f32 v63, v63
    v_add_f32 v34, v34, v61
    v_cvt_pk_bf16_f32 v186, v60, v61
    v_add_f32 v33, v33, v62
    s_waitcnt lgkmcnt(3)
    v_mfma_f32_32x32x16_bf16 v[144:159], a[228:231], a[144:147], v[144:159]
    v_add_f32 v34, v34, v63
    v_cvt_pk_bf16_f32 v187, v62, v63
    v_exp_f32 v72, v72
    v_mfma_f32_32x32x16_bf16 v[160:175], a[228:231], a[176:179], v[160:175]
    ds_read_b128 a[244:247], v22 offset:24576
    v_exp_f32 v73, v73
    v_exp_f32 v74, v74
    s_waitcnt lgkmcnt(3)
    v_mfma_f32_32x32x16_bf16 v[112:127], a[232:235], a[148:151], v[112:127]
    v_add_f32 v35, v35, v72
    v_exp_f32 v75, v75
    v_add_f32 v36, v36, v73
    v_mfma_f32_32x32x16_bf16 v[128:143], a[232:235], a[180:183], v[128:143]
    ds_read_b128 a[248:251], v23 offset:16384
    v_cvt_pk_bf16_f32 v188, v72, v73
    v_exp_f32 v76, v76
    v_add_f32 v35, v35, v74
    s_waitcnt lgkmcnt(3)
    v_mfma_f32_32x32x16_bf16 v[144:159], a[236:239], a[148:151], v[144:159]
    v_exp_f32 v77, v77
    v_add_f32 v36, v36, v75
    v_cvt_pk_bf16_f32 v189, v74, v75
    v_mfma_f32_32x32x16_bf16 v[160:175], a[236:239], a[180:183], v[160:175]
    ds_read_b128 a[252:255], v23 offset:24576
    v_exp_f32 v78, v78
    v_add_f32 v35, v35, v76
    v_exp_f32 v79, v79
    s_waitcnt lgkmcnt(3)
    v_mfma_f32_32x32x16_bf16 v[112:127], a[240:243], a[152:155], v[112:127]
    v_add_f32 v36, v36, v77
    v_cvt_pk_bf16_f32 v190, v76, v77
    v_add_f32 v35, v35, v78
    v_add_f32 v36, v36, v79
    v_mfma_f32_32x32x16_bf16 v[128:143], a[240:243], a[184:187], v[128:143]
    ds_read_b64_tr_b16 a[192:193], v24 offset:0
    ds_read_b64_tr_b16 a[194:195], v24 offset:2048
    v_cvt_pk_bf16_f32 v191, v78, v79
    v_exp_f32 v80, v80
    v_exp_f32 v81, v81
    s_waitcnt lgkmcnt(4)
    v_mfma_f32_32x32x16_bf16 v[144:159], a[244:247], a[152:155], v[144:159]
    v_exp_f32 v82, v82
    v_add_f32 v33, v33, v80
    v_mfma_f32_32x32x16_bf16 v[160:175], a[244:247], a[184:187], v[160:175]
    ds_read_b64_tr_b16 a[196:197], v25 offset:0
    ds_read_b64_tr_b16 a[198:199], v25 offset:2048
    v_exp_f32 v83, v83
    v_add_f32 v34, v34, v81
    v_cvt_pk_bf16_f32 v192, v80, v81
    s_waitcnt lgkmcnt(5)
    v_mfma_f32_32x32x16_bf16 v[112:127], a[248:251], a[156:159], v[112:127]
    v_exp_f32 v84, v84
    v_add_f32 v33, v33, v82
    v_exp_f32 v85, v85
    v_add_f32 v34, v34, v83
    v_mfma_f32_32x32x16_bf16 v[128:143], a[248:251], a[188:191], v[128:143]
    ds_read_b64_tr_b16 a[200:201], v26 offset:0
    ds_read_b64_tr_b16 a[202:203], v26 offset:2048
    v_cvt_pk_bf16_f32 v193, v82, v83
    v_exp_f32 v86, v86
    v_add_f32 v33, v33, v84
    s_waitcnt lgkmcnt(6)
    v_mfma_f32_32x32x16_bf16 v[144:159], a[252:255], a[156:159], v[144:159]
    v_exp_f32 v87, v87
    v_add_f32 v34, v34, v85
    v_cvt_pk_bf16_f32 v194, v84, v85
    v_mfma_f32_32x32x16_bf16 v[160:175], a[252:255], a[188:191], v[160:175]
    ds_read_b64_tr_b16 a[204:205], v27 offset:0
    ds_read_b64_tr_b16 a[206:207], v27 offset:2048
    v_add_f32 v33, v33, v86
    v_add_f32 v34, v34, v87
    v_cvt_pk_bf16_f32 v195, v86, v87
    s_waitcnt lgkmcnt(6)
    v_mfma_f32_32x32x16_bf16 a[0:15], a[192:195], v[176:179], a[0:15]
    v_exp_f32 v96, v96
    v_exp_f32 v97, v97
    v_exp_f32 v98, v98
    v_mfma_f32_32x32x16_bf16 a[16:31], a[192:195], v[180:183], a[16:31]
    ds_read_b64_tr_b16 a[208:209], v24 offset:4096
    ds_read_b64_tr_b16 a[210:211], v24 offset:6144
    v_add_f32 v35, v35, v96
    v_exp_f32 v99, v99
    v_add_f32 v36, v36, v97
    s_waitcnt lgkmcnt(6)
    v_mfma_f32_32x32x16_bf16 a[32:47], a[196:199], v[176:179], a[32:47]
    v_cvt_pk_bf16_f32 v196, v96, v97
    v_exp_f32 v100, v100
    v_add_f32 v35, v35, v98
    v_mfma_f32_32x32x16_bf16 a[48:63], a[196:199], v[180:183], a[48:63]
    ds_read_b64_tr_b16 a[212:213], v25 offset:4096
    ds_read_b64_tr_b16 a[214:215], v25 offset:6144
    v_exp_f32 v101, v101
    v_add_f32 v36, v36, v99
    v_cvt_pk_bf16_f32 v197, v98, v99
    s_waitcnt lgkmcnt(6)
    v_mfma_f32_32x32x16_bf16 a[64:79], a[200:203], v[176:179], a[64:79]
    v_exp_f32 v102, v102
    v_add_f32 v35, v35, v100
    v_exp_f32 v103, v103
    v_mfma_f32_32x32x16_bf16 a[80:95], a[200:203], v[180:183], a[80:95]
    ds_read_b64_tr_b16 a[216:217], v26 offset:4096
    ds_read_b64_tr_b16 a[218:219], v26 offset:6144
    v_add_f32 v36, v36, v101
    v_cvt_pk_bf16_f32 v198, v100, v101
    v_add_f32 v35, v35, v102
    v_add_f32 v36, v36, v103
    s_waitcnt lgkmcnt(6)
    v_mfma_f32_32x32x16_bf16 a[96:111], a[204:207], v[176:179], a[96:111]
    v_cvt_pk_bf16_f32 v199, v102, v103
    v_exp_f32 v88, v88
    v_mfma_f32_32x32x16_bf16 a[112:127], a[204:207], v[180:183], a[112:127]
    ds_read_b64_tr_b16 a[220:221], v27 offset:4096
    ds_read_b64_tr_b16 a[222:223], v27 offset:6144
    v_exp_f32 v89, v89
    v_exp_f32 v90, v90
    v_add_f32 v33, v33, v88
    s_waitcnt lgkmcnt(6)
    v_mfma_f32_32x32x16_bf16 a[0:15], a[208:211], v[184:187], a[0:15]
    v_exp_f32 v91, v91
    v_add_f32 v34, v34, v89
    v_cvt_pk_bf16_f32 v200, v88, v89
    v_mfma_f32_32x32x16_bf16 a[16:31], a[208:211], v[188:191], a[16:31]
    ds_read_b64_tr_b16 a[224:225], v24 offset:8192
    ds_read_b64_tr_b16 a[226:227], v24 offset:10240
    v_exp_f32 v92, v92
    v_add_f32 v33, v33, v90
    v_exp_f32 v93, v93
    s_waitcnt lgkmcnt(6)
    v_mfma_f32_32x32x16_bf16 a[32:47], a[212:215], v[184:187], a[32:47]
    v_add_f32 v34, v34, v91
    v_cvt_pk_bf16_f32 v201, v90, v91
    v_exp_f32 v94, v94
    v_mfma_f32_32x32x16_bf16 a[48:63], a[212:215], v[188:191], a[48:63]
    s_waitcnt vmcnt(8)
    s_barrier
    s_add_u32 s50, s50, 16384
    s_add_u32 s51, s51, 16384
    ds_read_b64_tr_b16 a[228:229], v25 offset:8192
    ds_read_b64_tr_b16 a[230:231], v25 offset:10240
    v_add_f32 v33, v33, v92
    v_exp_f32 v95, v95
    v_add_f32 v34, v34, v93
    v_cvt_pk_bf16_f32 v202, v92, v93
    s_waitcnt lgkmcnt(6)
    v_mfma_f32_32x32x16_bf16 a[64:79], a[216:219], v[184:187], a[64:79]
    s_add_u32 m0, s43, 16384
    s_nop 0
    buffer_load_dwordx4 v28, s[12:15], s50 offen offset:0 lds
    v_add_f32 v33, v33, v94
    v_add_f32 v34, v34, v95
    v_cvt_pk_bf16_f32 v203, v94, v95
    v_mfma_f32_32x32x16_bf16 a[80:95], a[216:219], v[188:191], a[80:95]
    ds_read_b64_tr_b16 a[232:233], v26 offset:8192
    ds_read_b64_tr_b16 a[234:235], v26 offset:10240
    v_exp_f32 v104, v104
    v_exp_f32 v105, v105
    s_waitcnt lgkmcnt(6)
    v_mfma_f32_32x32x16_bf16 a[96:111], a[220:223], v[184:187], a[96:111]
    buffer_load_dwordx4 v29, s[12:15], s50 offen offset:1024 lds
    v_exp_f32 v106, v106
    v_add_f32 v35, v35, v104
    v_exp_f32 v107, v107
    v_mfma_f32_32x32x16_bf16 a[112:127], a[220:223], v[188:191], a[112:127]
    ds_read_b64_tr_b16 a[236:237], v27 offset:8192
    ds_read_b64_tr_b16 a[238:239], v27 offset:10240
    v_add_f32 v36, v36, v105
    v_cvt_pk_bf16_f32 v204, v104, v105
    v_exp_f32 v108, v108
    v_add_f32 v35, v35, v106
    s_waitcnt lgkmcnt(6)
    v_mfma_f32_32x32x16_bf16 a[0:15], a[224:227], v[192:195], a[0:15]
    buffer_load_dwordx4 v30, s[12:15], s50 offen offset:2048 lds
    v_exp_f32 v109, v109
    v_add_f32 v36, v36, v107
    v_cvt_pk_bf16_f32 v205, v106, v107
    v_mfma_f32_32x32x16_bf16 a[16:31], a[224:227], v[196:199], a[16:31]
    ds_read_b64_tr_b16 a[240:241], v24 offset:12288
    ds_read_b64_tr_b16 a[242:243], v24 offset:14336
    v_exp_f32 v110, v110
    v_add_f32 v35, v35, v108
    s_waitcnt lgkmcnt(6)
    v_mfma_f32_32x32x16_bf16 a[32:47], a[228:231], v[192:195], a[32:47]
    buffer_load_dwordx4 v31, s[12:15], s50 offen offset:3072 lds
    v_exp_f32 v111, v111
    v_add_f32 v36, v36, v109
    v_cvt_pk_bf16_f32 v206, v108, v109
    v_add_f32 v35, v35, v110
    v_mfma_f32_32x32x16_bf16 a[48:63], a[228:231], v[196:199], a[48:63]
    ds_read_b64_tr_b16 a[244:245], v25 offset:12288
    ds_read_b64_tr_b16 a[246:247], v25 offset:14336
    v_add_f32 v36, v36, v111
    v_cvt_pk_bf16_f32 v207, v110, v111
    v_max3_f32 v37, v112, v113, v114
    v_max3_f32 v37, v37, v115, v116
    v_max3_f32 v37, v37, v117, v118
    s_waitcnt lgkmcnt(6)
    v_mfma_f32_32x32x16_bf16 a[64:79], a[232:235], v[192:195], a[64:79]
    s_add_u32 m0, s43, 114688
    s_nop 0
    buffer_load_dwordx4 v32, s[16:19], s51 offen offset:0 lds
    v_max3_f32 v37, v37, v119, v120
    v_max3_f32 v37, v37, v121, v122
    v_max3_f32 v37, v37, v123, v124
    v_max3_f32 v37, v37, v125, v126
    v_mfma_f32_32x32x16_bf16 a[80:95], a[232:235], v[196:199], a[80:95]
    ds_read_b64_tr_b16 a[248:249], v26 offset:12288
    ds_read_b64_tr_b16 a[250:251], v26 offset:14336
    v_max3_f32 v37, v37, v127, v144
    v_max3_f32 v37, v37, v145, v146
    v_max3_f32 v37, v37, v147, v148
    v_max3_f32 v37, v37, v149, v150
    s_waitcnt lgkmcnt(6)
    v_mfma_f32_32x32x16_bf16 a[96:111], a[236:239], v[192:195], a[96:111]
    buffer_load_dwordx4 v32, s[16:19], s51 offen offset:1024 lds
    v_max3_f32 v37, v37, v151, v152
    v_max3_f32 v37, v37, v153, v154
    v_max3_f32 v37, v37, v155, v156
    v_max3_f32 v37, v37, v157, v158
    v_mfma_f32_32x32x16_bf16 a[112:127], a[236:239], v[196:199], a[112:127]
    ds_read_b64_tr_b16 a[252:253], v27 offset:12288
    ds_read_b64_tr_b16 a[254:255], v27 offset:14336
    v_max_f32 v37, v37, v159
    v_max3_f32 v38, v128, v129, v130
    v_max3_f32 v38, v38, v131, v132
    v_max3_f32 v38, v38, v133, v134
    v_max3_f32 v38, v38, v135, v136
    s_waitcnt lgkmcnt(6)
    v_mfma_f32_32x32x16_bf16 a[0:15], a[240:243], v[200:203], a[0:15]
    buffer_load_dwordx4 v32, s[16:19], s51 offen offset:2048 lds
    v_max3_f32 v38, v38, v137, v138
    v_max3_f32 v38, v38, v139, v140
    v_max3_f32 v38, v38, v141, v142
    v_max3_f32 v38, v38, v143, v160
    v_mfma_f32_32x32x16_bf16 a[16:31], a[240:243], v[204:207], a[16:31]
    ds_read_b128 a[192:195], v16 offset:32768
    v_max3_f32 v38, v38, v161, v162
    v_max3_f32 v38, v38, v163, v164
    v_max3_f32 v38, v38, v165, v166
    v_max3_f32 v38, v38, v167, v168
    s_waitcnt lgkmcnt(5)
    v_mfma_f32_32x32x16_bf16 a[32:47], a[244:247], v[200:203], a[32:47]
    buffer_load_dwordx4 v32, s[16:19], s51 offen offset:3072 lds
    v_max3_f32 v38, v38, v169, v170
    v_max3_f32 v38, v38, v171, v172
    v_max3_f32 v38, v38, v173, v174
    v_max_f32 v38, v38, v175
    v_mfma_f32_32x32x16_bf16 a[48:63], a[244:247], v[204:207], a[48:63]
    ds_read_b128 a[196:199], v16 offset:40960
    s_waitcnt lgkmcnt(4)
    v_mfma_f32_32x32x16_bf16 a[64:79], a[248:251], v[200:203], a[64:79]
    v_mov_b32 v39, v37
    v_mov_b32 v40, v38
    s_nop 1
    v_permlane32_swap_b32 v37, v39
    v_permlane32_swap_b32 v38, v40
    s_nop 1
    v_max_f32 v37, v37, v39
    v_max_f32 v38, v38, v40
    v_max_f32 v41, v37, v38
    v_cmp_lt_f32 vcc, s52, v41
    v_mfma_f32_32x32x16_bf16 a[80:95], a[248:251], v[204:207], a[80:95]
    ds_read_b128 a[200:203], v17 offset:32768
    s_waitcnt lgkmcnt(3)
    v_mfma_f32_32x32x16_bf16 a[96:111], a[252:255], v[200:203], a[96:111]
    v_mfma_f32_32x32x16_bf16 a[112:127], a[252:255], v[204:207], a[112:127]
    s_add_u32 s53, s53, 1
    s_cmp_eq_u32 s53, 32
    s_cbranch_scc1 attn_kernel_nr0
    s_cbranch_vccnz attn_kernel_rs0
attn_kernel_nr0:
    ds_read_b128 a[204:207], v17 offset:40960
    v_exp_f32 v112, v112
    v_exp_f32 v113, v113
    s_waitcnt lgkmcnt(3)
    v_mfma_f32_32x32x16_bf16 v[48:63], a[192:195], a[128:131], v[208:223]
    v_exp_f32 v114, v114
    v_add_f32 v33, v33, v112
    v_exp_f32 v115, v115
    v_mfma_f32_32x32x16_bf16 v[64:79], a[192:195], a[160:163], v[224:239]
    ds_read_b128 a[208:211], v18 offset:32768
    v_add_f32 v34, v34, v113
    v_cvt_pk_bf16_f32 v176, v112, v113
    v_exp_f32 v116, v116
    s_waitcnt lgkmcnt(3)
    v_mfma_f32_32x32x16_bf16 v[80:95], a[196:199], a[128:131], v[208:223]
    v_add_f32 v33, v33, v114
    v_exp_f32 v117, v117
    v_add_f32 v34, v34, v115
    v_cvt_pk_bf16_f32 v177, v114, v115
    v_mfma_f32_32x32x16_bf16 v[96:111], a[196:199], a[160:163], v[224:239]
    ds_read_b128 a[212:215], v18 offset:40960
    v_exp_f32 v118, v118
    v_add_f32 v33, v33, v116
    s_waitcnt lgkmcnt(3)
    v_mfma_f32_32x32x16_bf16 v[48:63], a[200:203], a[132:135], v[48:63]
    v_exp_f32 v119, v119
    v_add_f32 v34, v34, v117
    v_cvt_pk_bf16_f32 v178, v116, v117
    v_add_f32 v33, v33, v118
    v_mfma_f32_32x32x16_bf16 v[64:79], a[200:203], a[164:167], v[64:79]
    ds_read_b128 a[216:219], v19 offset:32768
    v_add_f32 v34, v34, v119
    v_cvt_pk_bf16_f32 v179, v118, v119
    v_exp_f32 v128, v128
    s_waitcnt lgkmcnt(3)
    v_mfma_f32_32x32x16_bf16 v[80:95], a[204:207], a[132:135], v[80:95]
    v_exp_f32 v129, v129
    v_exp_f32 v130, v130
    v_add_f32 v35, v35, v128
    v_mfma_f32_32x32x16_bf16 v[96:111], a[204:207], a[164:167], v[96:111]
    ds_read_b128 a[220:223], v19 offset:40960
    v_exp_f32 v131, v131
    v_add_f32 v36, v36, v129
    v_cvt_pk_bf16_f32 v180, v128, v129
    s_waitcnt lgkmcnt(3)
    v_mfma_f32_32x32x16_bf16 v[48:63], a[208:211], a[136:139], v[48:63]
    v_exp_f32 v132, v132
    v_add_f32 v35, v35, v130
    v_mfma_f32_32x32x16_bf16 v[64:79], a[208:211], a[168:171], v[64:79]
    ds_read_b128 a[224:227], v20 offset:32768
    v_exp_f32 v133, v133
    v_add_f32 v36, v36, v131
    v_cvt_pk_bf16_f32 v181, v130, v131
    s_waitcnt lgkmcnt(3)
    v_mfma_f32_32x32x16_bf16 v[80:95], a[212:215], a[136:139], v[80:95]
    v_exp_f32 v134, v134
    v_add_f32 v35, v35, v132
    v_exp_f32 v135, v135
    v_add_f32 v36, v36, v133
    v_mfma_f32_32x32x16_bf16 v[96:111], a[212:215], a[168:171], v[96:111]
    ds_read_b128 a[228:231], v20 offset:40960
    v_cvt_pk_bf16_f32 v182, v132, v133
    v_add_f32 v35, v35, v134
    v_add_f32 v36, v36, v135
    v_cvt_pk_bf16_f32 v183, v134, v135
    s_waitcnt lgkmcnt(3)
    v_mfma_f32_32x32x16_bf16 v[48:63], a[216:219], a[140:143], v[48:63]
    v_exp_f32 v120, v120
    v_exp_f32 v121, v121
    v_mfma_f32_32x32x16_bf16 v[64:79], a[216:219], a[172:175], v[64:79]
    ds_read_b128 a[232:235], v21 offset:32768
    v_exp_f32 v122, v122
    v_add_f32 v33, v33, v120
    v_exp_f32 v123, v123
    s_waitcnt lgkmcnt(3)
    v_mfma_f32_32x32x16_bf16 v[80:95], a[220:223], a[140:143], v[80:95]
    v_add_f32 v34, v34, v121
    v_cvt_pk_bf16_f32 v184, v120, v121
    v_exp_f32 v124, v124
    v_mfma_f32_32x32x16_bf16 v[96:111], a[220:223], a[172:175], v[96:111]
    ds_read_b128 a[236:239], v21 offset:40960
    v_add_f32 v33, v33, v122
    v_exp_f32 v125, v125
    v_add_f32 v34, v34, v123
    s_waitcnt lgkmcnt(3)
    v_mfma_f32_32x32x16_bf16 v[48:63], a[224:227], a[144:147], v[48:63]
    v_cvt_pk_bf16_f32 v185, v122, v123
    v_exp_f32 v126, v126
    v_add_f32 v33, v33, v124
    v_mfma_f32_32x32x16_bf16 v[64:79], a[224:227], a[176:179], v[64:79]
    ds_read_b128 a[240:243], v22 offset:32768
    v_exp_f32 v127, v127
    v_add_f32 v34, v34, v125
    v_cvt_pk_bf16_f32 v186, v124, v125
    v_add_f32 v33, v33, v126
    s_waitcnt lgkmcnt(3)
    v_mfma_f32_32x32x16_bf16 v[80:95], a[228:231], a[144:147], v[80:95]
    v_add_f32 v34, v34, v127
    v_cvt_pk_bf16_f32 v187, v126, v127
    v_exp_f32 v136, v136
    v_mfma_f32_32x32x16_bf16 v[96:111], a[228:231], a[176:179], v[96:111]
    ds_read_b128 a[244:247], v22 offset:40960
    v_exp_f32 v137, v137
    v_exp_f32 v138, v138
    s_waitcnt lgkmcnt(3)
    v_mfma_f32_32x32x16_bf16 v[48:63], a[232:235], a[148:151], v[48:63]
    v_add_f32 v35, v35, v136
    v_exp_f32 v139, v139
    v_add_f32 v36, v36, v137
    v_mfma_f32_32x32x16_bf16 v[64:79], a[232:235], a[180:183], v[64:79]
    ds_read_b128 a[248:251], v23 offset:32768
    v_cvt_pk_bf16_f32 v188, v136, v137
    v_exp_f32 v140, v140
    v_add_f32 v35, v35, v138
    s_waitcnt lgkmcnt(3)
    v_mfma_f32_32x32x16_bf16 v[80:95], a[236:239], a[148:151], v[80:95]
    v_exp_f32 v141, v141
    v_add_f32 v36, v36, v139
    v_cvt_pk_bf16_f32 v189, v138, v139
    v_mfma_f32_32x32x16_bf16 v[96:111], a[236:239], a[180:183], v[96:111]
    ds_read_b128 a[252:255], v23 offset:40960
    v_exp_f32 v142, v142
    v_add_f32 v35, v35, v140
    v_exp_f32 v143, v143
    s_waitcnt lgkmcnt(3)
    v_mfma_f32_32x32x16_bf16 v[48:63], a[240:243], a[152:155], v[48:63]
    v_add_f32 v36, v36, v141
    v_cvt_pk_bf16_f32 v190, v140, v141
    v_add_f32 v35, v35, v142
    v_add_f32 v36, v36, v143
    v_mfma_f32_32x32x16_bf16 v[64:79], a[240:243], a[184:187], v[64:79]
    ds_read_b64_tr_b16 a[192:193], v24 offset:16384
    ds_read_b64_tr_b16 a[194:195], v24 offset:18432
    v_cvt_pk_bf16_f32 v191, v142, v143
    v_exp_f32 v144, v144
    v_exp_f32 v145, v145
    s_waitcnt lgkmcnt(4)
    v_mfma_f32_32x32x16_bf16 v[80:95], a[244:247], a[152:155], v[80:95]
    v_exp_f32 v146, v146
    v_add_f32 v33, v33, v144
    v_mfma_f32_32x32x16_bf16 v[96:111], a[244:247], a[184:187], v[96:111]
    ds_read_b64_tr_b16 a[196:197], v25 offset:16384
    ds_read_b64_tr_b16 a[198:199], v25 offset:18432
    v_exp_f32 v147, v147
    v_add_f32 v34, v34, v145
    v_cvt_pk_bf16_f32 v192, v144, v145
    s_waitcnt lgkmcnt(5)
    v_mfma_f32_32x32x16_bf16 v[48:63], a[248:251], a[156:159], v[48:63]
    v_exp_f32 v148, v148
    v_add_f32 v33, v33, v146
    v_exp_f32 v149, v149
    v_add_f32 v34, v34, v147
    v_mfma_f32_32x32x16_bf16 v[64:79], a[248:251], a[188:191], v[64:79]
    ds_read_b64_tr_b16 a[200:201], v26 offset:16384
    ds_read_b64_tr_b16 a[202:203], v26 offset:18432
    v_cvt_pk_bf16_f32 v193, v146, v147
    v_exp_f32 v150, v150
    v_add_f32 v33, v33, v148
    s_waitcnt lgkmcnt(6)
    v_mfma_f32_32x32x16_bf16 v[80:95], a[252:255], a[156:159], v[80:95]
    v_exp_f32 v151, v151
    v_add_f32 v34, v34, v149
    v_cvt_pk_bf16_f32 v194, v148, v149
    v_mfma_f32_32x32x16_bf16 v[96:111], a[252:255], a[188:191], v[96:111]
    ds_read_b64_tr_b16 a[204:205], v27 offset:16384
    ds_read_b64_tr_b16 a[206:207], v27 offset:18432
    v_add_f32 v33, v33, v150
    v_add_f32 v34, v34, v151
    v_cvt_pk_bf16_f32 v195, v150, v151
    s_waitcnt lgkmcnt(6)
    v_mfma_f32_32x32x16_bf16 a[0:15], a[192:195], v[176:179], a[0:15]
    v_exp_f32 v160, v160
    v_exp_f32 v161, v161
    v_exp_f32 v162, v162
    v_mfma_f32_32x32x16_bf16 a[16:31], a[192:195], v[180:183], a[16:31]
    ds_read_b64_tr_b16 a[208:209], v24 offset:20480
    ds_read_b64_tr_b16 a[210:211], v24 offset:22528
    v_add_f32 v35, v35, v160
    v_exp_f32 v163, v163
    v_add_f32 v36, v36, v161
    s_waitcnt lgkmcnt(6)
    v_mfma_f32_32x32x16_bf16 a[32:47], a[196:199], v[176:179], a[32:47]
    v_cvt_pk_bf16_f32 v196, v160, v161
    v_exp_f32 v164, v164
    v_add_f32 v35, v35, v162
    v_mfma_f32_32x32x16_bf16 a[48:63], a[196:199], v[180:183], a[48:63]
    ds_read_b64_tr_b16 a[212:213], v25 offset:20480
    ds_read_b64_tr_b16 a[214:215], v25 offset:22528
    v_exp_f32 v165, v165
    v_add_f32 v36, v36, v163
    v_cvt_pk_bf16_f32 v197, v162, v163
    s_waitcnt lgkmcnt(6)
    v_mfma_f32_32x32x16_bf16 a[64:79], a[200:203], v[176:179], a[64:79]
    v_exp_f32 v166, v166
    v_add_f32 v35, v35, v164
    v_exp_f32 v167, v167
    v_mfma_f32_32x32x16_bf16 a[80:95], a[200:203], v[180:183], a[80:95]
    ds_read_b64_tr_b16 a[216:217], v26 offset:20480
    ds_read_b64_tr_b16 a[218:219], v26 offset:22528
    v_add_f32 v36, v36, v165
    v_cvt_pk_bf16_f32 v198, v164, v165
    v_add_f32 v35, v35, v166
    v_add_f32 v36, v36, v167
    s_waitcnt lgkmcnt(6)
    v_mfma_f32_32x32x16_bf16 a[96:111], a[204:207], v[176:179], a[96:111]
    v_cvt_pk_bf16_f32 v199, v166, v167
    v_exp_f32 v152, v152
    v_mfma_f32_32x32x16_bf16 a[112:127], a[204:207], v[180:183], a[112:127]
    ds_read_b64_tr_b16 a[220:221], v27 offset:20480
    ds_read_b64_tr_b16 a[222:223], v27 offset:22528
    v_exp_f32 v153, v153
    v_exp_f32 v154, v154
    v_add_f32 v33, v33, v152
    s_waitcnt lgkmcnt(6)
    v_mfma_f32_32x32x16_bf16 a[0:15], a[208:211], v[184:187], a[0:15]
    v_exp_f32 v155, v155
    v_add_f32 v34, v34, v153
    v_cvt_pk_bf16_f32 v200, v152, v153
    v_mfma_f32_32x32x16_bf16 a[16:31], a[208:211], v[188:191], a[16:31]
    ds_read_b64_tr_b16 a[224:225], v24 offset:24576
    ds_read_b64_tr_b16 a[226:227], v24 offset:26624
    v_exp_f32 v156, v156
    v_add_f32 v33, v33, v154
    v_exp_f32 v157, v157
    s_waitcnt lgkmcnt(6)
    v_mfma_f32_32x32x16_bf16 a[32:47], a[212:215], v[184:187], a[32:47]
    v_add_f32 v34, v34, v155
    v_cvt_pk_bf16_f32 v201, v154, v155
    v_exp_f32 v158, v158
    v_mfma_f32_32x32x16_bf16 a[48:63], a[212:215], v[188:191], a[48:63]
    s_waitcnt vmcnt(8)
    s_barrier
    s_add_u32 s50, s50, 16384
    s_add_u32 s51, s51, 16384
    ds_read_b64_tr_b16 a[228:229], v25 offset:24576
    ds_read_b64_tr_b16 a[230:231], v25 offset:26624
    v_add_f32 v33, v33, v156
    v_exp_f32 v159, v159
    v_add_f32 v34, v34, v157
    v_cvt_pk_bf16_f32 v202, v156, v157
    s_waitcnt lgkmcnt(6)
    v_mfma_f32_32x32x16_bf16 a[64:79], a[216:219], v[184:187], a[64:79]
    s_add_u32 m0, s43, 32768
    s_nop 0
    buffer_load_dwordx4 v28, s[12:15], s50 offen offset:0 lds
    v_add_f32 v33, v33, v158
    v_add_f32 v34, v34, v159
    v_cvt_pk_bf16_f32 v203, v158, v159
    v_mfma_f32_32x32x16_bf16 a[80:95], a[216:219], v[188:191], a[80:95]
    ds_read_b64_tr_b16 a[232:233], v26 offset:24576
    ds_read_b64_tr_b16 a[234:235], v26 offset:26624
    v_exp_f32 v168, v168
    v_exp_f32 v169, v169
    s_waitcnt lgkmcnt(6)
    v_mfma_f32_32x32x16_bf16 a[96:111], a[220:223], v[184:187], a[96:111]
    buffer_load_dwordx4 v29, s[12:15], s50 offen offset:1024 lds
    v_exp_f32 v170, v170
    v_add_f32 v35, v35, v168
    v_exp_f32 v171, v171
    v_mfma_f32_32x32x16_bf16 a[112:127], a[220:223], v[188:191], a[112:127]
    ds_read_b64_tr_b16 a[236:237], v27 offset:24576
    ds_read_b64_tr_b16 a[238:239], v27 offset:26624
    v_add_f32 v36, v36, v169
    v_cvt_pk_bf16_f32 v204, v168, v169
    v_exp_f32 v172, v172
    v_add_f32 v35, v35, v170
    s_waitcnt lgkmcnt(6)
    v_mfma_f32_32x32x16_bf16 a[0:15], a[224:227], v[192:195], a[0:15]
    buffer_load_dwordx4 v30, s[12:15], s50 offen offset:2048 lds
    v_exp_f32 v173, v173
    v_add_f32 v36, v36, v171
    v_cvt_pk_bf16_f32 v205, v170, v171
    v_mfma_f32_32x32x16_bf16 a[16:31], a[224:227], v[196:199], a[16:31]
    ds_read_b64_tr_b16 a[240:241], v24 offset:28672
    ds_read_b64_tr_b16 a[242:243], v24 offset:30720
    v_exp_f32 v174, v174
    v_add_f32 v35, v35, v172
    s_waitcnt lgkmcnt(6)
    v_mfma_f32_32x32x16_bf16 a[32:47], a[228:231], v[192:195], a[32:47]
    buffer_load_dwordx4 v31, s[12:15], s50 offen offset:3072 lds
    v_exp_f32 v175, v175
    v_add_f32 v36, v36, v173
    v_cvt_pk_bf16_f32 v206, v172, v173
    v_add_f32 v35, v35, v174
    v_mfma_f32_32x32x16_bf16 a[48:63], a[228:231], v[196:199], a[48:63]
    ds_read_b64_tr_b16 a[244:245], v25 offset:28672
    ds_read_b64_tr_b16 a[246:247], v25 offset:30720
    v_add_f32 v36, v36, v175
    v_cvt_pk_bf16_f32 v207, v174, v175
    v_max3_f32 v37, v48, v49, v50
    v_max3_f32 v37, v37, v51, v52
    v_max3_f32 v37, v37, v53, v54
    s_waitcnt lgkmcnt(6)
    v_mfma_f32_32x32x16_bf16 a[64:79], a[232:235], v[192:195], a[64:79]
    s_add_u32 m0, s43, 65536
    s_nop 0
    buffer_load_dwordx4 v32, s[16:19], s51 offen offset:0 lds
    v_max3_f32 v37, v37, v55, v56
    v_max3_f32 v37, v37, v57, v58
    v_max3_f32 v37, v37, v59, v60
    v_max3_f32 v37, v37, v61, v62
    v_mfma_f32_32x32x16_bf16 a[80:95], a[232:235], v[196:199], a[80:95]
    ds_read_b64_tr_b16 a[248:249], v26 offset:28672
    ds_read_b64_tr_b16 a[250:251], v26 offset:30720
    v_max3_f32 v37, v37, v63, v80
    v_max3_f32 v37, v37, v81, v82
    v_max3_f32 v37, v37, v83, v84
    v_max3_f32 v37, v37, v85, v86
    s_waitcnt lgkmcnt(6)
    v_mfma_f32_32x32x16_bf16 a[96:111], a[236:239], v[192:195], a[96:111]
    buffer_load_dwordx4 v32, s[16:19], s51 offen offset:1024 lds
    v_max3_f32 v37, v37, v87, v88
    v_max3_f32 v37, v37, v89, v90
    v_max3_f32 v37, v37, v91, v92
    v_max3_f32 v37, v37, v93, v94
    v_mfma_f32_32x32x16_bf16 a[112:127], a[236:239], v[196:199], a[112:127]
    ds_read_b64_tr_b16 a[252:253], v27 offset:28672
    ds_read_b64_tr_b16 a[254:255], v27 offset:30720
    v_max_f32 v37, v37, v95
    v_max3_f32 v38, v64, v65, v66
    v_max3_f32 v38, v38, v67, v68
    v_max3_f32 v38, v38, v69, v70
    v_max3_f32 v38, v38, v71, v72
    s_waitcnt lgkmcnt(6)
    v_mfma_f32_32x32x16_bf16 a[0:15], a[240:243], v[200:203], a[0:15]
    buffer_load_dwordx4 v32, s[16:19], s51 offen offset:2048 lds
    v_max3_f32 v38, v38, v73, v74
    v_max3_f32 v38, v38, v75, v76
    v_max3_f32 v38, v38, v77, v78
    v_max3_f32 v38, v38, v79, v96
    v_mfma_f32_32x32x16_bf16 a[16:31], a[240:243], v[204:207], a[16:31]
    ds_read_b128 a[192:195], v16 offset:49152
    v_max3_f32 v38, v38, v97, v98
    v_max3_f32 v38, v38, v99, v100
    v_max3_f32 v38, v38, v101, v102
    v_max3_f32 v38, v38, v103, v104
    s_waitcnt lgkmcnt(5)
    v_mfma_f32_32x32x16_bf16 a[32:47], a[244:247], v[200:203], a[32:47]
    buffer_load_dwordx4 v32, s[16:19], s51 offen offset:3072 lds
    v_max3_f32 v38, v38, v105, v106
    v_max3_f32 v38, v38, v107, v108
    v_max3_f32 v38, v38, v109, v110
    v_max_f32 v38, v38, v111
    v_mfma_f32_32x32x16_bf16 a[48:63], a[244:247], v[204:207], a[48:63]
    ds_read_b128 a[196:199], v16 offset:57344
    s_waitcnt lgkmcnt(4)
    v_mfma_f32_32x32x16_bf16 a[64:79], a[248:251], v[200:203], a[64:79]
    v_mov_b32 v39, v37
    v_mov_b32 v40, v38
    s_nop 1
    v_permlane32_swap_b32 v37, v39
    v_permlane32_swap_b32 v38, v40
    s_nop 1
    v_max_f32 v37, v37, v39
    v_max_f32 v38, v38, v40
    v_max_f32 v41, v37, v38
    v_cmp_lt_f32 vcc, s52, v41
    v_mfma_f32_32x32x16_bf16 a[80:95], a[248:251], v[204:207], a[80:95]
    ds_read_b128 a[200:203], v17 offset:49152
    s_waitcnt lgkmcnt(3)
    v_mfma_f32_32x32x16_bf16 a[96:111], a[252:255], v[200:203], a[96:111]
    v_mfma_f32_32x32x16_bf16 a[112:127], a[252:255], v[204:207], a[112:127]
    s_add_u32 s53, s53, 1
    s_cmp_eq_u32 s53, 32
    s_cbranch_scc1 attn_kernel_nr1
    s_cbranch_vccnz attn_kernel_rs1
attn_kernel_nr1:
    s_cmp_eq_u32 s53, 2
    s_cbranch_scc1 attn_kernel_pf
attn_kernel_pfret:
    ds_read_b128 a[204:207], v17 offset:57344
    v_exp_f32 v48, v48
    v_exp_f32 v49, v49
    s_waitcnt lgkmcnt(3)
    v_mfma_f32_32x32x16_bf16 v[112:127], a[192:195], a[128:131], v[208:223]
    v_exp_f32 v50, v50
    v_add_f32 v33, v33, v48
    v_exp_f32 v51, v51
    v_mfma_f32_32x32x16_bf16 v[128:143], a[192:195], a[160:163], v[224:239]
    ds_read_b128 a[208:211], v18 offset:49152
    v_add_f32 v34, v34, v49
    v_cvt_pk_bf16_f32 v176, v48, v49
    v_exp_f32 v52, v52
    s_waitcnt lgkmcnt(3)
    v_mfma_f32_32x32x16_bf16 v[144:159], a[196:199], a[128:131], v[208:223]
    v_add_f32 v33, v33, v50
    v_exp_f32 v53, v53
    v_add_f32 v34, v34, v51
    v_cvt_pk_bf16_f32 v177, v50, v51
    v_mfma_f32_32x32x16_bf16 v[160:175], a[196:199], a[160:163], v[224:239]
    ds_read_b128 a[212:215], v18 offset:57344
    v_exp_f32 v54, v54
    v_add_f32 v33, v33, v52
    s_waitcnt lgkmcnt(3)
    v_mfma_f32_32x32x16_bf16 v[112:127], a[200:203], a[132:135], v[112:127]
    v_exp_f32 v55, v55
    v_add_f32 v34, v34, v53
    v_cvt_pk_bf16_f32 v178, v52, v53
    v_add_f32 v33, v33, v54
    v_mfma_f32_32x32x16_bf16 v[128:143], a[200:203], a[164:167], v[128:143]
    ds_read_b128 a[216:219], v19 offset:49152
    v_add_f32 v34, v34, v55
    v_cvt_pk_bf16_f32 v179, v54, v55
    v_exp_f32 v64, v64
    s_waitcnt lgkmcnt(3)
    v_mfma_f32_32x32x16_bf16 v[144:159], a[204:207], a[132:135], v[144:159]
    v_exp_f32 v65, v65
    v_exp_f32 v66, v66
    v_add_f32 v35, v35, v64
    v_mfma_f32_32x32x16_bf16 v[160:175], a[204:207], a[164:167], v[160:175]
    ds_read_b128 a[220:223], v19 offset:57344
    v_exp_f32 v67, v67
    v_add_f32 v36, v36, v65
    v_cvt_pk_bf16_f32 v180, v64, v65
    s_waitcnt lgkmcnt(3)
    v_mfma_f32_32x32x16_bf16 v[112:127], a[208:211], a[136:139], v[112:127]
    v_exp_f32 v68, v68
    v_add_f32 v35, v35, v66
    v_mfma_f32_32x32x16_bf16 v[128:143], a[208:211], a[168:171], v[128:143]
    ds_read_b128 a[224:227], v20 offset:49152
    v_exp_f32 v69, v69
    v_add_f32 v36, v36, v67
    v_cvt_pk_bf16_f32 v181, v66, v67
    s_waitcnt lgkmcnt(3)
    v_mfma_f32_32x32x16_bf16 v[144:159], a[212:215], a[136:139], v[144:159]
    v_exp_f32 v70, v70
    v_add_f32 v35, v35, v68
    v_exp_f32 v71, v71
    v_add_f32 v36, v36, v69
    v_mfma_f32_32x32x16_bf16 v[160:175], a[212:215], a[168:171], v[160:175]
    ds_read_b128 a[228:231], v20 offset:57344
    v_cvt_pk_bf16_f32 v182, v68, v69
    v_add_f32 v35, v35, v70
    v_add_f32 v36, v36, v71
    v_cvt_pk_bf16_f32 v183, v70, v71
    s_waitcnt lgkmcnt(3)
    v_mfma_f32_32x32x16_bf16 v[112:127], a[216:219], a[140:143], v[112:127]
    v_exp_f32 v56, v56
    v_exp_f32 v57, v57
    v_mfma_f32_32x32x16_bf16 v[128:143], a[216:219], a[172:175], v[128:143]
    ds_read_b128 a[232:235], v21 offset:49152
    v_exp_f32 v58, v58
    v_add_f32 v33, v33, v56
    v_exp_f32 v59, v59
    s_waitcnt lgkmcnt(3)
    v_mfma_f32_32x32x16_bf16 v[144:159], a[220:223], a[140:143], v[144:159]
    v_add_f32 v34, v34, v57
    v_cvt_pk_bf16_f32 v184, v56, v57
    v_exp_f32 v60, v60
    v_mfma_f32_32x32x16_bf16 v[160:175], a[220:223], a[172:175], v[160:175]
    ds_read_b128 a[236:239], v21 offset:57344
    v_add_f32 v33, v33, v58
    v_exp_f32 v61, v61
    v_add_f32 v34, v34, v59
    s_waitcnt lgkmcnt(3)
    v_mfma_f32_32x32x16_bf16 v[112:127], a[224:227], a[144:147], v[112:127]
    v_cvt_pk_bf16_f32 v185, v58, v59
    v_exp_f32 v62, v62
    v_add_f32 v33, v33, v60
    v_mfma_f32_32x32x16_bf16 v[128:143], a[224:227], a[176:179], v[128:143]
    ds_read_b128 a[240:243], v22 offset:49152
    v_exp_f32 v63, v63
    v_add_f32 v34, v34, v61
    v_cvt_pk_bf16_f32 v186, v60, v61
    v_add_f32 v33, v33, v62
    s_waitcnt lgkmcnt(3)
    v_mfma_f32_32x32x16_bf16 v[144:159], a[228:231], a[144:147], v[144:159]
    v_add_f32 v34, v34, v63
    v_cvt_pk_bf16_f32 v187, v62, v63
    v_exp_f32 v72, v72
    v_mfma_f32_32x32x16_bf16 v[160:175], a[228:231], a[176:179], v[160:175]
    ds_read_b128 a[244:247], v22 offset:57344
    v_exp_f32 v73, v73
    v_exp_f32 v74, v74
    s_waitcnt lgkmcnt(3)
    v_mfma_f32_32x32x16_bf16 v[112:127], a[232:235], a[148:151], v[112:127]
    v_add_f32 v35, v35, v72
    v_exp_f32 v75, v75
    v_add_f32 v36, v36, v73
    v_mfma_f32_32x32x16_bf16 v[128:143], a[232:235], a[180:183], v[128:143]
    ds_read_b128 a[248:251], v23 offset:49152
    v_cvt_pk_bf16_f32 v188, v72, v73
    v_exp_f32 v76, v76
    v_add_f32 v35, v35, v74
    s_waitcnt lgkmcnt(3)
    v_mfma_f32_32x32x16_bf16 v[144:159], a[236:239], a[148:151], v[144:159]
    v_exp_f32 v77, v77
    v_add_f32 v36, v36, v75
    v_cvt_pk_bf16_f32 v189, v74, v75
    v_mfma_f32_32x32x16_bf16 v[160:175], a[236:239], a[180:183], v[160:175]
    ds_read_b128 a[252:255], v23 offset:57344
    v_exp_f32 v78, v78
    v_add_f32 v35, v35, v76
    v_exp_f32 v79, v79
    s_waitcnt lgkmcnt(3)
    v_mfma_f32_32x32x16_bf16 v[112:127], a[240:243], a[152:155], v[112:127]
    v_add_f32 v36, v36, v77
    v_cvt_pk_bf16_f32 v190, v76, v77
    v_add_f32 v35, v35, v78
    v_add_f32 v36, v36, v79
    v_mfma_f32_32x32x16_bf16 v[128:143], a[240:243], a[184:187], v[128:143]
    ds_read_b64_tr_b16 a[192:193], v24 offset:32768
    ds_read_b64_tr_b16 a[194:195], v24 offset:34816
    v_cvt_pk_bf16_f32 v191, v78, v79
    v_exp_f32 v80, v80
    v_exp_f32 v81, v81
    s_waitcnt lgkmcnt(4)
    v_mfma_f32_32x32x16_bf16 v[144:159], a[244:247], a[152:155], v[144:159]
    v_exp_f32 v82, v82
    v_add_f32 v33, v33, v80
    v_mfma_f32_32x32x16_bf16 v[160:175], a[244:247], a[184:187], v[160:175]
    ds_read_b64_tr_b16 a[196:197], v25 offset:32768
    ds_read_b64_tr_b16 a[198:199], v25 offset:34816
    v_exp_f32 v83, v83
    v_add_f32 v34, v34, v81
    v_cvt_pk_bf16_f32 v192, v80, v81
    s_waitcnt lgkmcnt(5)
    v_mfma_f32_32x32x16_bf16 v[112:127], a[248:251], a[156:159], v[112:127]
    v_exp_f32 v84, v84
    v_add_f32 v33, v33, v82
    v_exp_f32 v85, v85
    v_add_f32 v34, v34, v83
    v_mfma_f32_32x32x16_bf16 v[128:143], a[248:251], a[188:191], v[128:143]
    ds_read_b64_tr_b16 a[200:201], v26 offset:32768
    ds_read_b64_tr_b16 a[202:203], v26 offset:34816
    v_cvt_pk_bf16_f32 v193, v82, v83
    v_exp_f32 v86, v86
    v_add_f32 v33, v33, v84
    s_waitcnt lgkmcnt(6)
    v_mfma_f32_32x32x16_bf16 v[144:159], a[252:255], a[156:159], v[144:159]
    v_exp_f32 v87, v87
    v_add_f32 v34, v34, v85
    v_cvt_pk_bf16_f32 v194, v84, v85
    v_mfma_f32_32x32x16_bf16 v[160:175], a[252:255], a[188:191], v[160:175]
    ds_read_b64_tr_b16 a[204:205], v27 offset:32768
    ds_read_b64_tr_b16 a[206:207], v27 offset:34816
    v_add_f32 v33, v33, v86
    v_add_f32 v34, v34, v87
    v_cvt_pk_bf16_f32 v195, v86, v87
    s_waitcnt lgkmcnt(6)
    v_mfma_f32_32x32x16_bf16 a[0:15], a[192:195], v[176:179], a[0:15]
    v_exp_f32 v96, v96
    v_exp_f32 v97, v97
    v_exp_f32 v98, v98
    v_mfma_f32_32x32x16_bf16 a[16:31], a[192:195], v[180:183], a[16:31]
    ds_read_b64_tr_b16 a[208:209], v24 offset:36864
    ds_read_b64_tr_b16 a[210:211], v24 offset:38912
    v_add_f32 v35, v35, v96
    v_exp_f32 v99, v99
    v_add_f32 v36, v36, v97
    s_waitcnt lgkmcnt(6)
    v_mfma_f32_32x32x16_bf16 a[32:47], a[196:199], v[176:179], a[32:47]
    v_cvt_pk_bf16_f32 v196, v96, v97
    v_exp_f32 v100, v100
    v_add_f32 v35, v35, v98
    v_mfma_f32_32x32x16_bf16 a[48:63], a[196:199], v[180:183], a[48:63]
    ds_read_b64_tr_b16 a[212:213], v25 offset:36864
    ds_read_b64_tr_b16 a[214:215], v25 offset:38912
    v_exp_f32 v101, v101
    v_add_f32 v36, v36, v99
    v_cvt_pk_bf16_f32 v197, v98, v99
    s_waitcnt lgkmcnt(6)
    v_mfma_f32_32x32x16_bf16 a[64:79], a[200:203], v[176:179], a[64:79]
    v_exp_f32 v102, v102
    v_add_f32 v35, v35, v100
    v_exp_f32 v103, v103
    v_mfma_f32_32x32x16_bf16 a[80:95], a[200:203], v[180:183], a[80:95]
    ds_read_b64_tr_b16 a[216:217], v26 offset:36864
    ds_read_b64_tr_b16 a[218:219], v26 offset:38912
    v_add_f32 v36, v36, v101
    v_cvt_pk_bf16_f32 v198, v100, v101
    v_add_f32 v35, v35, v102
    v_add_f32 v36, v36, v103
    s_waitcnt lgkmcnt(6)
    v_mfma_f32_32x32x16_bf16 a[96:111], a[204:207], v[176:179], a[96:111]
    v_cvt_pk_bf16_f32 v199, v102, v103
    v_exp_f32 v88, v88
    v_mfma_f32_32x32x16_bf16 a[112:127], a[204:207], v[180:183], a[112:127]
    ds_read_b64_tr_b16 a[220:221], v27 offset:36864
    ds_read_b64_tr_b16 a[222:223], v27 offset:38912
    v_exp_f32 v89, v89
    v_exp_f32 v90, v90
    v_add_f32 v33, v33, v88
    s_waitcnt lgkmcnt(6)
    v_mfma_f32_32x32x16_bf16 a[0:15], a[208:211], v[184:187], a[0:15]
    v_exp_f32 v91, v91
    v_add_f32 v34, v34, v89
    v_cvt_pk_bf16_f32 v200, v88, v89
    v_mfma_f32_32x32x16_bf16 a[16:31], a[208:211], v[188:191], a[16:31]
    ds_read_b64_tr_b16 a[224:225], v24 offset:40960
    ds_read_b64_tr_b16 a[226:227], v24 offset:43008
    v_exp_f32 v92, v92
    v_add_f32 v33, v33, v90
    v_exp_f32 v93, v93
    s_waitcnt lgkmcnt(6)
    v_mfma_f32_32x32x16_bf16 a[32:47], a[212:215], v[184:187], a[32:47]
    v_add_f32 v34, v34, v91
    v_cvt_pk_bf16_f32 v201, v90, v91
    v_exp_f32 v94, v94
    v_mfma_f32_32x32x16_bf16 a[48:63], a[212:215], v[188:191], a[48:63]
    s_waitcnt vmcnt(8)
    s_barrier
    s_add_u32 s50, s50, 16384
    s_add_u32 s51, s51, 16384
    ds_read_b64_tr_b16 a[228:229], v25 offset:40960
    ds_read_b64_tr_b16 a[230:231], v25 offset:43008
    v_add_f32 v33, v33, v92
    v_exp_f32 v95, v95
    v_add_f32 v34, v34, v93
    v_cvt_pk_bf16_f32 v202, v92, v93
    s_waitcnt lgkmcnt(6)
    v_mfma_f32_32x32x16_bf16 a[64:79], a[216:219], v[184:187], a[64:79]
    s_add_u32 m0, s43, 49152
    s_nop 0
    buffer_load_dwordx4 v28, s[12:15], s50 offen offset:0 lds
    v_add_f32 v33, v33, v94
    v_add_f32 v34, v34, v95
    v_cvt_pk_bf16_f32 v203, v94, v95
    v_mfma_f32_32x32x16_bf16 a[80:95], a[216:219], v[188:191], a[80:95]
    ds_read_b64_tr_b16 a[232:233], v26 offset:40960
    ds_read_b64_tr_b16 a[234:235], v26 offset:43008
    v_exp_f32 v104, v104
    v_exp_f32 v105, v105
    s_waitcnt lgkmcnt(6)
    v_mfma_f32_32x32x16_bf16 a[96:111], a[220:223], v[184:187], a[96:111]
    buffer_load_dwordx4 v29, s[12:15], s50 offen offset:1024 lds
    v_exp_f32 v106, v106
    v_add_f32 v35, v35, v104
    v_exp_f32 v107, v107
    v_mfma_f32_32x32x16_bf16 a[112:127], a[220:223], v[188:191], a[112:127]
    ds_read_b64_tr_b16 a[236:237], v27 offset:40960
    ds_read_b64_tr_b16 a[238:239], v27 offset:43008
    v_add_f32 v36, v36, v105
    v_cvt_pk_bf16_f32 v204, v104, v105
    v_exp_f32 v108, v108
    v_add_f32 v35, v35, v106
    s_waitcnt lgkmcnt(6)
    v_mfma_f32_32x32x16_bf16 a[0:15], a[224:227], v[192:195], a[0:15]
    buffer_load_dwordx4 v30, s[12:15], s50 offen offset:2048 lds
    v_exp_f32 v109, v109
    v_add_f32 v36, v36, v107
    v_cvt_pk_bf16_f32 v205, v106, v107
    v_mfma_f32_32x32x16_bf16 a[16:31], a[224:227], v[196:199], a[16:31]
    ds_read_b64_tr_b16 a[240:241], v24 offset:45056
    ds_read_b64_tr_b16 a[242:243], v24 offset:47104
    v_exp_f32 v110, v110
    v_add_f32 v35, v35, v108
    s_waitcnt lgkmcnt(6)
    v_mfma_f32_32x32x16_bf16 a[32:47], a[228:231], v[192:195], a[32:47]
    buffer_load_dwordx4 v31, s[12:15], s50 offen offset:3072 lds
    v_exp_f32 v111, v111
    v_add_f32 v36, v36, v109
    v_cvt_pk_bf16_f32 v206, v108, v109
    v_add_f32 v35, v35, v110
    v_mfma_f32_32x32x16_bf16 a[48:63], a[228:231], v[196:199], a[48:63]
    ds_read_b64_tr_b16 a[244:245], v25 offset:45056
    ds_read_b64_tr_b16 a[246:247], v25 offset:47104
    v_add_f32 v36, v36, v111
    v_cvt_pk_bf16_f32 v207, v110, v111
    v_max3_f32 v37, v112, v113, v114
    v_max3_f32 v37, v37, v115, v116
    v_max3_f32 v37, v37, v117, v118
    s_waitcnt lgkmcnt(6)
    v_mfma_f32_32x32x16_bf16 a[64:79], a[232:235], v[192:195], a[64:79]
    s_add_u32 m0, s43, 81920
    s_nop 0
    buffer_load_dwordx4 v32, s[16:19], s51 offen offset:0 lds
    v_max3_f32 v37, v37, v119, v120
    v_max3_f32 v37, v37, v121, v122
    v_max3_f32 v37, v37, v123, v124
    v_max3_f32 v37, v37, v125, v126
    v_mfma_f32_32x32x16_bf16 a[80:95], a[232:235], v[196:199], a[80:95]
    ds_read_b64_tr_b16 a[248:249], v26 offset:45056
    ds_read_b64_tr_b16 a[250:251], v26 offset:47104
    v_max3_f32 v37, v37, v127, v144
    v_max3_f32 v37, v37, v145, v146
    v_max3_f32 v37, v37, v147, v148
    v_max3_f32 v37, v37, v149, v150
    s_waitcnt lgkmcnt(6)
    v_mfma_f32_32x32x16_bf16 a[96:111], a[236:239], v[192:195], a[96:111]
    buffer_load_dwordx4 v32, s[16:19], s51 offen offset:1024 lds
    v_max3_f32 v37, v37, v151, v152
    v_max3_f32 v37, v37, v153, v154
    v_max3_f32 v37, v37, v155, v156
    v_max3_f32 v37, v37, v157, v158
    v_mfma_f32_32x32x16_bf16 a[112:127], a[236:239], v[196:199], a[112:127]
    ds_read_b64_tr_b16 a[252:253], v27 offset:45056
    ds_read_b64_tr_b16 a[254:255], v27 offset:47104
    v_max_f32 v37, v37, v159
    v_max3_f32 v38, v128, v129, v130
    v_max3_f32 v38, v38, v131, v132
    v_max3_f32 v38, v38, v133, v134
    v_max3_f32 v38, v38, v135, v136
    s_waitcnt lgkmcnt(6)
    v_mfma_f32_32x32x16_bf16 a[0:15], a[240:243], v[200:203], a[0:15]
    buffer_load_dwordx4 v32, s[16:19], s51 offen offset:2048 lds
    v_max3_f32 v38, v38, v137, v138
    v_max3_f32 v38, v38, v139, v140
    v_max3_f32 v38, v38, v141, v142
    v_max3_f32 v38, v38, v143, v160
    v_mfma_f32_32x32x16_bf16 a[16:31], a[240:243], v[204:207], a[16:31]
    ds_read_b128 a[192:195], v16 offset:0
    v_max3_f32 v38, v38, v161, v162
    v_max3_f32 v38, v38, v163, v164
    v_max3_f32 v38, v38, v165, v166
    v_max3_f32 v38, v38, v167, v168
    s_waitcnt lgkmcnt(5)
    v_mfma_f32_32x32x16_bf16 a[32:47], a[244:247], v[200:203], a[32:47]
    buffer_load_dwordx4 v32, s[16:19], s51 offen offset:3072 lds
    v_max3_f32 v38, v38, v169, v170
    v_max3_f32 v38, v38, v171, v172
    v_max3_f32 v38, v38, v173, v174
    v_max_f32 v38, v38, v175
    v_mfma_f32_32x32x16_bf16 a[48:63], a[244:247], v[204:207], a[48:63]
    ds_read_b128 a[196:199], v16 offset:8192
    s_waitcnt lgkmcnt(4)
    v_mfma_f32_32x32x16_bf16 a[64:79], a[248:251], v[200:203], a[64:79]
    v_mov_b32 v39, v37
    v_mov_b32 v40, v38
    s_nop 1
    v_permlane32_swap_b32 v37, v39
    v_permlane32_swap_b32 v38, v40
    s_nop 1
    v_max_f32 v37, v37, v39
    v_max_f32 v38, v38, v40
    v_max_f32 v41, v37, v38
    v_cmp_lt_f32 vcc, s52, v41
    v_mfma_f32_32x32x16_bf16 a[80:95], a[248:251], v[204:207], a[80:95]
    ds_read_b128 a[200:203], v17 offset:0
    s_waitcnt lgkmcnt(3)
    v_mfma_f32_32x32x16_bf16 a[96:111], a[252:255], v[200:203], a[96:111]
    v_mfma_f32_32x32x16_bf16 a[112:127], a[252:255], v[204:207], a[112:127]
    s_add_u32 s53, s53, 1
    s_cmp_eq_u32 s53, 32
    s_cbranch_scc1 attn_kernel_nr2
    s_cbranch_vccnz attn_kernel_rs2
attn_kernel_nr2:
    ds_read_b128 a[204:207], v17 offset:8192
    v_exp_f32 v112, v112
    v_exp_f32 v113, v113
    s_waitcnt lgkmcnt(3)
    v_mfma_f32_32x32x16_bf16 v[48:63], a[192:195], a[128:131], v[208:223]
    v_exp_f32 v114, v114
    v_add_f32 v33, v33, v112
    v_exp_f32 v115, v115
    v_mfma_f32_32x32x16_bf16 v[64:79], a[192:195], a[160:163], v[224:239]
    ds_read_b128 a[208:211], v18 offset:0
    v_add_f32 v34, v34, v113
    v_cvt_pk_bf16_f32 v176, v112, v113
    v_exp_f32 v116, v116
    s_waitcnt lgkmcnt(3)
    v_mfma_f32_32x32x16_bf16 v[80:95], a[196:199], a[128:131], v[208:223]
    v_add_f32 v33, v33, v114
    v_exp_f32 v117, v117
    v_add_f32 v34, v34, v115
    v_cvt_pk_bf16_f32 v177, v114, v115
    v_mfma_f32_32x32x16_bf16 v[96:111], a[196:199], a[160:163], v[224:239]
    ds_read_b128 a[212:215], v18 offset:8192
    v_exp_f32 v118, v118
    v_add_f32 v33, v33, v116
    s_waitcnt lgkmcnt(3)
    v_mfma_f32_32x32x16_bf16 v[48:63], a[200:203], a[132:135], v[48:63]
    v_exp_f32 v119, v119
    v_add_f32 v34, v34, v117
    v_cvt_pk_bf16_f32 v178, v116, v117
    v_add_f32 v33, v33, v118
    v_mfma_f32_32x32x16_bf16 v[64:79], a[200:203], a[164:167], v[64:79]
    ds_read_b128 a[216:219], v19 offset:0
    v_add_f32 v34, v34, v119
    v_cvt_pk_bf16_f32 v179, v118, v119
    v_exp_f32 v128, v128
    s_waitcnt lgkmcnt(3)
    v_mfma_f32_32x32x16_bf16 v[80:95], a[204:207], a[132:135], v[80:95]
    v_exp_f32 v129, v129
    v_exp_f32 v130, v130
    v_add_f32 v35, v35, v128
    v_mfma_f32_32x32x16_bf16 v[96:111], a[204:207], a[164:167], v[96:111]
    ds_read_b128 a[220:223], v19 offset:8192
    v_exp_f32 v131, v131
    v_add_f32 v36, v36, v129
    v_cvt_pk_bf16_f32 v180, v128, v129
    s_waitcnt lgkmcnt(3)
    v_mfma_f32_32x32x16_bf16 v[48:63], a[208:211], a[136:139], v[48:63]
    v_exp_f32 v132, v132
    v_add_f32 v35, v35, v130
    v_mfma_f32_32x32x16_bf16 v[64:79], a[208:211], a[168:171], v[64:79]
    ds_read_b128 a[224:227], v20 offset:0
    v_exp_f32 v133, v133
    v_add_f32 v36, v36, v131
    v_cvt_pk_bf16_f32 v181, v130, v131
    s_waitcnt lgkmcnt(3)
    v_mfma_f32_32x32x16_bf16 v[80:95], a[212:215], a[136:139], v[80:95]
    v_exp_f32 v134, v134
    v_add_f32 v35, v35, v132
    v_exp_f32 v135, v135
    v_add_f32 v36, v36, v133
    v_mfma_f32_32x32x16_bf16 v[96:111], a[212:215], a[168:171], v[96:111]
    ds_read_b128 a[228:231], v20 offset:8192
    v_cvt_pk_bf16_f32 v182, v132, v133
    v_add_f32 v35, v35, v134
    v_add_f32 v36, v36, v135
    v_cvt_pk_bf16_f32 v183, v134, v135
    s_waitcnt lgkmcnt(3)
    v_mfma_f32_32x32x16_bf16 v[48:63], a[216:219], a[140:143], v[48:63]
    v_exp_f32 v120, v120
    v_exp_f32 v121, v121
    v_mfma_f32_32x32x16_bf16 v[64:79], a[216:219], a[172:175], v[64:79]
    ds_read_b128 a[232:235], v21 offset:0
    v_exp_f32 v122, v122
    v_add_f32 v33, v33, v120
    v_exp_f32 v123, v123
    s_waitcnt lgkmcnt(3)
    v_mfma_f32_32x32x16_bf16 v[80:95], a[220:223], a[140:143], v[80:95]
    v_add_f32 v34, v34, v121
    v_cvt_pk_bf16_f32 v184, v120, v121
    v_exp_f32 v124, v124
    v_mfma_f32_32x32x16_bf16 v[96:111], a[220:223], a[172:175], v[96:111]
    ds_read_b128 a[236:239], v21 offset:8192
    v_add_f32 v33, v33, v122
    v_exp_f32 v125, v125
    v_add_f32 v34, v34, v123
    s_waitcnt lgkmcnt(3)
    v_mfma_f32_32x32x16_bf16 v[48:63], a[224:227], a[144:147], v[48:63]
    v_cvt_pk_bf16_f32 v185, v122, v123
    v_exp_f32 v126, v126
    v_add_f32 v33, v33, v124
    v_mfma_f32_32x32x16_bf16 v[64:79], a[224:227], a[176:179], v[64:79]
    ds_read_b128 a[240:243], v22 offset:0
    v_exp_f32 v127, v127
    v_add_f32 v34, v34, v125
    v_cvt_pk_bf16_f32 v186, v124, v125
    v_add_f32 v33, v33, v126
    s_waitcnt lgkmcnt(3)
    v_mfma_f32_32x32x16_bf16 v[80:95], a[228:231], a[144:147], v[80:95]
    v_add_f32 v34, v34, v127
    v_cvt_pk_bf16_f32 v187, v126, v127
    v_exp_f32 v136, v136
    v_mfma_f32_32x32x16_bf16 v[96:111], a[228:231], a[176:179], v[96:111]
    ds_read_b128 a[244:247], v22 offset:8192
    v_exp_f32 v137, v137
    v_exp_f32 v138, v138
    s_waitcnt lgkmcnt(3)
    v_mfma_f32_32x32x16_bf16 v[48:63], a[232:235], a[148:151], v[48:63]
    v_add_f32 v35, v35, v136
    v_exp_f32 v139, v139
    v_add_f32 v36, v36, v137
    v_mfma_f32_32x32x16_bf16 v[64:79], a[232:235], a[180:183], v[64:79]
    ds_read_b128 a[248:251], v23 offset:0
    v_cvt_pk_bf16_f32 v188, v136, v137
    v_exp_f32 v140, v140
    v_add_f32 v35, v35, v138
    s_waitcnt lgkmcnt(3)
    v_mfma_f32_32x32x16_bf16 v[80:95], a[236:239], a[148:151], v[80:95]
    v_exp_f32 v141, v141
    v_add_f32 v36, v36, v139
    v_cvt_pk_bf16_f32 v189, v138, v139
    v_mfma_f32_32x32x16_bf16 v[96:111], a[236:239], a[180:183], v[96:111]
    ds_read_b128 a[252:255], v23 offset:8192
    v_exp_f32 v142, v142
    v_add_f32 v35, v35, v140
    v_exp_f32 v143, v143
    s_waitcnt lgkmcnt(3)
    v_mfma_f32_32x32x16_bf16 v[48:63], a[240:243], a[152:155], v[48:63]
    v_add_f32 v36, v36, v141
    v_cvt_pk_bf16_f32 v190, v140, v141
    v_add_f32 v35, v35, v142
    v_add_f32 v36, v36, v143
    v_mfma_f32_32x32x16_bf16 v[64:79], a[240:243], a[184:187], v[64:79]
    ds_read_b64_tr_b16 a[192:193], v24 offset:49152
    ds_read_b64_tr_b16 a[194:195], v24 offset:51200
    v_cvt_pk_bf16_f32 v191, v142, v143
    v_exp_f32 v144, v144
    v_exp_f32 v145, v145
    s_waitcnt lgkmcnt(4)
    v_mfma_f32_32x32x16_bf16 v[80:95], a[244:247], a[152:155], v[80:95]
    v_exp_f32 v146, v146
    v_add_f32 v33, v33, v144
    v_mfma_f32_32x32x16_bf16 v[96:111], a[244:247], a[184:187], v[96:111]
    ds_read_b64_tr_b16 a[196:197], v25 offset:49152
    ds_read_b64_tr_b16 a[198:199], v25 offset:51200
    v_exp_f32 v147, v147
    v_add_f32 v34, v34, v145
    v_cvt_pk_bf16_f32 v192, v144, v145
    s_waitcnt lgkmcnt(5)
    v_mfma_f32_32x32x16_bf16 v[48:63], a[248:251], a[156:159], v[48:63]
    v_exp_f32 v148, v148
    v_add_f32 v33, v33, v146
    v_exp_f32 v149, v149
    v_add_f32 v34, v34, v147
    v_mfma_f32_32x32x16_bf16 v[64:79], a[248:251], a[188:191], v[64:79]
    ds_read_b64_tr_b16 a[200:201], v26 offset:49152
    ds_read_b64_tr_b16 a[202:203], v26 offset:51200
    v_cvt_pk_bf16_f32 v193, v146, v147
    v_exp_f32 v150, v150
    v_add_f32 v33, v33, v148
    s_waitcnt lgkmcnt(6)
    v_mfma_f32_32x32x16_bf16 v[80:95], a[252:255], a[156:159], v[80:95]
    v_exp_f32 v151, v151
    v_add_f32 v34, v34, v149
    v_cvt_pk_bf16_f32 v194, v148, v149
    v_mfma_f32_32x32x16_bf16 v[96:111], a[252:255], a[188:191], v[96:111]
    ds_read_b64_tr_b16 a[204:205], v27 offset:49152
    ds_read_b64_tr_b16 a[206:207], v27 offset:51200
    v_add_f32 v33, v33, v150
    v_add_f32 v34, v34, v151
    v_cvt_pk_bf16_f32 v195, v150, v151
    s_waitcnt lgkmcnt(6)
    v_mfma_f32_32x32x16_bf16 a[0:15], a[192:195], v[176:179], a[0:15]
    v_exp_f32 v160, v160
    v_exp_f32 v161, v161
    v_exp_f32 v162, v162
    v_mfma_f32_32x32x16_bf16 a[16:31], a[192:195], v[180:183], a[16:31]
    ds_read_b64_tr_b16 a[208:209], v24 offset:53248
    ds_read_b64_tr_b16 a[210:211], v24 offset:55296
    v_add_f32 v35, v35, v160
    v_exp_f32 v163, v163
    v_add_f32 v36, v36, v161
    s_waitcnt lgkmcnt(6)
    v_mfma_f32_32x32x16_bf16 a[32:47], a[196:199], v[176:179], a[32:47]
    v_cvt_pk_bf16_f32 v196, v160, v161
    v_exp_f32 v164, v164
    v_add_f32 v35, v35, v162
    v_mfma_f32_32x32x16_bf16 a[48:63], a[196:199], v[180:183], a[48:63]
    ds_read_b64_tr_b16 a[212:213], v25 offset:53248
    ds_read_b64_tr_b16 a[214:215], v25 offset:55296
    v_exp_f32 v165, v165
    v_add_f32 v36, v36, v163
    v_cvt_pk_bf16_f32 v197, v162, v163
    s_waitcnt lgkmcnt(6)
    v_mfma_f32_32x32x16_bf16 a[64:79], a[200:203], v[176:179], a[64:79]
    v_exp_f32 v166, v166
    v_add_f32 v35, v35, v164
    v_exp_f32 v167, v167
    v_mfma_f32_32x32x16_bf16 a[80:95], a[200:203], v[180:183], a[80:95]
    ds_read_b64_tr_b16 a[216:217], v26 offset:53248
    ds_read_b64_tr_b16 a[218:219], v26 offset:55296
    v_add_f32 v36, v36, v165
    v_cvt_pk_bf16_f32 v198, v164, v165
    v_add_f32 v35, v35, v166
    v_add_f32 v36, v36, v167
    s_waitcnt lgkmcnt(6)
    v_mfma_f32_32x32x16_bf16 a[96:111], a[204:207], v[176:179], a[96:111]
    v_cvt_pk_bf16_f32 v199, v166, v167
    v_exp_f32 v152, v152
    v_mfma_f32_32x32x16_bf16 a[112:127], a[204:207], v[180:183], a[112:127]
    ds_read_b64_tr_b16 a[220:221], v27 offset:53248
    ds_read_b64_tr_b16 a[222:223], v27 offset:55296
    v_exp_f32 v153, v153
    v_exp_f32 v154, v154
    v_add_f32 v33, v33, v152
    s_waitcnt lgkmcnt(6)
    v_mfma_f32_32x32x16_bf16 a[0:15], a[208:211], v[184:187], a[0:15]
    v_exp_f32 v155, v155
    v_add_f32 v34, v34, v153
    v_cvt_pk_bf16_f32 v200, v152, v153
    v_mfma_f32_32x32x16_bf16 a[16:31], a[208:211], v[188:191], a[16:31]
    ds_read_b64_tr_b16 a[224:225], v24 offset:57344
    ds_read_b64_tr_b16 a[226:227], v24 offset:59392
    v_exp_f32 v156, v156
    v_add_f32 v33, v33, v154
    v_exp_f32 v157, v157
    s_waitcnt lgkmcnt(6)
    v_mfma_f32_32x32x16_bf16 a[32:47], a[212:215], v[184:187], a[32:47]
    v_add_f32 v34, v34, v155
    v_cvt_pk_bf16_f32 v201, v154, v155
    v_exp_f32 v158, v158
    v_mfma_f32_32x32x16_bf16 a[48:63], a[212:215], v[188:191], a[48:63]
    s_waitcnt vmcnt(8)
    s_barrier
    s_add_u32 s50, s50, 16384
    s_add_u32 s51, s51, 16384
    ds_read_b64_tr_b16 a[228:229], v25 offset:57344
    ds_read_b64_tr_b16 a[230:231], v25 offset:59392
    v_add_f32 v33, v33, v156
    v_exp_f32 v159, v159
    v_add_f32 v34, v34, v157
    v_cvt_pk_bf16_f32 v202, v156, v157
    s_waitcnt lgkmcnt(6)
    v_mfma_f32_32x32x16_bf16 a[64:79], a[216:219], v[184:187], a[64:79]
    s_add_u32 m0, s43, 0
    s_nop 0
    buffer_load_dwordx4 v28, s[12:15], s50 offen offset:0 lds
    v_add_f32 v33, v33, v158
    v_add_f32 v34, v34, v159
    v_cvt_pk_bf16_f32 v203, v158, v159
    v_mfma_f32_32x32x16_bf16 a[80:95], a[216:219], v[188:191], a[80:95]
    ds_read_b64_tr_b16 a[232:233], v26 offset:57344
    ds_read_b64_tr_b16 a[234:235], v26 offset:59392
    v_exp_f32 v168, v168
    v_exp_f32 v169, v169
    s_waitcnt lgkmcnt(6)
    v_mfma_f32_32x32x16_bf16 a[96:111], a[220:223], v[184:187], a[96:111]
    buffer_load_dwordx4 v29, s[12:15], s50 offen offset:1024 lds
    v_exp_f32 v170, v170
    v_add_f32 v35, v35, v168
    v_exp_f32 v171, v171
    v_mfma_f32_32x32x16_bf16 a[112:127], a[220:223], v[188:191], a[112:127]
    ds_read_b64_tr_b16 a[236:237], v27 offset:57344
    ds_read_b64_tr_b16 a[238:239], v27 offset:59392
    v_add_f32 v36, v36, v169
    v_cvt_pk_bf16_f32 v204, v168, v169
    v_exp_f32 v172, v172
    v_add_f32 v35, v35, v170
    s_waitcnt lgkmcnt(6)
    v_mfma_f32_32x32x16_bf16 a[0:15], a[224:227], v[192:195], a[0:15]
    buffer_load_dwordx4 v30, s[12:15], s50 offen offset:2048 lds
    v_exp_f32 v173, v173
    v_add_f32 v36, v36, v171
    v_cvt_pk_bf16_f32 v205, v170, v171
    v_mfma_f32_32x32x16_bf16 a[16:31], a[224:227], v[196:199], a[16:31]
    ds_read_b64_tr_b16 a[240:241], v24 offset:61440
    ds_read_b64_tr_b16 a[242:243], v24 offset:63488
    v_exp_f32 v174, v174
    v_add_f32 v35, v35, v172
    s_waitcnt lgkmcnt(6)
    v_mfma_f32_32x32x16_bf16 a[32:47], a[228:231], v[192:195], a[32:47]
    buffer_load_dwordx4 v31, s[12:15], s50 offen offset:3072 lds
    v_exp_f32 v175, v175
    v_add_f32 v36, v36, v173
    v_cvt_pk_bf16_f32 v206, v172, v173
    v_add_f32 v35, v35, v174
    v_mfma_f32_32x32x16_bf16 a[48:63], a[228:231], v[196:199], a[48:63]
    ds_read_b64_tr_b16 a[244:245], v25 offset:61440
    ds_read_b64_tr_b16 a[246:247], v25 offset:63488
    v_add_f32 v36, v36, v175
    v_cvt_pk_bf16_f32 v207, v174, v175
    v_max3_f32 v37, v48, v49, v50
    v_max3_f32 v37, v37, v51, v52
    v_max3_f32 v37, v37, v53, v54
    s_waitcnt lgkmcnt(6)
    v_mfma_f32_32x32x16_bf16 a[64:79], a[232:235], v[192:195], a[64:79]
    s_add_u32 m0, s43, 98304
    s_nop 0
    buffer_load_dwordx4 v32, s[16:19], s51 offen offset:0 lds
    v_max3_f32 v37, v37, v55, v56
    v_max3_f32 v37, v37, v57, v58
    v_max3_f32 v37, v37, v59, v60
    v_max3_f32 v37, v37, v61, v62
    v_mfma_f32_32x32x16_bf16 a[80:95], a[232:235], v[196:199], a[80:95]
    ds_read_b64_tr_b16 a[248:249], v26 offset:61440
    ds_read_b64_tr_b16 a[250:251], v26 offset:63488
    v_max3_f32 v37, v37, v63, v80
    v_max3_f32 v37, v37, v81, v82
    v_max3_f32 v37, v37, v83, v84
    v_max3_f32 v37, v37, v85, v86
    s_waitcnt lgkmcnt(6)
    v_mfma_f32_32x32x16_bf16 a[96:111], a[236:239], v[192:195], a[96:111]
    buffer_load_dwordx4 v32, s[16:19], s51 offen offset:1024 lds
    v_max3_f32 v37, v37, v87, v88
    v_max3_f32 v37, v37, v89, v90
    v_max3_f32 v37, v37, v91, v92
    v_max3_f32 v37, v37, v93, v94
    v_mfma_f32_32x32x16_bf16 a[112:127], a[236:239], v[196:199], a[112:127]
    ds_read_b64_tr_b16 a[252:253], v27 offset:61440
    ds_read_b64_tr_b16 a[254:255], v27 offset:63488
    v_max_f32 v37, v37, v95
    v_max3_f32 v38, v64, v65, v66
    v_max3_f32 v38, v38, v67, v68
    v_max3_f32 v38, v38, v69, v70
    v_max3_f32 v38, v38, v71, v72
    s_waitcnt lgkmcnt(6)
    v_mfma_f32_32x32x16_bf16 a[0:15], a[240:243], v[200:203], a[0:15]
    buffer_load_dwordx4 v32, s[16:19], s51 offen offset:2048 lds
    v_max3_f32 v38, v38, v73, v74
    v_max3_f32 v38, v38, v75, v76
    v_max3_f32 v38, v38, v77, v78
    v_max3_f32 v38, v38, v79, v96
    v_mfma_f32_32x32x16_bf16 a[16:31], a[240:243], v[204:207], a[16:31]
    ds_read_b128 a[192:195], v16 offset:16384
    v_max3_f32 v38, v38, v97, v98
    v_max3_f32 v38, v38, v99, v100
    v_max3_f32 v38, v38, v101, v102
    v_max3_f32 v38, v38, v103, v104
    s_waitcnt lgkmcnt(5)
    v_mfma_f32_32x32x16_bf16 a[32:47], a[244:247], v[200:203], a[32:47]
    buffer_load_dwordx4 v32, s[16:19], s51 offen offset:3072 lds
    v_max3_f32 v38, v38, v105, v106
    v_max3_f32 v38, v38, v107, v108
    v_max3_f32 v38, v38, v109, v110
    v_max_f32 v38, v38, v111
    v_mfma_f32_32x32x16_bf16 a[48:63], a[244:247], v[204:207], a[48:63]
    ds_read_b128 a[196:199], v16 offset:24576
    s_waitcnt lgkmcnt(4)
    v_mfma_f32_32x32x16_bf16 a[64:79], a[248:251], v[200:203], a[64:79]
    v_mov_b32 v39, v37
    v_mov_b32 v40, v38
    s_nop 1
    v_permlane32_swap_b32 v37, v39
    v_permlane32_swap_b32 v38, v40
    s_nop 1
    v_max_f32 v37, v37, v39
    v_max_f32 v38, v38, v40
    v_max_f32 v41, v37, v38
    v_cmp_lt_f32 vcc, s52, v41
    v_mfma_f32_32x32x16_bf16 a[80:95], a[248:251], v[204:207], a[80:95]
    ds_read_b128 a[200:203], v17 offset:16384
    s_waitcnt lgkmcnt(3)
    v_mfma_f32_32x32x16_bf16 a[96:111], a[252:255], v[200:203], a[96:111]
    v_mfma_f32_32x32x16_bf16 a[112:127], a[252:255], v[204:207], a[112:127]
    s_add_u32 s53, s53, 1
    s_cmp_eq_u32 s53, 32
    s_cbranch_scc1 attn_kernel_nr3
    s_cbranch_vccnz attn_kernel_rs3
attn_kernel_nr3:
    s_cmp_lt_u32 s53, 32
    s_cbranch_scc1 attn_kernel_loop
    s_waitcnt vmcnt(0) lgkmcnt(0)
    s_nop 15
    s_nop 15
    v_add_f32 v33, v33, v34
    v_mov_b32 v34, v33
    v_add_f32 v35, v35, v36
    v_mov_b32 v36, v35
    s_nop 1
    v_permlane32_swap_b32 v33, v34
    v_permlane32_swap_b32 v35, v36
    s_nop 1
    v_add_f32 v33, v33, v34
    v_rcp_f32 v33, v33
    v_add_f32 v35, v35, v36
    v_rcp_f32 v35, v35
    s_lshl_b32 s46, s45, 3
    s_lshl_b32 s47, s40, 1
    s_add_u32 s46, s46, s47
    s_lshl_b32 s46, s46, 8
    s_lshl_b32 s47, s44, 3
    s_add_u32 s46, s46, s47
    s_lshl_b32 s46, s46, 10
    v_lshlrev_b32 v12, 4, v1
    v_add_u32 v12, s46, v12
    v_accvgpr_read_b32 v240, a0
    v_accvgpr_read_b32 v241, a1
    v_accvgpr_read_b32 v242, a2
    v_accvgpr_read_b32 v243, a3
    v_accvgpr_read_b32 v244, a4
    v_accvgpr_read_b32 v245, a5
    v_accvgpr_read_b32 v246, a6
    v_accvgpr_read_b32 v247, a7
    v_mul_f32 v240, v240, v33
    v_mul_f32 v241, v241, v33
    v_mul_f32 v242, v242, v33
    v_mul_f32 v243, v243, v33
    v_mul_f32 v244, v244, v33
    v_mul_f32 v245, v245, v33
    v_mul_f32 v246, v246, v33
    v_mul_f32 v247, v247, v33
    v_cvt_pk_bf16_f32 v48, v240, v241
    v_cvt_pk_bf16_f32 v49, v242, v243
    v_cvt_pk_bf16_f32 v50, v244, v245
    v_cvt_pk_bf16_f32 v51, v246, v247
    s_nop 1
    v_permlane32_swap_b32 v48, v50
    v_permlane32_swap_b32 v49, v51
    s_nop 1
    s_mov_b32 s46, 0
    buffer_store_dwordx4 v[48:51], v12, s[28:31], s46 offen offset:0
    v_accvgpr_read_b32 v240, a8
    v_accvgpr_read_b32 v241, a9
    v_accvgpr_read_b32 v242, a10
    v_accvgpr_read_b32 v243, a11
    v_accvgpr_read_b32 v244, a12
    v_accvgpr_read_b32 v245, a13
    v_accvgpr_read_b32 v246, a14
    v_accvgpr_read_b32 v247, a15
    v_mul_f32 v240, v240, v33
    v_mul_f32 v241, v241, v33
    v_mul_f32 v242, v242, v33
    v_mul_f32 v243, v243, v33
    v_mul_f32 v244, v244, v33
    v_mul_f32 v245, v245, v33
    v_mul_f32 v246, v246, v33
    v_mul_f32 v247, v247, v33
    v_cvt_pk_bf16_f32 v52, v240, v241
    v_cvt_pk_bf16_f32 v53, v242, v243
    v_cvt_pk_bf16_f32 v54, v244, v245
    v_cvt_pk_bf16_f32 v55, v246, v247
    s_nop 1
    v_permlane32_swap_b32 v52, v54
    v_permlane32_swap_b32 v53, v55
    s_nop 1
    s_mov_b32 s46, 0
    buffer_store_dwordx4 v[52:55], v12, s[28:31], s46 offen offset:1024
    v_accvgpr_read_b32 v240, a32
    v_accvgpr_read_b32 v241, a33
    v_accvgpr_read_b32 v242, a34
    v_accvgpr_read_b32 v243, a35
    v_accvgpr_read_b32 v244, a36
    v_accvgpr_read_b32 v245, a37
    v_accvgpr_read_b32 v246, a38
    v_accvgpr_read_b32 v247, a39
    v_mul_f32 v240, v240, v33
    v_mul_f32 v241, v241, v33
    v_mul_f32 v242, v242, v33
    v_mul_f32 v243, v243, v33
    v_mul_f32 v244, v244, v33
    v_mul_f32 v245, v245, v33
    v_mul_f32 v246, v246, v33
    v_mul_f32 v247, v247, v33
    v_cvt_pk_bf16_f32 v56, v240, v241
    v_cvt_pk_bf16_f32 v57, v242, v243
    v_cvt_pk_bf16_f32 v58, v244, v245
    v_cvt_pk_bf16_f32 v59, v246, v247
    s_nop 1
    v_permlane32_swap_b32 v56, v58
    v_permlane32_swap_b32 v57, v59
    s_nop 1
    s_mov_b32 s46, 0
    buffer_store_dwordx4 v[56:59], v12, s[28:31], s46 offen offset:2048
    v_accvgpr_read_b32 v240, a40
    v_accvgpr_read_b32 v241, a41
    v_accvgpr_read_b32 v242, a42
    v_accvgpr_read_b32 v243, a43
    v_accvgpr_read_b32 v244, a44
    v_accvgpr_read_b32 v245, a45
    v_accvgpr_read_b32 v246, a46
    v_accvgpr_read_b32 v247, a47
    v_mul_f32 v240, v240, v33
    v_mul_f32 v241, v241, v33
    v_mul_f32 v242, v242, v33
    v_mul_f32 v243, v243, v33
    v_mul_f32 v244, v244, v33
    v_mul_f32 v245, v245, v33
    v_mul_f32 v246, v246, v33
    v_mul_f32 v247, v247, v33
    v_cvt_pk_bf16_f32 v60, v240, v241
    v_cvt_pk_bf16_f32 v61, v242, v243
    v_cvt_pk_bf16_f32 v62, v244, v245
    v_cvt_pk_bf16_f32 v63, v246, v247
    s_nop 1
    v_permlane32_swap_b32 v60, v62
    v_permlane32_swap_b32 v61, v63
    s_nop 1
    s_mov_b32 s46, 0
    buffer_store_dwordx4 v[60:63], v12, s[28:31], s46 offen offset:3072
    v_accvgpr_read_b32 v240, a64
    v_accvgpr_read_b32 v241, a65
    v_accvgpr_read_b32 v242, a66
    v_accvgpr_read_b32 v243, a67
    v_accvgpr_read_b32 v244, a68
    v_accvgpr_read_b32 v245, a69
    v_accvgpr_read_b32 v246, a70
    v_accvgpr_read_b32 v247, a71
    v_mul_f32 v240, v240, v33
    v_mul_f32 v241, v241, v33
    v_mul_f32 v242, v242, v33
    v_mul_f32 v243, v243, v33
    v_mul_f32 v244, v244, v33
    v_mul_f32 v245, v245, v33
    v_mul_f32 v246, v246, v33
    v_mul_f32 v247, v247, v33
    v_cvt_pk_bf16_f32 v48, v240, v241
    v_cvt_pk_bf16_f32 v49, v242, v243
    v_cvt_pk_bf16_f32 v50, v244, v245
    v_cvt_pk_bf16_f32 v51, v246, v247
    s_nop 1
    v_permlane32_swap_b32 v48, v50
    v_permlane32_swap_b32 v49, v51
    s_nop 1
    s_mov_b32 s46, 4096
    buffer_store_dwordx4 v[48:51], v12, s[28:31], s46 offen offset:0
    v_accvgpr_read_b32 v240, a72
    v_accvgpr_read_b32 v241, a73
    v_accvgpr_read_b32 v242, a74
    v_accvgpr_read_b32 v243, a75
    v_accvgpr_read_b32 v244, a76
    v_accvgpr_read_b32 v245, a77
    v_accvgpr_read_b32 v246, a78
    v_accvgpr_read_b32 v247, a79
    v_mul_f32 v240, v240, v33
    v_mul_f32 v241, v241, v33
    v_mul_f32 v242, v242, v33
    v_mul_f32 v243, v243, v33
    v_mul_f32 v244, v244, v33
    v_mul_f32 v245, v245, v33
    v_mul_f32 v246, v246, v33
    v_mul_f32 v247, v247, v33
    v_cvt_pk_bf16_f32 v52, v240, v241
    v_cvt_pk_bf16_f32 v53, v242, v243
    v_cvt_pk_bf16_f32 v54, v244, v245
    v_cvt_pk_bf16_f32 v55, v246, v247
    s_nop 1
    v_permlane32_swap_b32 v52, v54
    v_permlane32_swap_b32 v53, v55
    s_nop 1
    s_mov_b32 s46, 4096
    buffer_store_dwordx4 v[52:55], v12, s[28:31], s46 offen offset:1024
    v_accvgpr_read_b32 v240, a96
    v_accvgpr_read_b32 v241, a97
    v_accvgpr_read_b32 v242, a98
    v_accvgpr_read_b32 v243, a99
    v_accvgpr_read_b32 v244, a100
    v_accvgpr_read_b32 v245, a101
    v_accvgpr_read_b32 v246, a102
    v_accvgpr_read_b32 v247, a103
    v_mul_f32 v240, v240, v33
    v_mul_f32 v241, v241, v33
    v_mul_f32 v242, v242, v33
    v_mul_f32 v243, v243, v33
    v_mul_f32 v244, v244, v33
    v_mul_f32 v245, v245, v33
    v_mul_f32 v246, v246, v33
    v_mul_f32 v247, v247, v33
    v_cvt_pk_bf16_f32 v56, v240, v241
    v_cvt_pk_bf16_f32 v57, v242, v243
    v_cvt_pk_bf16_f32 v58, v244, v245
    v_cvt_pk_bf16_f32 v59, v246, v247
    s_nop 1
    v_permlane32_swap_b32 v56, v58
    v_permlane32_swap_b32 v57, v59
    s_nop 1
    s_mov_b32 s46, 4096
    buffer_store_dwordx4 v[56:59], v12, s[28:31], s46 offen offset:2048
    v_accvgpr_read_b32 v240, a104
    v_accvgpr_read_b32 v241, a105
    v_accvgpr_read_b32 v242, a106
    v_accvgpr_read_b32 v243, a107
    v_accvgpr_read_b32 v244, a108
    v_accvgpr_read_b32 v245, a109
    v_accvgpr_read_b32 v246, a110
    v_accvgpr_read_b32 v247, a111
    v_mul_f32 v240, v240, v33
    v_mul_f32 v241, v241, v33
    v_mul_f32 v242, v242, v33
    v_mul_f32 v243, v243, v33
    v_mul_f32 v244, v244, v33
    v_mul_f32 v245, v245, v33
    v_mul_f32 v246, v246, v33
    v_mul_f32 v247, v247, v33
    v_cvt_pk_bf16_f32 v60, v240, v241
    v_cvt_pk_bf16_f32 v61, v242, v243
    v_cvt_pk_bf16_f32 v62, v244, v245
    v_cvt_pk_bf16_f32 v63, v246, v247
    s_nop 1
    v_permlane32_swap_b32 v60, v62
    v_permlane32_swap_b32 v61, v63
    s_nop 1
    s_mov_b32 s46, 4096
    buffer_store_dwordx4 v[60:63], v12, s[28:31], s46 offen offset:3072
    v_accvgpr_read_b32 v240, a16
    v_accvgpr_read_b32 v241, a17
    v_accvgpr_read_b32 v242, a18
    v_accvgpr_read_b32 v243, a19
    v_accvgpr_read_b32 v244, a20
    v_accvgpr_read_b32 v245, a21
    v_accvgpr_read_b32 v246, a22
    v_accvgpr_read_b32 v247, a23
    v_mul_f32 v240, v240, v35
    v_mul_f32 v241, v241, v35
    v_mul_f32 v242, v242, v35
    v_mul_f32 v243, v243, v35
    v_mul_f32 v244, v244, v35
    v_mul_f32 v245, v245, v35
    v_mul_f32 v246, v246, v35
    v_mul_f32 v247, v247, v35
    v_cvt_pk_bf16_f32 v48, v240, v241
    v_cvt_pk_bf16_f32 v49, v242, v243
    v_cvt_pk_bf16_f32 v50, v244, v245
    v_cvt_pk_bf16_f32 v51, v246, v247
    s_nop 1
    v_permlane32_swap_b32 v48, v50
    v_permlane32_swap_b32 v49, v51
    s_nop 1
    s_mov_b32 s46, 262144
    buffer_store_dwordx4 v[48:51], v12, s[28:31], s46 offen offset:0
    v_accvgpr_read_b32 v240, a24
    v_accvgpr_read_b32 v241, a25
    v_accvgpr_read_b32 v242, a26
    v_accvgpr_read_b32 v243, a27
    v_accvgpr_read_b32 v244, a28
    v_accvgpr_read_b32 v245, a29
    v_accvgpr_read_b32 v246, a30
    v_accvgpr_read_b32 v247, a31
    v_mul_f32 v240, v240, v35
    v_mul_f32 v241, v241, v35
    v_mul_f32 v242, v242, v35
    v_mul_f32 v243, v243, v35
    v_mul_f32 v244, v244, v35
    v_mul_f32 v245, v245, v35
    v_mul_f32 v246, v246, v35
    v_mul_f32 v247, v247, v35
    v_cvt_pk_bf16_f32 v52, v240, v241
    v_cvt_pk_bf16_f32 v53, v242, v243
    v_cvt_pk_bf16_f32 v54, v244, v245
    v_cvt_pk_bf16_f32 v55, v246, v247
    s_nop 1
    v_permlane32_swap_b32 v52, v54
    v_permlane32_swap_b32 v53, v55
    s_nop 1
    s_mov_b32 s46, 262144
    buffer_store_dwordx4 v[52:55], v12, s[28:31], s46 offen offset:1024
    v_accvgpr_read_b32 v240, a48
    v_accvgpr_read_b32 v241, a49
    v_accvgpr_read_b32 v242, a50
    v_accvgpr_read_b32 v243, a51
    v_accvgpr_read_b32 v244, a52
    v_accvgpr_read_b32 v245, a53
    v_accvgpr_read_b32 v246, a54
    v_accvgpr_read_b32 v247, a55
    v_mul_f32 v240, v240, v35
    v_mul_f32 v241, v241, v35
    v_mul_f32 v242, v242, v35
    v_mul_f32 v243, v243, v35
    v_mul_f32 v244, v244, v35
    v_mul_f32 v245, v245, v35
    v_mul_f32 v246, v246, v35
    v_mul_f32 v247, v247, v35
    v_cvt_pk_bf16_f32 v56, v240, v241
    v_cvt_pk_bf16_f32 v57, v242, v243
    v_cvt_pk_bf16_f32 v58, v244, v245
    v_cvt_pk_bf16_f32 v59, v246, v247
    s_nop 1
    v_permlane32_swap_b32 v56, v58
    v_permlane32_swap_b32 v57, v59
    s_nop 1
    s_mov_b32 s46, 262144
    buffer_store_dwordx4 v[56:59], v12, s[28:31], s46 offen offset:2048
    v_accvgpr_read_b32 v240, a56
    v_accvgpr_read_b32 v241, a57
    v_accvgpr_read_b32 v242, a58
    v_accvgpr_read_b32 v243, a59
    v_accvgpr_read_b32 v244, a60
    v_accvgpr_read_b32 v245, a61
    v_accvgpr_read_b32 v246, a62
    v_accvgpr_read_b32 v247, a63
    v_mul_f32 v240, v240, v35
    v_mul_f32 v241, v241, v35
    v_mul_f32 v242, v242, v35
    v_mul_f32 v243, v243, v35
    v_mul_f32 v244, v244, v35
    v_mul_f32 v245, v245, v35
    v_mul_f32 v246, v246, v35
    v_mul_f32 v247, v247, v35
    v_cvt_pk_bf16_f32 v60, v240, v241
    v_cvt_pk_bf16_f32 v61, v242, v243
    v_cvt_pk_bf16_f32 v62, v244, v245
    v_cvt_pk_bf16_f32 v63, v246, v247
    s_nop 1
    v_permlane32_swap_b32 v60, v62
    v_permlane32_swap_b32 v61, v63
    s_nop 1
    s_mov_b32 s46, 262144
    buffer_store_dwordx4 v[60:63], v12, s[28:31], s46 offen offset:3072
    v_accvgpr_read_b32 v240, a80
    v_accvgpr_read_b32 v241, a81
    v_accvgpr_read_b32 v242, a82
    v_accvgpr_read_b32 v243, a83
    v_accvgpr_read_b32 v244, a84
    v_accvgpr_read_b32 v245, a85
    v_accvgpr_read_b32 v246, a86
    v_accvgpr_read_b32 v247, a87
    v_mul_f32 v240, v240, v35
    v_mul_f32 v241, v241, v35
    v_mul_f32 v242, v242, v35
    v_mul_f32 v243, v243, v35
    v_mul_f32 v244, v244, v35
    v_mul_f32 v245, v245, v35
    v_mul_f32 v246, v246, v35
    v_mul_f32 v247, v247, v35
    v_cvt_pk_bf16_f32 v48, v240, v241
    v_cvt_pk_bf16_f32 v49, v242, v243
    v_cvt_pk_bf16_f32 v50, v244, v245
    v_cvt_pk_bf16_f32 v51, v246, v247
    s_nop 1
    v_permlane32_swap_b32 v48, v50
    v_permlane32_swap_b32 v49, v51
    s_nop 1
    s_mov_b32 s46, 266240
    buffer_store_dwordx4 v[48:51], v12, s[28:31], s46 offen offset:0
    v_accvgpr_read_b32 v240, a88
    v_accvgpr_read_b32 v241, a89
    v_accvgpr_read_b32 v242, a90
    v_accvgpr_read_b32 v243, a91
    v_accvgpr_read_b32 v244, a92
    v_accvgpr_read_b32 v245, a93
    v_accvgpr_read_b32 v246, a94
    v_accvgpr_read_b32 v247, a95
    v_mul_f32 v240, v240, v35
    v_mul_f32 v241, v241, v35
    v_mul_f32 v242, v242, v35
    v_mul_f32 v243, v243, v35
    v_mul_f32 v244, v244, v35
    v_mul_f32 v245, v245, v35
    v_mul_f32 v246, v246, v35
    v_mul_f32 v247, v247, v35
    v_cvt_pk_bf16_f32 v52, v240, v241
    v_cvt_pk_bf16_f32 v53, v242, v243
    v_cvt_pk_bf16_f32 v54, v244, v245
    v_cvt_pk_bf16_f32 v55, v246, v247
    s_nop 1
    v_permlane32_swap_b32 v52, v54
    v_permlane32_swap_b32 v53, v55
    s_nop 1
    s_mov_b32 s46, 266240
    buffer_store_dwordx4 v[52:55], v12, s[28:31], s46 offen offset:1024
    v_accvgpr_read_b32 v240, a112
    v_accvgpr_read_b32 v241, a113
    v_accvgpr_read_b32 v242, a114
    v_accvgpr_read_b32 v243, a115
    v_accvgpr_read_b32 v244, a116
    v_accvgpr_read_b32 v245, a117
    v_accvgpr_read_b32 v246, a118
    v_accvgpr_read_b32 v247, a119
    v_mul_f32 v240, v240, v35
    v_mul_f32 v241, v241, v35
    v_mul_f32 v242, v242, v35
    v_mul_f32 v243, v243, v35
    v_mul_f32 v244, v244, v35
    v_mul_f32 v245, v245, v35
    v_mul_f32 v246, v246, v35
    v_mul_f32 v247, v247, v35
    v_cvt_pk_bf16_f32 v56, v240, v241
    v_cvt_pk_bf16_f32 v57, v242, v243
    v_cvt_pk_bf16_f32 v58, v244, v245
    v_cvt_pk_bf16_f32 v59, v246, v247
    s_nop 1
    v_permlane32_swap_b32 v56, v58
    v_permlane32_swap_b32 v57, v59
    s_nop 1
    s_mov_b32 s46, 266240
    buffer_store_dwordx4 v[56:59], v12, s[28:31], s46 offen offset:2048
    v_accvgpr_read_b32 v240, a120
    v_accvgpr_read_b32 v241, a121
    v_accvgpr_read_b32 v242, a122
    v_accvgpr_read_b32 v243, a123
    v_accvgpr_read_b32 v244, a124
    v_accvgpr_read_b32 v245, a125
    v_accvgpr_read_b32 v246, a126
    v_accvgpr_read_b32 v247, a127
    v_mul_f32 v240, v240, v35
    v_mul_f32 v241, v241, v35
    v_mul_f32 v242, v242, v35
    v_mul_f32 v243, v243, v35
    v_mul_f32 v244, v244, v35
    v_mul_f32 v245, v245, v35
    v_mul_f32 v246, v246, v35
    v_mul_f32 v247, v247, v35
    v_cvt_pk_bf16_f32 v60, v240, v241
    v_cvt_pk_bf16_f32 v61, v242, v243
    v_cvt_pk_bf16_f32 v62, v244, v245
    v_cvt_pk_bf16_f32 v63, v246, v247
    s_nop 1
    v_permlane32_swap_b32 v60, v62
    v_permlane32_swap_b32 v61, v63
    s_nop 1
    s_mov_b32 s46, 266240
    buffer_store_dwordx4 v[60:63], v12, s[28:31], s46 offen offset:3072
    s_waitcnt vmcnt(0)
    s_endpgm
attn_kernel_pf:
    s_lshl_b32 s33, s2, 2
    s_add_u32 s33, s33, s40
    v_lshlrev_b32 v240, 4, v1
    s_add_u32 m0, s43, 131072
    s_mov_b32 s36, s56
    s_and_b32 s37, s57, 0xffff
    s_mov_b32 s38, 4194304
    s_mov_b32 s39, 0x20000
    s_mul_i32 s34, s33, 4096
    buffer_load_dwordx4 v240, s[36:39], s34 offen offset:0 lds
    buffer_load_dwordx4 v240, s[36:39], s34 offen offset:1024 lds
    buffer_load_dwordx4 v240, s[36:39], s34 offen offset:2048 lds
    buffer_load_dwordx4 v240, s[36:39], s34 offen offset:3072 lds
    s_mov_b32 s36, s58
    s_and_b32 s37, s59, 0xffff
    s_mov_b32 s38, 1409024
    s_mov_b32 s39, 0x20000
    s_mul_i32 s34, s33, 2048
    buffer_load_dwordx4 v240, s[36:39], s34 offen offset:0 lds
    buffer_load_dwordx4 v240, s[36:39], s34 offen offset:1024 lds
    s_mov_b32 s36, s60
    s_and_b32 s37, s61, 0xffff
    s_mov_b32 s38, 1409024
    s_mov_b32 s39, 0x20000
    s_mul_i32 s34, s33, 2048
    buffer_load_dwordx4 v240, s[36:39], s34 offen offset:0 lds
    buffer_load_dwordx4 v240, s[36:39], s34 offen offset:1024 lds
    s_mov_b32 s36, s62
    s_and_b32 s37, s63, 0xffff
    s_mov_b32 s38, 1409024
    s_mov_b32 s39, 0x20000
    s_mul_i32 s34, s33, 2048
    buffer_load_dwordx4 v240, s[36:39], s34 offen offset:0 lds
    buffer_load_dwordx4 v240, s[36:39], s34 offen offset:1024 lds
    s_branch attn_kernel_pfret
attn_kernel_rs0:
    s_nop 15
    s_nop 15
    v_max_f32 v42, 0, v37
    v_exp_f32 v44, -v42
    v_max_f32 v43, 0, v38
    v_exp_f32 v45, -v43
    s_nop 0
    v_sub_f32 v112, v112, v42
    v_sub_f32 v113, v113, v42
    v_sub_f32 v114, v114, v42
    v_sub_f32 v115, v115, v42
    v_sub_f32 v116, v116, v42
    v_sub_f32 v117, v117, v42
    v_sub_f32 v118, v118, v42
    v_sub_f32 v119, v119, v42
    v_sub_f32 v120, v120, v42
    v_sub_f32 v121, v121, v42
    v_sub_f32 v122, v122, v42
    v_sub_f32 v123, v123, v42
    v_sub_f32 v124, v124, v42
    v_sub_f32 v125, v125, v42
    v_sub_f32 v126, v126, v42
    v_sub_f32 v127, v127, v42
    v_sub_f32 v144, v144, v42
    v_sub_f32 v145, v145, v42
    v_sub_f32 v146, v146, v42
    v_sub_f32 v147, v147, v42
    v_sub_f32 v148, v148, v42
    v_sub_f32 v149, v149, v42
    v_sub_f32 v150, v150, v42
    v_sub_f32 v151, v151, v42
    v_sub_f32 v152, v152, v42
    v_sub_f32 v153, v153, v42
    v_sub_f32 v154, v154, v42
    v_sub_f32 v155, v155, v42
    v_sub_f32 v156, v156, v42
    v_sub_f32 v157, v157, v42
    v_sub_f32 v158, v158, v42
    v_sub_f32 v159, v159, v42
    v_sub_f32 v208, v208, v42
    v_sub_f32 v209, v209, v42
    v_sub_f32 v210, v210, v42
    v_sub_f32 v211, v211, v42
    v_sub_f32 v212, v212, v42
    v_sub_f32 v213, v213, v42
    v_sub_f32 v214, v214, v42
    v_sub_f32 v215, v215, v42
    v_sub_f32 v216, v216, v42
    v_sub_f32 v217, v217, v42
    v_sub_f32 v218, v218, v42
    v_sub_f32 v219, v219, v42
    v_sub_f32 v220, v220, v42
    v_sub_f32 v221, v221, v42
    v_sub_f32 v222, v222, v42
    v_sub_f32 v223, v223, v42
    v_mul_f32 v33, v33, v44
    v_mul_f32 v34, v34, v44
    v_accvgpr_read_b32 v240, a0
    v_accvgpr_read_b32 v241, a1
    v_accvgpr_read_b32 v242, a2
    v_accvgpr_read_b32 v243, a3
    v_mul_f32 v240, v240, v44
    v_mul_f32 v241, v241, v44
    v_mul_f32 v242, v242, v44
    v_mul_f32 v243, v243, v44
    v_accvgpr_write_b32 a0, v240
    v_accvgpr_write_b32 a1, v241
    v_accvgpr_write_b32 a2, v242
    v_accvgpr_write_b32 a3, v243
    v_accvgpr_read_b32 v240, a4
    v_accvgpr_read_b32 v241, a5
    v_accvgpr_read_b32 v242, a6
    v_accvgpr_read_b32 v243, a7
    v_mul_f32 v240, v240, v44
    v_mul_f32 v241, v241, v44
    v_mul_f32 v242, v242, v44
    v_mul_f32 v243, v243, v44
    v_accvgpr_write_b32 a4, v240
    v_accvgpr_write_b32 a5, v241
    v_accvgpr_write_b32 a6, v242
    v_accvgpr_write_b32 a7, v243
    v_accvgpr_read_b32 v240, a8
    v_accvgpr_read_b32 v241, a9
    v_accvgpr_read_b32 v242, a10
    v_accvgpr_read_b32 v243, a11
    v_mul_f32 v240, v240, v44
    v_mul_f32 v241, v241, v44
    v_mul_f32 v242, v242, v44
    v_mul_f32 v243, v243, v44
    v_accvgpr_write_b32 a8, v240
    v_accvgpr_write_b32 a9, v241
    v_accvgpr_write_b32 a10, v242
    v_accvgpr_write_b32 a11, v243
    v_accvgpr_read_b32 v240, a12
    v_accvgpr_read_b32 v241, a13
    v_accvgpr_read_b32 v242, a14
    v_accvgpr_read_b32 v243, a15
    v_mul_f32 v240, v240, v44
    v_mul_f32 v241, v241, v44
    v_mul_f32 v242, v242, v44
    v_mul_f32 v243, v243, v44
    v_accvgpr_write_b32 a12, v240
    v_accvgpr_write_b32 a13, v241
    v_accvgpr_write_b32 a14, v242
    v_accvgpr_write_b32 a15, v243
    v_accvgpr_read_b32 v240, a32
    v_accvgpr_read_b32 v241, a33
    v_accvgpr_read_b32 v242, a34
    v_accvgpr_read_b32 v243, a35
    v_mul_f32 v240, v240, v44
    v_mul_f32 v241, v241, v44
    v_mul_f32 v242, v242, v44
    v_mul_f32 v243, v243, v44
    v_accvgpr_write_b32 a32, v240
    v_accvgpr_write_b32 a33, v241
    v_accvgpr_write_b32 a34, v242
    v_accvgpr_write_b32 a35, v243
    v_accvgpr_read_b32 v240, a36
    v_accvgpr_read_b32 v241, a37
    v_accvgpr_read_b32 v242, a38
    v_accvgpr_read_b32 v243, a39
    v_mul_f32 v240, v240, v44
    v_mul_f32 v241, v241, v44
    v_mul_f32 v242, v242, v44
    v_mul_f32 v243, v243, v44
    v_accvgpr_write_b32 a36, v240
    v_accvgpr_write_b32 a37, v241
    v_accvgpr_write_b32 a38, v242
    v_accvgpr_write_b32 a39, v243
    v_accvgpr_read_b32 v240, a40
    v_accvgpr_read_b32 v241, a41
    v_accvgpr_read_b32 v242, a42
    v_accvgpr_read_b32 v243, a43
    v_mul_f32 v240, v240, v44
    v_mul_f32 v241, v241, v44
    v_mul_f32 v242, v242, v44
    v_mul_f32 v243, v243, v44
    v_accvgpr_write_b32 a40, v240
    v_accvgpr_write_b32 a41, v241
    v_accvgpr_write_b32 a42, v242
    v_accvgpr_write_b32 a43, v243
    v_accvgpr_read_b32 v240, a44
    v_accvgpr_read_b32 v241, a45
    v_accvgpr_read_b32 v242, a46
    v_accvgpr_read_b32 v243, a47
    v_mul_f32 v240, v240, v44
    v_mul_f32 v241, v241, v44
    v_mul_f32 v242, v242, v44
    v_mul_f32 v243, v243, v44
    v_accvgpr_write_b32 a44, v240
    v_accvgpr_write_b32 a45, v241
    v_accvgpr_write_b32 a46, v242
    v_accvgpr_write_b32 a47, v243
    v_accvgpr_read_b32 v240, a64
    v_accvgpr_read_b32 v241, a65
    v_accvgpr_read_b32 v242, a66
    v_accvgpr_read_b32 v243, a67
    v_mul_f32 v240, v240, v44
    v_mul_f32 v241, v241, v44
    v_mul_f32 v242, v242, v44
    v_mul_f32 v243, v243, v44
    v_accvgpr_write_b32 a64, v240
    v_accvgpr_write_b32 a65, v241
    v_accvgpr_write_b32 a66, v242
    v_accvgpr_write_b32 a67, v243
    v_accvgpr_read_b32 v240, a68
    v_accvgpr_read_b32 v241, a69
    v_accvgpr_read_b32 v242, a70
    v_accvgpr_read_b32 v243, a71
    v_mul_f32 v240, v240, v44
    v_mul_f32 v241, v241, v44
    v_mul_f32 v242, v242, v44
    v_mul_f32 v243, v243, v44
    v_accvgpr_write_b32 a68, v240
    v_accvgpr_write_b32 a69, v241
    v_accvgpr_write_b32 a70, v242
    v_accvgpr_write_b32 a71, v243
    v_accvgpr_read_b32 v240, a72
    v_accvgpr_read_b32 v241, a73
    v_accvgpr_read_b32 v242, a74
    v_accvgpr_read_b32 v243, a75
    v_mul_f32 v240, v240, v44
    v_mul_f32 v241, v241, v44
    v_mul_f32 v242, v242, v44
    v_mul_f32 v243, v243, v44
    v_accvgpr_write_b32 a72, v240
    v_accvgpr_write_b32 a73, v241
    v_accvgpr_write_b32 a74, v242
    v_accvgpr_write_b32 a75, v243
    v_accvgpr_read_b32 v240, a76
    v_accvgpr_read_b32 v241, a77
    v_accvgpr_read_b32 v242, a78
    v_accvgpr_read_b32 v243, a79
    v_mul_f32 v240, v240, v44
    v_mul_f32 v241, v241, v44
    v_mul_f32 v242, v242, v44
    v_mul_f32 v243, v243, v44
    v_accvgpr_write_b32 a76, v240
    v_accvgpr_write_b32 a77, v241
    v_accvgpr_write_b32 a78, v242
    v_accvgpr_write_b32 a79, v243
    v_accvgpr_read_b32 v240, a96
    v_accvgpr_read_b32 v241, a97
    v_accvgpr_read_b32 v242, a98
    v_accvgpr_read_b32 v243, a99
    v_mul_f32 v240, v240, v44
    v_mul_f32 v241, v241, v44
    v_mul_f32 v242, v242, v44
    v_mul_f32 v243, v243, v44
    v_accvgpr_write_b32 a96, v240
    v_accvgpr_write_b32 a97, v241
    v_accvgpr_write_b32 a98, v242
    v_accvgpr_write_b32 a99, v243
    v_accvgpr_read_b32 v240, a100
    v_accvgpr_read_b32 v241, a101
    v_accvgpr_read_b32 v242, a102
    v_accvgpr_read_b32 v243, a103
    v_mul_f32 v240, v240, v44
    v_mul_f32 v241, v241, v44
    v_mul_f32 v242, v242, v44
    v_mul_f32 v243, v243, v44
    v_accvgpr_write_b32 a100, v240
    v_accvgpr_write_b32 a101, v241
    v_accvgpr_write_b32 a102, v242
    v_accvgpr_write_b32 a103, v243
    v_accvgpr_read_b32 v240, a104
    v_accvgpr_read_b32 v241, a105
    v_accvgpr_read_b32 v242, a106
    v_accvgpr_read_b32 v243, a107
    v_mul_f32 v240, v240, v44
    v_mul_f32 v241, v241, v44
    v_mul_f32 v242, v242, v44
    v_mul_f32 v243, v243, v44
    v_accvgpr_write_b32 a104, v240
    v_accvgpr_write_b32 a105, v241
    v_accvgpr_write_b32 a106, v242
    v_accvgpr_write_b32 a107, v243
    v_accvgpr_read_b32 v240, a108
    v_accvgpr_read_b32 v241, a109
    v_accvgpr_read_b32 v242, a110
    v_accvgpr_read_b32 v243, a111
    v_mul_f32 v240, v240, v44
    v_mul_f32 v241, v241, v44
    v_mul_f32 v242, v242, v44
    v_mul_f32 v243, v243, v44
    v_accvgpr_write_b32 a108, v240
    v_accvgpr_write_b32 a109, v241
    v_accvgpr_write_b32 a110, v242
    v_accvgpr_write_b32 a111, v243
    v_sub_f32 v128, v128, v43
    v_sub_f32 v129, v129, v43
    v_sub_f32 v130, v130, v43
    v_sub_f32 v131, v131, v43
    v_sub_f32 v132, v132, v43
    v_sub_f32 v133, v133, v43
    v_sub_f32 v134, v134, v43
    v_sub_f32 v135, v135, v43
    v_sub_f32 v136, v136, v43
    v_sub_f32 v137, v137, v43
    v_sub_f32 v138, v138, v43
    v_sub_f32 v139, v139, v43
    v_sub_f32 v140, v140, v43
    v_sub_f32 v141, v141, v43
    v_sub_f32 v142, v142, v43
    v_sub_f32 v143, v143, v43
    v_sub_f32 v160, v160, v43
    v_sub_f32 v161, v161, v43
    v_sub_f32 v162, v162, v43
    v_sub_f32 v163, v163, v43
    v_sub_f32 v164, v164, v43
    v_sub_f32 v165, v165, v43
    v_sub_f32 v166, v166, v43
    v_sub_f32 v167, v167, v43
    v_sub_f32 v168, v168, v43
    v_sub_f32 v169, v169, v43
    v_sub_f32 v170, v170, v43
    v_sub_f32 v171, v171, v43
    v_sub_f32 v172, v172, v43
    v_sub_f32 v173, v173, v43
    v_sub_f32 v174, v174, v43
    v_sub_f32 v175, v175, v43
    v_sub_f32 v224, v224, v43
    v_sub_f32 v225, v225, v43
    v_sub_f32 v226, v226, v43
    v_sub_f32 v227, v227, v43
    v_sub_f32 v228, v228, v43
    v_sub_f32 v229, v229, v43
    v_sub_f32 v230, v230, v43
    v_sub_f32 v231, v231, v43
    v_sub_f32 v232, v232, v43
    v_sub_f32 v233, v233, v43
    v_sub_f32 v234, v234, v43
    v_sub_f32 v235, v235, v43
    v_sub_f32 v236, v236, v43
    v_sub_f32 v237, v237, v43
    v_sub_f32 v238, v238, v43
    v_sub_f32 v239, v239, v43
    v_mul_f32 v35, v35, v45
    v_mul_f32 v36, v36, v45
    v_accvgpr_read_b32 v240, a16
    v_accvgpr_read_b32 v241, a17
    v_accvgpr_read_b32 v242, a18
    v_accvgpr_read_b32 v243, a19
    v_mul_f32 v240, v240, v45
    v_mul_f32 v241, v241, v45
    v_mul_f32 v242, v242, v45
    v_mul_f32 v243, v243, v45
    v_accvgpr_write_b32 a16, v240
    v_accvgpr_write_b32 a17, v241
    v_accvgpr_write_b32 a18, v242
    v_accvgpr_write_b32 a19, v243
    v_accvgpr_read_b32 v240, a20
    v_accvgpr_read_b32 v241, a21
    v_accvgpr_read_b32 v242, a22
    v_accvgpr_read_b32 v243, a23
    v_mul_f32 v240, v240, v45
    v_mul_f32 v241, v241, v45
    v_mul_f32 v242, v242, v45
    v_mul_f32 v243, v243, v45
    v_accvgpr_write_b32 a20, v240
    v_accvgpr_write_b32 a21, v241
    v_accvgpr_write_b32 a22, v242
    v_accvgpr_write_b32 a23, v243
    v_accvgpr_read_b32 v240, a24
    v_accvgpr_read_b32 v241, a25
    v_accvgpr_read_b32 v242, a26
    v_accvgpr_read_b32 v243, a27
    v_mul_f32 v240, v240, v45
    v_mul_f32 v241, v241, v45
    v_mul_f32 v242, v242, v45
    v_mul_f32 v243, v243, v45
    v_accvgpr_write_b32 a24, v240
    v_accvgpr_write_b32 a25, v241
    v_accvgpr_write_b32 a26, v242
    v_accvgpr_write_b32 a27, v243
    v_accvgpr_read_b32 v240, a28
    v_accvgpr_read_b32 v241, a29
    v_accvgpr_read_b32 v242, a30
    v_accvgpr_read_b32 v243, a31
    v_mul_f32 v240, v240, v45
    v_mul_f32 v241, v241, v45
    v_mul_f32 v242, v242, v45
    v_mul_f32 v243, v243, v45
    v_accvgpr_write_b32 a28, v240
    v_accvgpr_write_b32 a29, v241
    v_accvgpr_write_b32 a30, v242
    v_accvgpr_write_b32 a31, v243
    v_accvgpr_read_b32 v240, a48
    v_accvgpr_read_b32 v241, a49
    v_accvgpr_read_b32 v242, a50
    v_accvgpr_read_b32 v243, a51
    v_mul_f32 v240, v240, v45
    v_mul_f32 v241, v241, v45
    v_mul_f32 v242, v242, v45
    v_mul_f32 v243, v243, v45
    v_accvgpr_write_b32 a48, v240
    v_accvgpr_write_b32 a49, v241
    v_accvgpr_write_b32 a50, v242
    v_accvgpr_write_b32 a51, v243
    v_accvgpr_read_b32 v240, a52
    v_accvgpr_read_b32 v241, a53
    v_accvgpr_read_b32 v242, a54
    v_accvgpr_read_b32 v243, a55
    v_mul_f32 v240, v240, v45
    v_mul_f32 v241, v241, v45
    v_mul_f32 v242, v242, v45
    v_mul_f32 v243, v243, v45
    v_accvgpr_write_b32 a52, v240
    v_accvgpr_write_b32 a53, v241
    v_accvgpr_write_b32 a54, v242
    v_accvgpr_write_b32 a55, v243
    v_accvgpr_read_b32 v240, a56
    v_accvgpr_read_b32 v241, a57
    v_accvgpr_read_b32 v242, a58
    v_accvgpr_read_b32 v243, a59
    v_mul_f32 v240, v240, v45
    v_mul_f32 v241, v241, v45
    v_mul_f32 v242, v242, v45
    v_mul_f32 v243, v243, v45
    v_accvgpr_write_b32 a56, v240
    v_accvgpr_write_b32 a57, v241
    v_accvgpr_write_b32 a58, v242
    v_accvgpr_write_b32 a59, v243
    v_accvgpr_read_b32 v240, a60
    v_accvgpr_read_b32 v241, a61
    v_accvgpr_read_b32 v242, a62
    v_accvgpr_read_b32 v243, a63
    v_mul_f32 v240, v240, v45
    v_mul_f32 v241, v241, v45
    v_mul_f32 v242, v242, v45
    v_mul_f32 v243, v243, v45
    v_accvgpr_write_b32 a60, v240
    v_accvgpr_write_b32 a61, v241
    v_accvgpr_write_b32 a62, v242
    v_accvgpr_write_b32 a63, v243
    v_accvgpr_read_b32 v240, a80
    v_accvgpr_read_b32 v241, a81
    v_accvgpr_read_b32 v242, a82
    v_accvgpr_read_b32 v243, a83
    v_mul_f32 v240, v240, v45
    v_mul_f32 v241, v241, v45
    v_mul_f32 v242, v242, v45
    v_mul_f32 v243, v243, v45
    v_accvgpr_write_b32 a80, v240
    v_accvgpr_write_b32 a81, v241
    v_accvgpr_write_b32 a82, v242
    v_accvgpr_write_b32 a83, v243
    v_accvgpr_read_b32 v240, a84
    v_accvgpr_read_b32 v241, a85
    v_accvgpr_read_b32 v242, a86
    v_accvgpr_read_b32 v243, a87
    v_mul_f32 v240, v240, v45
    v_mul_f32 v241, v241, v45
    v_mul_f32 v242, v242, v45
    v_mul_f32 v243, v243, v45
    v_accvgpr_write_b32 a84, v240
    v_accvgpr_write_b32 a85, v241
    v_accvgpr_write_b32 a86, v242
    v_accvgpr_write_b32 a87, v243
    v_accvgpr_read_b32 v240, a88
    v_accvgpr_read_b32 v241, a89
    v_accvgpr_read_b32 v242, a90
    v_accvgpr_read_b32 v243, a91
    v_mul_f32 v240, v240, v45
    v_mul_f32 v241, v241, v45
    v_mul_f32 v242, v242, v45
    v_mul_f32 v243, v243, v45
    v_accvgpr_write_b32 a88, v240
    v_accvgpr_write_b32 a89, v241
    v_accvgpr_write_b32 a90, v242
    v_accvgpr_write_b32 a91, v243
    v_accvgpr_read_b32 v240, a92
    v_accvgpr_read_b32 v241, a93
    v_accvgpr_read_b32 v242, a94
    v_accvgpr_read_b32 v243, a95
    v_mul_f32 v240, v240, v45
    v_mul_f32 v241, v241, v45
    v_mul_f32 v242, v242, v45
    v_mul_f32 v243, v243, v45
    v_accvgpr_write_b32 a92, v240
    v_accvgpr_write_b32 a93, v241
    v_accvgpr_write_b32 a94, v242
    v_accvgpr_write_b32 a95, v243
    v_accvgpr_read_b32 v240, a112
    v_accvgpr_read_b32 v241, a113
    v_accvgpr_read_b32 v242, a114
    v_accvgpr_read_b32 v243, a115
    v_mul_f32 v240, v240, v45
    v_mul_f32 v241, v241, v45
    v_mul_f32 v242, v242, v45
    v_mul_f32 v243, v243, v45
    v_accvgpr_write_b32 a112, v240
    v_accvgpr_write_b32 a113, v241
    v_accvgpr_write_b32 a114, v242
    v_accvgpr_write_b32 a115, v243
    v_accvgpr_read_b32 v240, a116
    v_accvgpr_read_b32 v241, a117
    v_accvgpr_read_b32 v242, a118
    v_accvgpr_read_b32 v243, a119
    v_mul_f32 v240, v240, v45
    v_mul_f32 v241, v241, v45
    v_mul_f32 v242, v242, v45
    v_mul_f32 v243, v243, v45
    v_accvgpr_write_b32 a116, v240
    v_accvgpr_write_b32 a117, v241
    v_accvgpr_write_b32 a118, v242
    v_accvgpr_write_b32 a119, v243
    v_accvgpr_read_b32 v240, a120
    v_accvgpr_read_b32 v241, a121
    v_accvgpr_read_b32 v242, a122
    v_accvgpr_read_b32 v243, a123
    v_mul_f32 v240, v240, v45
    v_mul_f32 v241, v241, v45
    v_mul_f32 v242, v242, v45
    v_mul_f32 v243, v243, v45
    v_accvgpr_write_b32 a120, v240
    v_accvgpr_write_b32 a121, v241
    v_accvgpr_write_b32 a122, v242
    v_accvgpr_write_b32 a123, v243
    v_accvgpr_read_b32 v240, a124
    v_accvgpr_read_b32 v241, a125
    v_accvgpr_read_b32 v242, a126
    v_accvgpr_read_b32 v243, a127
    v_mul_f32 v240, v240, v45
    v_mul_f32 v241, v241, v45
    v_mul_f32 v242, v242, v45
    v_mul_f32 v243, v243, v45
    v_accvgpr_write_b32 a124, v240
    v_accvgpr_write_b32 a125, v241
    v_accvgpr_write_b32 a126, v242
    v_accvgpr_write_b32 a127, v243
    s_nop 3
    s_branch attn_kernel_nr0
attn_kernel_rs1:
    s_nop 15
    s_nop 15
    v_max_f32 v42, 0, v37
    v_exp_f32 v44, -v42
    v_max_f32 v43, 0, v38
    v_exp_f32 v45, -v43
    s_nop 0
    v_sub_f32 v48, v48, v42
    v_sub_f32 v49, v49, v42
    v_sub_f32 v50, v50, v42
    v_sub_f32 v51, v51, v42
    v_sub_f32 v52, v52, v42
    v_sub_f32 v53, v53, v42
    v_sub_f32 v54, v54, v42
    v_sub_f32 v55, v55, v42
    v_sub_f32 v56, v56, v42
    v_sub_f32 v57, v57, v42
    v_sub_f32 v58, v58, v42
    v_sub_f32 v59, v59, v42
    v_sub_f32 v60, v60, v42
    v_sub_f32 v61, v61, v42
    v_sub_f32 v62, v62, v42
    v_sub_f32 v63, v63, v42
    v_sub_f32 v80, v80, v42
    v_sub_f32 v81, v81, v42
    v_sub_f32 v82, v82, v42
    v_sub_f32 v83, v83, v42
    v_sub_f32 v84, v84, v42
    v_sub_f32 v85, v85, v42
    v_sub_f32 v86, v86, v42
    v_sub_f32 v87, v87, v42
    v_sub_f32 v88, v88, v42
    v_sub_f32 v89, v89, v42
    v_sub_f32 v90, v90, v42
    v_sub_f32 v91, v91, v42
    v_sub_f32 v92, v92, v42
    v_sub_f32 v93, v93, v42
    v_sub_f32 v94, v94, v42
    v_sub_f32 v95, v95, v42
    v_sub_f32 v208, v208, v42
    v_sub_f32 v209, v209, v42
    v_sub_f32 v210, v210, v42
    v_sub_f32 v211, v211, v42
    v_sub_f32 v212, v212, v42
    v_sub_f32 v213, v213, v42
    v_sub_f32 v214, v214, v42
    v_sub_f32 v215, v215, v42
    v_sub_f32 v216, v216, v42
    v_sub_f32 v217, v217, v42
    v_sub_f32 v218, v218, v42
    v_sub_f32 v219, v219, v42
    v_sub_f32 v220, v220, v42
    v_sub_f32 v221, v221, v42
    v_sub_f32 v222, v222, v42
    v_sub_f32 v223, v223, v42
    v_mul_f32 v33, v33, v44
    v_mul_f32 v34, v34, v44
    v_accvgpr_read_b32 v240, a0
    v_accvgpr_read_b32 v241, a1
    v_accvgpr_read_b32 v242, a2
    v_accvgpr_read_b32 v243, a3
    v_mul_f32 v240, v240, v44
    v_mul_f32 v241, v241, v44
    v_mul_f32 v242, v242, v44
    v_mul_f32 v243, v243, v44
    v_accvgpr_write_b32 a0, v240
    v_accvgpr_write_b32 a1, v241
    v_accvgpr_write_b32 a2, v242
    v_accvgpr_write_b32 a3, v243
    v_accvgpr_read_b32 v240, a4
    v_accvgpr_read_b32 v241, a5
    v_accvgpr_read_b32 v242, a6
    v_accvgpr_read_b32 v243, a7
    v_mul_f32 v240, v240, v44
    v_mul_f32 v241, v241, v44
    v_mul_f32 v242, v242, v44
    v_mul_f32 v243, v243, v44
    v_accvgpr_write_b32 a4, v240
    v_accvgpr_write_b32 a5, v241
    v_accvgpr_write_b32 a6, v242
    v_accvgpr_write_b32 a7, v243
    v_accvgpr_read_b32 v240, a8
    v_accvgpr_read_b32 v241, a9
    v_accvgpr_read_b32 v242, a10
    v_accvgpr_read_b32 v243, a11
    v_mul_f32 v240, v240, v44
    v_mul_f32 v241, v241, v44
    v_mul_f32 v242, v242, v44
    v_mul_f32 v243, v243, v44
    v_accvgpr_write_b32 a8, v240
    v_accvgpr_write_b32 a9, v241
    v_accvgpr_write_b32 a10, v242
    v_accvgpr_write_b32 a11, v243
    v_accvgpr_read_b32 v240, a12
    v_accvgpr_read_b32 v241, a13
    v_accvgpr_read_b32 v242, a14
    v_accvgpr_read_b32 v243, a15
    v_mul_f32 v240, v240, v44
    v_mul_f32 v241, v241, v44
    v_mul_f32 v242, v242, v44
    v_mul_f32 v243, v243, v44
    v_accvgpr_write_b32 a12, v240
    v_accvgpr_write_b32 a13, v241
    v_accvgpr_write_b32 a14, v242
    v_accvgpr_write_b32 a15, v243
    v_accvgpr_read_b32 v240, a32
    v_accvgpr_read_b32 v241, a33
    v_accvgpr_read_b32 v242, a34
    v_accvgpr_read_b32 v243, a35
    v_mul_f32 v240, v240, v44
    v_mul_f32 v241, v241, v44
    v_mul_f32 v242, v242, v44
    v_mul_f32 v243, v243, v44
    v_accvgpr_write_b32 a32, v240
    v_accvgpr_write_b32 a33, v241
    v_accvgpr_write_b32 a34, v242
    v_accvgpr_write_b32 a35, v243
    v_accvgpr_read_b32 v240, a36
    v_accvgpr_read_b32 v241, a37
    v_accvgpr_read_b32 v242, a38
    v_accvgpr_read_b32 v243, a39
    v_mul_f32 v240, v240, v44
    v_mul_f32 v241, v241, v44
    v_mul_f32 v242, v242, v44
    v_mul_f32 v243, v243, v44
    v_accvgpr_write_b32 a36, v240
    v_accvgpr_write_b32 a37, v241
    v_accvgpr_write_b32 a38, v242
    v_accvgpr_write_b32 a39, v243
    v_accvgpr_read_b32 v240, a40
    v_accvgpr_read_b32 v241, a41
    v_accvgpr_read_b32 v242, a42
    v_accvgpr_read_b32 v243, a43
    v_mul_f32 v240, v240, v44
    v_mul_f32 v241, v241, v44
    v_mul_f32 v242, v242, v44
    v_mul_f32 v243, v243, v44
    v_accvgpr_write_b32 a40, v240
    v_accvgpr_write_b32 a41, v241
    v_accvgpr_write_b32 a42, v242
    v_accvgpr_write_b32 a43, v243
    v_accvgpr_read_b32 v240, a44
    v_accvgpr_read_b32 v241, a45
    v_accvgpr_read_b32 v242, a46
    v_accvgpr_read_b32 v243, a47
    v_mul_f32 v240, v240, v44
    v_mul_f32 v241, v241, v44
    v_mul_f32 v242, v242, v44
    v_mul_f32 v243, v243, v44
    v_accvgpr_write_b32 a44, v240
    v_accvgpr_write_b32 a45, v241
    v_accvgpr_write_b32 a46, v242
    v_accvgpr_write_b32 a47, v243
    v_accvgpr_read_b32 v240, a64
    v_accvgpr_read_b32 v241, a65
    v_accvgpr_read_b32 v242, a66
    v_accvgpr_read_b32 v243, a67
    v_mul_f32 v240, v240, v44
    v_mul_f32 v241, v241, v44
    v_mul_f32 v242, v242, v44
    v_mul_f32 v243, v243, v44
    v_accvgpr_write_b32 a64, v240
    v_accvgpr_write_b32 a65, v241
    v_accvgpr_write_b32 a66, v242
    v_accvgpr_write_b32 a67, v243
    v_accvgpr_read_b32 v240, a68
    v_accvgpr_read_b32 v241, a69
    v_accvgpr_read_b32 v242, a70
    v_accvgpr_read_b32 v243, a71
    v_mul_f32 v240, v240, v44
    v_mul_f32 v241, v241, v44
    v_mul_f32 v242, v242, v44
    v_mul_f32 v243, v243, v44
    v_accvgpr_write_b32 a68, v240
    v_accvgpr_write_b32 a69, v241
    v_accvgpr_write_b32 a70, v242
    v_accvgpr_write_b32 a71, v243
    v_accvgpr_read_b32 v240, a72
    v_accvgpr_read_b32 v241, a73
    v_accvgpr_read_b32 v242, a74
    v_accvgpr_read_b32 v243, a75
    v_mul_f32 v240, v240, v44
    v_mul_f32 v241, v241, v44
    v_mul_f32 v242, v242, v44
    v_mul_f32 v243, v243, v44
    v_accvgpr_write_b32 a72, v240
    v_accvgpr_write_b32 a73, v241
    v_accvgpr_write_b32 a74, v242
    v_accvgpr_write_b32 a75, v243
    v_accvgpr_read_b32 v240, a76
    v_accvgpr_read_b32 v241, a77
    v_accvgpr_read_b32 v242, a78
    v_accvgpr_read_b32 v243, a79
    v_mul_f32 v240, v240, v44
    v_mul_f32 v241, v241, v44
    v_mul_f32 v242, v242, v44
    v_mul_f32 v243, v243, v44
    v_accvgpr_write_b32 a76, v240
    v_accvgpr_write_b32 a77, v241
    v_accvgpr_write_b32 a78, v242
    v_accvgpr_write_b32 a79, v243
    v_accvgpr_read_b32 v240, a96
    v_accvgpr_read_b32 v241, a97
    v_accvgpr_read_b32 v242, a98
    v_accvgpr_read_b32 v243, a99
    v_mul_f32 v240, v240, v44
    v_mul_f32 v241, v241, v44
    v_mul_f32 v242, v242, v44
    v_mul_f32 v243, v243, v44
    v_accvgpr_write_b32 a96, v240
    v_accvgpr_write_b32 a97, v241
    v_accvgpr_write_b32 a98, v242
    v_accvgpr_write_b32 a99, v243
    v_accvgpr_read_b32 v240, a100
    v_accvgpr_read_b32 v241, a101
    v_accvgpr_read_b32 v242, a102
    v_accvgpr_read_b32 v243, a103
    v_mul_f32 v240, v240, v44
    v_mul_f32 v241, v241, v44
    v_mul_f32 v242, v242, v44
    v_mul_f32 v243, v243, v44
    v_accvgpr_write_b32 a100, v240
    v_accvgpr_write_b32 a101, v241
    v_accvgpr_write_b32 a102, v242
    v_accvgpr_write_b32 a103, v243
    v_accvgpr_read_b32 v240, a104
    v_accvgpr_read_b32 v241, a105
    v_accvgpr_read_b32 v242, a106
    v_accvgpr_read_b32 v243, a107
    v_mul_f32 v240, v240, v44
    v_mul_f32 v241, v241, v44
    v_mul_f32 v242, v242, v44
    v_mul_f32 v243, v243, v44
    v_accvgpr_write_b32 a104, v240
    v_accvgpr_write_b32 a105, v241
    v_accvgpr_write_b32 a106, v242
    v_accvgpr_write_b32 a107, v243
    v_accvgpr_read_b32 v240, a108
    v_accvgpr_read_b32 v241, a109
    v_accvgpr_read_b32 v242, a110
    v_accvgpr_read_b32 v243, a111
    v_mul_f32 v240, v240, v44
    v_mul_f32 v241, v241, v44
    v_mul_f32 v242, v242, v44
    v_mul_f32 v243, v243, v44
    v_accvgpr_write_b32 a108, v240
    v_accvgpr_write_b32 a109, v241
    v_accvgpr_write_b32 a110, v242
    v_accvgpr_write_b32 a111, v243
    v_sub_f32 v64, v64, v43
    v_sub_f32 v65, v65, v43
    v_sub_f32 v66, v66, v43
    v_sub_f32 v67, v67, v43
    v_sub_f32 v68, v68, v43
    v_sub_f32 v69, v69, v43
    v_sub_f32 v70, v70, v43
    v_sub_f32 v71, v71, v43
    v_sub_f32 v72, v72, v43
    v_sub_f32 v73, v73, v43
    v_sub_f32 v74, v74, v43
    v_sub_f32 v75, v75, v43
    v_sub_f32 v76, v76, v43
    v_sub_f32 v77, v77, v43
    v_sub_f32 v78, v78, v43
    v_sub_f32 v79, v79, v43
    v_sub_f32 v96, v96, v43
    v_sub_f32 v97, v97, v43
    v_sub_f32 v98, v98, v43
    v_sub_f32 v99, v99, v43
    v_sub_f32 v100, v100, v43
    v_sub_f32 v101, v101, v43
    v_sub_f32 v102, v102, v43
    v_sub_f32 v103, v103, v43
    v_sub_f32 v104, v104, v43
    v_sub_f32 v105, v105, v43
    v_sub_f32 v106, v106, v43
    v_sub_f32 v107, v107, v43
    v_sub_f32 v108, v108, v43
    v_sub_f32 v109, v109, v43
    v_sub_f32 v110, v110, v43
    v_sub_f32 v111, v111, v43
    v_sub_f32 v224, v224, v43
    v_sub_f32 v225, v225, v43
    v_sub_f32 v226, v226, v43
    v_sub_f32 v227, v227, v43
    v_sub_f32 v228, v228, v43
    v_sub_f32 v229, v229, v43
    v_sub_f32 v230, v230, v43
    v_sub_f32 v231, v231, v43
    v_sub_f32 v232, v232, v43
    v_sub_f32 v233, v233, v43
    v_sub_f32 v234, v234, v43
    v_sub_f32 v235, v235, v43
    v_sub_f32 v236, v236, v43
    v_sub_f32 v237, v237, v43
    v_sub_f32 v238, v238, v43
    v_sub_f32 v239, v239, v43
    v_mul_f32 v35, v35, v45
    v_mul_f32 v36, v36, v45
    v_accvgpr_read_b32 v240, a16
    v_accvgpr_read_b32 v241, a17
    v_accvgpr_read_b32 v242, a18
    v_accvgpr_read_b32 v243, a19
    v_mul_f32 v240, v240, v45
    v_mul_f32 v241, v241, v45
    v_mul_f32 v242, v242, v45
    v_mul_f32 v243, v243, v45
    v_accvgpr_write_b32 a16, v240
    v_accvgpr_write_b32 a17, v241
    v_accvgpr_write_b32 a18, v242
    v_accvgpr_write_b32 a19, v243
    v_accvgpr_read_b32 v240, a20
    v_accvgpr_read_b32 v241, a21
    v_accvgpr_read_b32 v242, a22
    v_accvgpr_read_b32 v243, a23
    v_mul_f32 v240, v240, v45
    v_mul_f32 v241, v241, v45
    v_mul_f32 v242, v242, v45
    v_mul_f32 v243, v243, v45
    v_accvgpr_write_b32 a20, v240
    v_accvgpr_write_b32 a21, v241
    v_accvgpr_write_b32 a22, v242
    v_accvgpr_write_b32 a23, v243
    v_accvgpr_read_b32 v240, a24
    v_accvgpr_read_b32 v241, a25
    v_accvgpr_read_b32 v242, a26
    v_accvgpr_read_b32 v243, a27
    v_mul_f32 v240, v240, v45
    v_mul_f32 v241, v241, v45
    v_mul_f32 v242, v242, v45
    v_mul_f32 v243, v243, v45
    v_accvgpr_write_b32 a24, v240
    v_accvgpr_write_b32 a25, v241
    v_accvgpr_write_b32 a26, v242
    v_accvgpr_write_b32 a27, v243
    v_accvgpr_read_b32 v240, a28
    v_accvgpr_read_b32 v241, a29
    v_accvgpr_read_b32 v242, a30
    v_accvgpr_read_b32 v243, a31
    v_mul_f32 v240, v240, v45
    v_mul_f32 v241, v241, v45
    v_mul_f32 v242, v242, v45
    v_mul_f32 v243, v243, v45
    v_accvgpr_write_b32 a28, v240
    v_accvgpr_write_b32 a29, v241
    v_accvgpr_write_b32 a30, v242
    v_accvgpr_write_b32 a31, v243
    v_accvgpr_read_b32 v240, a48
    v_accvgpr_read_b32 v241, a49
    v_accvgpr_read_b32 v242, a50
    v_accvgpr_read_b32 v243, a51
    v_mul_f32 v240, v240, v45
    v_mul_f32 v241, v241, v45
    v_mul_f32 v242, v242, v45
    v_mul_f32 v243, v243, v45
    v_accvgpr_write_b32 a48, v240
    v_accvgpr_write_b32 a49, v241
    v_accvgpr_write_b32 a50, v242
    v_accvgpr_write_b32 a51, v243
    v_accvgpr_read_b32 v240, a52
    v_accvgpr_read_b32 v241, a53
    v_accvgpr_read_b32 v242, a54
    v_accvgpr_read_b32 v243, a55
    v_mul_f32 v240, v240, v45
    v_mul_f32 v241, v241, v45
    v_mul_f32 v242, v242, v45
    v_mul_f32 v243, v243, v45
    v_accvgpr_write_b32 a52, v240
    v_accvgpr_write_b32 a53, v241
    v_accvgpr_write_b32 a54, v242
    v_accvgpr_write_b32 a55, v243
    v_accvgpr_read_b32 v240, a56
    v_accvgpr_read_b32 v241, a57
    v_accvgpr_read_b32 v242, a58
    v_accvgpr_read_b32 v243, a59
    v_mul_f32 v240, v240, v45
    v_mul_f32 v241, v241, v45
    v_mul_f32 v242, v242, v45
    v_mul_f32 v243, v243, v45
    v_accvgpr_write_b32 a56, v240
    v_accvgpr_write_b32 a57, v241
    v_accvgpr_write_b32 a58, v242
    v_accvgpr_write_b32 a59, v243
    v_accvgpr_read_b32 v240, a60
    v_accvgpr_read_b32 v241, a61
    v_accvgpr_read_b32 v242, a62
    v_accvgpr_read_b32 v243, a63
    v_mul_f32 v240, v240, v45
    v_mul_f32 v241, v241, v45
    v_mul_f32 v242, v242, v45
    v_mul_f32 v243, v243, v45
    v_accvgpr_write_b32 a60, v240
    v_accvgpr_write_b32 a61, v241
    v_accvgpr_write_b32 a62, v242
    v_accvgpr_write_b32 a63, v243
    v_accvgpr_read_b32 v240, a80
    v_accvgpr_read_b32 v241, a81
    v_accvgpr_read_b32 v242, a82
    v_accvgpr_read_b32 v243, a83
    v_mul_f32 v240, v240, v45
    v_mul_f32 v241, v241, v45
    v_mul_f32 v242, v242, v45
    v_mul_f32 v243, v243, v45
    v_accvgpr_write_b32 a80, v240
    v_accvgpr_write_b32 a81, v241
    v_accvgpr_write_b32 a82, v242
    v_accvgpr_write_b32 a83, v243
    v_accvgpr_read_b32 v240, a84
    v_accvgpr_read_b32 v241, a85
    v_accvgpr_read_b32 v242, a86
    v_accvgpr_read_b32 v243, a87
    v_mul_f32 v240, v240, v45
    v_mul_f32 v241, v241, v45
    v_mul_f32 v242, v242, v45
    v_mul_f32 v243, v243, v45
    v_accvgpr_write_b32 a84, v240
    v_accvgpr_write_b32 a85, v241
    v_accvgpr_write_b32 a86, v242
    v_accvgpr_write_b32 a87, v243
    v_accvgpr_read_b32 v240, a88
    v_accvgpr_read_b32 v241, a89
    v_accvgpr_read_b32 v242, a90
    v_accvgpr_read_b32 v243, a91
    v_mul_f32 v240, v240, v45
    v_mul_f32 v241, v241, v45
    v_mul_f32 v242, v242, v45
    v_mul_f32 v243, v243, v45
    v_accvgpr_write_b32 a88, v240
    v_accvgpr_write_b32 a89, v241
    v_accvgpr_write_b32 a90, v242
    v_accvgpr_write_b32 a91, v243
    v_accvgpr_read_b32 v240, a92
    v_accvgpr_read_b32 v241, a93
    v_accvgpr_read_b32 v242, a94
    v_accvgpr_read_b32 v243, a95
    v_mul_f32 v240, v240, v45
    v_mul_f32 v241, v241, v45
    v_mul_f32 v242, v242, v45
    v_mul_f32 v243, v243, v45
    v_accvgpr_write_b32 a92, v240
    v_accvgpr_write_b32 a93, v241
    v_accvgpr_write_b32 a94, v242
    v_accvgpr_write_b32 a95, v243
    v_accvgpr_read_b32 v240, a112
    v_accvgpr_read_b32 v241, a113
    v_accvgpr_read_b32 v242, a114
    v_accvgpr_read_b32 v243, a115
    v_mul_f32 v240, v240, v45
    v_mul_f32 v241, v241, v45
    v_mul_f32 v242, v242, v45
    v_mul_f32 v243, v243, v45
    v_accvgpr_write_b32 a112, v240
    v_accvgpr_write_b32 a113, v241
    v_accvgpr_write_b32 a114, v242
    v_accvgpr_write_b32 a115, v243
    v_accvgpr_read_b32 v240, a116
    v_accvgpr_read_b32 v241, a117
    v_accvgpr_read_b32 v242, a118
    v_accvgpr_read_b32 v243, a119
    v_mul_f32 v240, v240, v45
    v_mul_f32 v241, v241, v45
    v_mul_f32 v242, v242, v45
    v_mul_f32 v243, v243, v45
    v_accvgpr_write_b32 a116, v240
    v_accvgpr_write_b32 a117, v241
    v_accvgpr_write_b32 a118, v242
    v_accvgpr_write_b32 a119, v243
    v_accvgpr_read_b32 v240, a120
    v_accvgpr_read_b32 v241, a121
    v_accvgpr_read_b32 v242, a122
    v_accvgpr_read_b32 v243, a123
    v_mul_f32 v240, v240, v45
    v_mul_f32 v241, v241, v45
    v_mul_f32 v242, v242, v45
    v_mul_f32 v243, v243, v45
    v_accvgpr_write_b32 a120, v240
    v_accvgpr_write_b32 a121, v241
    v_accvgpr_write_b32 a122, v242
    v_accvgpr_write_b32 a123, v243
    v_accvgpr_read_b32 v240, a124
    v_accvgpr_read_b32 v241, a125
    v_accvgpr_read_b32 v242, a126
    v_accvgpr_read_b32 v243, a127
    v_mul_f32 v240, v240, v45
    v_mul_f32 v241, v241, v45
    v_mul_f32 v242, v242, v45
    v_mul_f32 v243, v243, v45
    v_accvgpr_write_b32 a124, v240
    v_accvgpr_write_b32 a125, v241
    v_accvgpr_write_b32 a126, v242
    v_accvgpr_write_b32 a127, v243
    s_nop 3
    s_branch attn_kernel_nr1
attn_kernel_rs2:
    s_nop 15
    s_nop 15
    v_max_f32 v42, 0, v37
    v_exp_f32 v44, -v42
    v_max_f32 v43, 0, v38
    v_exp_f32 v45, -v43
    s_nop 0
    v_sub_f32 v112, v112, v42
    v_sub_f32 v113, v113, v42
    v_sub_f32 v114, v114, v42
    v_sub_f32 v115, v115, v42
    v_sub_f32 v116, v116, v42
    v_sub_f32 v117, v117, v42
    v_sub_f32 v118, v118, v42
    v_sub_f32 v119, v119, v42
    v_sub_f32 v120, v120, v42
    v_sub_f32 v121, v121, v42
    v_sub_f32 v122, v122, v42
    v_sub_f32 v123, v123, v42
    v_sub_f32 v124, v124, v42
    v_sub_f32 v125, v125, v42
    v_sub_f32 v126, v126, v42
    v_sub_f32 v127, v127, v42
    v_sub_f32 v144, v144, v42
    v_sub_f32 v145, v145, v42
    v_sub_f32 v146, v146, v42
    v_sub_f32 v147, v147, v42
    v_sub_f32 v148, v148, v42
    v_sub_f32 v149, v149, v42
    v_sub_f32 v150, v150, v42
    v_sub_f32 v151, v151, v42
    v_sub_f32 v152, v152, v42
    v_sub_f32 v153, v153, v42
    v_sub_f32 v154, v154, v42
    v_sub_f32 v155, v155, v42
    v_sub_f32 v156, v156, v42
    v_sub_f32 v157, v157, v42
    v_sub_f32 v158, v158, v42
    v_sub_f32 v159, v159, v42
    v_sub_f32 v208, v208, v42
    v_sub_f32 v209, v209, v42
    v_sub_f32 v210, v210, v42
    v_sub_f32 v211, v211, v42
    v_sub_f32 v212, v212, v42
    v_sub_f32 v213, v213, v42
    v_sub_f32 v214, v214, v42
    v_sub_f32 v215, v215, v42
    v_sub_f32 v216, v216, v42
    v_sub_f32 v217, v217, v42
    v_sub_f32 v218, v218, v42
    v_sub_f32 v219, v219, v42
    v_sub_f32 v220, v220, v42
    v_sub_f32 v221, v221, v42
    v_sub_f32 v222, v222, v42
    v_sub_f32 v223, v223, v42
    v_mul_f32 v33, v33, v44
    v_mul_f32 v34, v34, v44
    v_accvgpr_read_b32 v240, a0
    v_accvgpr_read_b32 v241, a1
    v_accvgpr_read_b32 v242, a2
    v_accvgpr_read_b32 v243, a3
    v_mul_f32 v240, v240, v44
    v_mul_f32 v241, v241, v44
    v_mul_f32 v242, v242, v44
    v_mul_f32 v243, v243, v44
    v_accvgpr_write_b32 a0, v240
    v_accvgpr_write_b32 a1, v241
    v_accvgpr_write_b32 a2, v242
    v_accvgpr_write_b32 a3, v243
    v_accvgpr_read_b32 v240, a4
    v_accvgpr_read_b32 v241, a5
    v_accvgpr_read_b32 v242, a6
    v_accvgpr_read_b32 v243, a7
    v_mul_f32 v240, v240, v44
    v_mul_f32 v241, v241, v44
    v_mul_f32 v242, v242, v44
    v_mul_f32 v243, v243, v44
    v_accvgpr_write_b32 a4, v240
    v_accvgpr_write_b32 a5, v241
    v_accvgpr_write_b32 a6, v242
    v_accvgpr_write_b32 a7, v243
    v_accvgpr_read_b32 v240, a8
    v_accvgpr_read_b32 v241, a9
    v_accvgpr_read_b32 v242, a10
    v_accvgpr_read_b32 v243, a11
    v_mul_f32 v240, v240, v44
    v_mul_f32 v241, v241, v44
    v_mul_f32 v242, v242, v44
    v_mul_f32 v243, v243, v44
    v_accvgpr_write_b32 a8, v240
    v_accvgpr_write_b32 a9, v241
    v_accvgpr_write_b32 a10, v242
    v_accvgpr_write_b32 a11, v243
    v_accvgpr_read_b32 v240, a12
    v_accvgpr_read_b32 v241, a13
    v_accvgpr_read_b32 v242, a14
    v_accvgpr_read_b32 v243, a15
    v_mul_f32 v240, v240, v44
    v_mul_f32 v241, v241, v44
    v_mul_f32 v242, v242, v44
    v_mul_f32 v243, v243, v44
    v_accvgpr_write_b32 a12, v240
    v_accvgpr_write_b32 a13, v241
    v_accvgpr_write_b32 a14, v242
    v_accvgpr_write_b32 a15, v243
    v_accvgpr_read_b32 v240, a32
    v_accvgpr_read_b32 v241, a33
    v_accvgpr_read_b32 v242, a34
    v_accvgpr_read_b32 v243, a35
    v_mul_f32 v240, v240, v44
    v_mul_f32 v241, v241, v44
    v_mul_f32 v242, v242, v44
    v_mul_f32 v243, v243, v44
    v_accvgpr_write_b32 a32, v240
    v_accvgpr_write_b32 a33, v241
    v_accvgpr_write_b32 a34, v242
    v_accvgpr_write_b32 a35, v243
    v_accvgpr_read_b32 v240, a36
    v_accvgpr_read_b32 v241, a37
    v_accvgpr_read_b32 v242, a38
    v_accvgpr_read_b32 v243, a39
    v_mul_f32 v240, v240, v44
    v_mul_f32 v241, v241, v44
    v_mul_f32 v242, v242, v44
    v_mul_f32 v243, v243, v44
    v_accvgpr_write_b32 a36, v240
    v_accvgpr_write_b32 a37, v241
    v_accvgpr_write_b32 a38, v242
    v_accvgpr_write_b32 a39, v243
    v_accvgpr_read_b32 v240, a40
    v_accvgpr_read_b32 v241, a41
    v_accvgpr_read_b32 v242, a42
    v_accvgpr_read_b32 v243, a43
    v_mul_f32 v240, v240, v44
    v_mul_f32 v241, v241, v44
    v_mul_f32 v242, v242, v44
    v_mul_f32 v243, v243, v44
    v_accvgpr_write_b32 a40, v240
    v_accvgpr_write_b32 a41, v241
    v_accvgpr_write_b32 a42, v242
    v_accvgpr_write_b32 a43, v243
    v_accvgpr_read_b32 v240, a44
    v_accvgpr_read_b32 v241, a45
    v_accvgpr_read_b32 v242, a46
    v_accvgpr_read_b32 v243, a47
    v_mul_f32 v240, v240, v44
    v_mul_f32 v241, v241, v44
    v_mul_f32 v242, v242, v44
    v_mul_f32 v243, v243, v44
    v_accvgpr_write_b32 a44, v240
    v_accvgpr_write_b32 a45, v241
    v_accvgpr_write_b32 a46, v242
    v_accvgpr_write_b32 a47, v243
    v_accvgpr_read_b32 v240, a64
    v_accvgpr_read_b32 v241, a65
    v_accvgpr_read_b32 v242, a66
    v_accvgpr_read_b32 v243, a67
    v_mul_f32 v240, v240, v44
    v_mul_f32 v241, v241, v44
    v_mul_f32 v242, v242, v44
    v_mul_f32 v243, v243, v44
    v_accvgpr_write_b32 a64, v240
    v_accvgpr_write_b32 a65, v241
    v_accvgpr_write_b32 a66, v242
    v_accvgpr_write_b32 a67, v243
    v_accvgpr_read_b32 v240, a68
    v_accvgpr_read_b32 v241, a69
    v_accvgpr_read_b32 v242, a70
    v_accvgpr_read_b32 v243, a71
    v_mul_f32 v240, v240, v44
    v_mul_f32 v241, v241, v44
    v_mul_f32 v242, v242, v44
    v_mul_f32 v243, v243, v44
    v_accvgpr_write_b32 a68, v240
    v_accvgpr_write_b32 a69, v241
    v_accvgpr_write_b32 a70, v242
    v_accvgpr_write_b32 a71, v243
    v_accvgpr_read_b32 v240, a72
    v_accvgpr_read_b32 v241, a73
    v_accvgpr_read_b32 v242, a74
    v_accvgpr_read_b32 v243, a75
    v_mul_f32 v240, v240, v44
    v_mul_f32 v241, v241, v44
    v_mul_f32 v242, v242, v44
    v_mul_f32 v243, v243, v44
    v_accvgpr_write_b32 a72, v240
    v_accvgpr_write_b32 a73, v241
    v_accvgpr_write_b32 a74, v242
    v_accvgpr_write_b32 a75, v243
    v_accvgpr_read_b32 v240, a76
    v_accvgpr_read_b32 v241, a77
    v_accvgpr_read_b32 v242, a78
    v_accvgpr_read_b32 v243, a79
    v_mul_f32 v240, v240, v44
    v_mul_f32 v241, v241, v44
    v_mul_f32 v242, v242, v44
    v_mul_f32 v243, v243, v44
    v_accvgpr_write_b32 a76, v240
    v_accvgpr_write_b32 a77, v241
    v_accvgpr_write_b32 a78, v242
    v_accvgpr_write_b32 a79, v243
    v_accvgpr_read_b32 v240, a96
    v_accvgpr_read_b32 v241, a97
    v_accvgpr_read_b32 v242, a98
    v_accvgpr_read_b32 v243, a99
    v_mul_f32 v240, v240, v44
    v_mul_f32 v241, v241, v44
    v_mul_f32 v242, v242, v44
    v_mul_f32 v243, v243, v44
    v_accvgpr_write_b32 a96, v240
    v_accvgpr_write_b32 a97, v241
    v_accvgpr_write_b32 a98, v242
    v_accvgpr_write_b32 a99, v243
    v_accvgpr_read_b32 v240, a100
    v_accvgpr_read_b32 v241, a101
    v_accvgpr_read_b32 v242, a102
    v_accvgpr_read_b32 v243, a103
    v_mul_f32 v240, v240, v44
    v_mul_f32 v241, v241, v44
    v_mul_f32 v242, v242, v44
    v_mul_f32 v243, v243, v44
    v_accvgpr_write_b32 a100, v240
    v_accvgpr_write_b32 a101, v241
    v_accvgpr_write_b32 a102, v242
    v_accvgpr_write_b32 a103, v243
    v_accvgpr_read_b32 v240, a104
    v_accvgpr_read_b32 v241, a105
    v_accvgpr_read_b32 v242, a106
    v_accvgpr_read_b32 v243, a107
    v_mul_f32 v240, v240, v44
    v_mul_f32 v241, v241, v44
    v_mul_f32 v242, v242, v44
    v_mul_f32 v243, v243, v44
    v_accvgpr_write_b32 a104, v240
    v_accvgpr_write_b32 a105, v241
    v_accvgpr_write_b32 a106, v242
    v_accvgpr_write_b32 a107, v243
    v_accvgpr_read_b32 v240, a108
    v_accvgpr_read_b32 v241, a109
    v_accvgpr_read_b32 v242, a110
    v_accvgpr_read_b32 v243, a111
    v_mul_f32 v240, v240, v44
    v_mul_f32 v241, v241, v44
    v_mul_f32 v242, v242, v44
    v_mul_f32 v243, v243, v44
    v_accvgpr_write_b32 a108, v240
    v_accvgpr_write_b32 a109, v241
    v_accvgpr_write_b32 a110, v242
    v_accvgpr_write_b32 a111, v243
    v_sub_f32 v128, v128, v43
    v_sub_f32 v129, v129, v43
    v_sub_f32 v130, v130, v43
    v_sub_f32 v131, v131, v43
    v_sub_f32 v132, v132, v43
    v_sub_f32 v133, v133, v43
    v_sub_f32 v134, v134, v43
    v_sub_f32 v135, v135, v43
    v_sub_f32 v136, v136, v43
    v_sub_f32 v137, v137, v43
    v_sub_f32 v138, v138, v43
    v_sub_f32 v139, v139, v43
    v_sub_f32 v140, v140, v43
    v_sub_f32 v141, v141, v43
    v_sub_f32 v142, v142, v43
    v_sub_f32 v143, v143, v43
    v_sub_f32 v160, v160, v43
    v_sub_f32 v161, v161, v43
    v_sub_f32 v162, v162, v43
    v_sub_f32 v163, v163, v43
    v_sub_f32 v164, v164, v43
    v_sub_f32 v165, v165, v43
    v_sub_f32 v166, v166, v43
    v_sub_f32 v167, v167, v43
    v_sub_f32 v168, v168, v43
    v_sub_f32 v169, v169, v43
    v_sub_f32 v170, v170, v43
    v_sub_f32 v171, v171, v43
    v_sub_f32 v172, v172, v43
    v_sub_f32 v173, v173, v43
    v_sub_f32 v174, v174, v43
    v_sub_f32 v175, v175, v43
    v_sub_f32 v224, v224, v43
    v_sub_f32 v225, v225, v43
    v_sub_f32 v226, v226, v43
    v_sub_f32 v227, v227, v43
    v_sub_f32 v228, v228, v43
    v_sub_f32 v229, v229, v43
    v_sub_f32 v230, v230, v43
    v_sub_f32 v231, v231, v43
    v_sub_f32 v232, v232, v43
    v_sub_f32 v233, v233, v43
    v_sub_f32 v234, v234, v43
    v_sub_f32 v235, v235, v43
    v_sub_f32 v236, v236, v43
    v_sub_f32 v237, v237, v43
    v_sub_f32 v238, v238, v43
    v_sub_f32 v239, v239, v43
    v_mul_f32 v35, v35, v45
    v_mul_f32 v36, v36, v45
    v_accvgpr_read_b32 v240, a16
    v_accvgpr_read_b32 v241, a17
    v_accvgpr_read_b32 v242, a18
    v_accvgpr_read_b32 v243, a19
    v_mul_f32 v240, v240, v45
    v_mul_f32 v241, v241, v45
    v_mul_f32 v242, v242, v45
    v_mul_f32 v243, v243, v45
    v_accvgpr_write_b32 a16, v240
    v_accvgpr_write_b32 a17, v241
    v_accvgpr_write_b32 a18, v242
    v_accvgpr_write_b32 a19, v243
    v_accvgpr_read_b32 v240, a20
    v_accvgpr_read_b32 v241, a21
    v_accvgpr_read_b32 v242, a22
    v_accvgpr_read_b32 v243, a23
    v_mul_f32 v240, v240, v45
    v_mul_f32 v241, v241, v45
    v_mul_f32 v242, v242, v45
    v_mul_f32 v243, v243, v45
    v_accvgpr_write_b32 a20, v240
    v_accvgpr_write_b32 a21, v241
    v_accvgpr_write_b32 a22, v242
    v_accvgpr_write_b32 a23, v243
    v_accvgpr_read_b32 v240, a24
    v_accvgpr_read_b32 v241, a25
    v_accvgpr_read_b32 v242, a26
    v_accvgpr_read_b32 v243, a27
    v_mul_f32 v240, v240, v45
    v_mul_f32 v241, v241, v45
    v_mul_f32 v242, v242, v45
    v_mul_f32 v243, v243, v45
    v_accvgpr_write_b32 a24, v240
    v_accvgpr_write_b32 a25, v241
    v_accvgpr_write_b32 a26, v242
    v_accvgpr_write_b32 a27, v243
    v_accvgpr_read_b32 v240, a28
    v_accvgpr_read_b32 v241, a29
    v_accvgpr_read_b32 v242, a30
    v_accvgpr_read_b32 v243, a31
    v_mul_f32 v240, v240, v45
    v_mul_f32 v241, v241, v45
    v_mul_f32 v242, v242, v45
    v_mul_f32 v243, v243, v45
    v_accvgpr_write_b32 a28, v240
    v_accvgpr_write_b32 a29, v241
    v_accvgpr_write_b32 a30, v242
    v_accvgpr_write_b32 a31, v243
    v_accvgpr_read_b32 v240, a48
    v_accvgpr_read_b32 v241, a49
    v_accvgpr_read_b32 v242, a50
    v_accvgpr_read_b32 v243, a51
    v_mul_f32 v240, v240, v45
    v_mul_f32 v241, v241, v45
    v_mul_f32 v242, v242, v45
    v_mul_f32 v243, v243, v45
    v_accvgpr_write_b32 a48, v240
    v_accvgpr_write_b32 a49, v241
    v_accvgpr_write_b32 a50, v242
    v_accvgpr_write_b32 a51, v243
    v_accvgpr_read_b32 v240, a52
    v_accvgpr_read_b32 v241, a53
    v_accvgpr_read_b32 v242, a54
    v_accvgpr_read_b32 v243, a55
    v_mul_f32 v240, v240, v45
    v_mul_f32 v241, v241, v45
    v_mul_f32 v242, v242, v45
    v_mul_f32 v243, v243, v45
    v_accvgpr_write_b32 a52, v240
    v_accvgpr_write_b32 a53, v241
    v_accvgpr_write_b32 a54, v242
    v_accvgpr_write_b32 a55, v243
    v_accvgpr_read_b32 v240, a56
    v_accvgpr_read_b32 v241, a57
    v_accvgpr_read_b32 v242, a58
    v_accvgpr_read_b32 v243, a59
    v_mul_f32 v240, v240, v45
    v_mul_f32 v241, v241, v45
    v_mul_f32 v242, v242, v45
    v_mul_f32 v243, v243, v45
    v_accvgpr_write_b32 a56, v240
    v_accvgpr_write_b32 a57, v241
    v_accvgpr_write_b32 a58, v242
    v_accvgpr_write_b32 a59, v243
    v_accvgpr_read_b32 v240, a60
    v_accvgpr_read_b32 v241, a61
    v_accvgpr_read_b32 v242, a62
    v_accvgpr_read_b32 v243, a63
    v_mul_f32 v240, v240, v45
    v_mul_f32 v241, v241, v45
    v_mul_f32 v242, v242, v45
    v_mul_f32 v243, v243, v45
    v_accvgpr_write_b32 a60, v240
    v_accvgpr_write_b32 a61, v241
    v_accvgpr_write_b32 a62, v242
    v_accvgpr_write_b32 a63, v243
    v_accvgpr_read_b32 v240, a80
    v_accvgpr_read_b32 v241, a81
    v_accvgpr_read_b32 v242, a82
    v_accvgpr_read_b32 v243, a83
    v_mul_f32 v240, v240, v45
    v_mul_f32 v241, v241, v45
    v_mul_f32 v242, v242, v45
    v_mul_f32 v243, v243, v45
    v_accvgpr_write_b32 a80, v240
    v_accvgpr_write_b32 a81, v241
    v_accvgpr_write_b32 a82, v242
    v_accvgpr_write_b32 a83, v243
    v_accvgpr_read_b32 v240, a84
    v_accvgpr_read_b32 v241, a85
    v_accvgpr_read_b32 v242, a86
    v_accvgpr_read_b32 v243, a87
    v_mul_f32 v240, v240, v45
    v_mul_f32 v241, v241, v45
    v_mul_f32 v242, v242, v45
    v_mul_f32 v243, v243, v45
    v_accvgpr_write_b32 a84, v240
    v_accvgpr_write_b32 a85, v241
    v_accvgpr_write_b32 a86, v242
    v_accvgpr_write_b32 a87, v243
    v_accvgpr_read_b32 v240, a88
    v_accvgpr_read_b32 v241, a89
    v_accvgpr_read_b32 v242, a90
    v_accvgpr_read_b32 v243, a91
    v_mul_f32 v240, v240, v45
    v_mul_f32 v241, v241, v45
    v_mul_f32 v242, v242, v45
    v_mul_f32 v243, v243, v45
    v_accvgpr_write_b32 a88, v240
    v_accvgpr_write_b32 a89, v241
    v_accvgpr_write_b32 a90, v242
    v_accvgpr_write_b32 a91, v243
    v_accvgpr_read_b32 v240, a92
    v_accvgpr_read_b32 v241, a93
    v_accvgpr_read_b32 v242, a94
    v_accvgpr_read_b32 v243, a95
    v_mul_f32 v240, v240, v45
    v_mul_f32 v241, v241, v45
    v_mul_f32 v242, v242, v45
    v_mul_f32 v243, v243, v45
    v_accvgpr_write_b32 a92, v240
    v_accvgpr_write_b32 a93, v241
    v_accvgpr_write_b32 a94, v242
    v_accvgpr_write_b32 a95, v243
    v_accvgpr_read_b32 v240, a112
    v_accvgpr_read_b32 v241, a113
    v_accvgpr_read_b32 v242, a114
    v_accvgpr_read_b32 v243, a115
    v_mul_f32 v240, v240, v45
    v_mul_f32 v241, v241, v45
    v_mul_f32 v242, v242, v45
    v_mul_f32 v243, v243, v45
    v_accvgpr_write_b32 a112, v240
    v_accvgpr_write_b32 a113, v241
    v_accvgpr_write_b32 a114, v242
    v_accvgpr_write_b32 a115, v243
    v_accvgpr_read_b32 v240, a116
    v_accvgpr_read_b32 v241, a117
    v_accvgpr_read_b32 v242, a118
    v_accvgpr_read_b32 v243, a119
    v_mul_f32 v240, v240, v45
    v_mul_f32 v241, v241, v45
    v_mul_f32 v242, v242, v45
    v_mul_f32 v243, v243, v45
    v_accvgpr_write_b32 a116, v240
    v_accvgpr_write_b32 a117, v241
    v_accvgpr_write_b32 a118, v242
    v_accvgpr_write_b32 a119, v243
    v_accvgpr_read_b32 v240, a120
    v_accvgpr_read_b32 v241, a121
    v_accvgpr_read_b32 v242, a122
    v_accvgpr_read_b32 v243, a123
    v_mul_f32 v240, v240, v45
    v_mul_f32 v241, v241, v45
    v_mul_f32 v242, v242, v45
    v_mul_f32 v243, v243, v45
    v_accvgpr_write_b32 a120, v240
    v_accvgpr_write_b32 a121, v241
    v_accvgpr_write_b32 a122, v242
    v_accvgpr_write_b32 a123, v243
    v_accvgpr_read_b32 v240, a124
    v_accvgpr_read_b32 v241, a125
    v_accvgpr_read_b32 v242, a126
    v_accvgpr_read_b32 v243, a127
    v_mul_f32 v240, v240, v45
    v_mul_f32 v241, v241, v45
    v_mul_f32 v242, v242, v45
    v_mul_f32 v243, v243, v45
    v_accvgpr_write_b32 a124, v240
    v_accvgpr_write_b32 a125, v241
    v_accvgpr_write_b32 a126, v242
    v_accvgpr_write_b32 a127, v243
    s_nop 3
    s_branch attn_kernel_nr2
attn_kernel_rs3:
    s_nop 15
    s_nop 15
    v_max_f32 v42, 0, v37
    v_exp_f32 v44, -v42
    v_max_f32 v43, 0, v38
    v_exp_f32 v45, -v43
    s_nop 0
    v_sub_f32 v48, v48, v42
    v_sub_f32 v49, v49, v42
    v_sub_f32 v50, v50, v42
    v_sub_f32 v51, v51, v42
    v_sub_f32 v52, v52, v42
    v_sub_f32 v53, v53, v42
    v_sub_f32 v54, v54, v42
    v_sub_f32 v55, v55, v42
    v_sub_f32 v56, v56, v42
    v_sub_f32 v57, v57, v42
    v_sub_f32 v58, v58, v42
    v_sub_f32 v59, v59, v42
    v_sub_f32 v60, v60, v42
    v_sub_f32 v61, v61, v42
    v_sub_f32 v62, v62, v42
    v_sub_f32 v63, v63, v42
    v_sub_f32 v80, v80, v42
    v_sub_f32 v81, v81, v42
    v_sub_f32 v82, v82, v42
    v_sub_f32 v83, v83, v42
    v_sub_f32 v84, v84, v42
    v_sub_f32 v85, v85, v42
    v_sub_f32 v86, v86, v42
    v_sub_f32 v87, v87, v42
    v_sub_f32 v88, v88, v42
    v_sub_f32 v89, v89, v42
    v_sub_f32 v90, v90, v42
    v_sub_f32 v91, v91, v42
    v_sub_f32 v92, v92, v42
    v_sub_f32 v93, v93, v42
    v_sub_f32 v94, v94, v42
    v_sub_f32 v95, v95, v42
    v_sub_f32 v208, v208, v42
    v_sub_f32 v209, v209, v42
    v_sub_f32 v210, v210, v42
    v_sub_f32 v211, v211, v42
    v_sub_f32 v212, v212, v42
    v_sub_f32 v213, v213, v42
    v_sub_f32 v214, v214, v42
    v_sub_f32 v215, v215, v42
    v_sub_f32 v216, v216, v42
    v_sub_f32 v217, v217, v42
    v_sub_f32 v218, v218, v42
    v_sub_f32 v219, v219, v42
    v_sub_f32 v220, v220, v42
    v_sub_f32 v221, v221, v42
    v_sub_f32 v222, v222, v42
    v_sub_f32 v223, v223, v42
    v_mul_f32 v33, v33, v44
    v_mul_f32 v34, v34, v44
    v_accvgpr_read_b32 v240, a0
    v_accvgpr_read_b32 v241, a1
    v_accvgpr_read_b32 v242, a2
    v_accvgpr_read_b32 v243, a3
    v_mul_f32 v240, v240, v44
    v_mul_f32 v241, v241, v44
    v_mul_f32 v242, v242, v44
    v_mul_f32 v243, v243, v44
    v_accvgpr_write_b32 a0, v240
    v_accvgpr_write_b32 a1, v241
    v_accvgpr_write_b32 a2, v242
    v_accvgpr_write_b32 a3, v243
    v_accvgpr_read_b32 v240, a4
    v_accvgpr_read_b32 v241, a5
    v_accvgpr_read_b32 v242, a6
    v_accvgpr_read_b32 v243, a7
    v_mul_f32 v240, v240, v44
    v_mul_f32 v241, v241, v44
    v_mul_f32 v242, v242, v44
    v_mul_f32 v243, v243, v44
    v_accvgpr_write_b32 a4, v240
    v_accvgpr_write_b32 a5, v241
    v_accvgpr_write_b32 a6, v242
    v_accvgpr_write_b32 a7, v243
    v_accvgpr_read_b32 v240, a8
    v_accvgpr_read_b32 v241, a9
    v_accvgpr_read_b32 v242, a10
    v_accvgpr_read_b32 v243, a11
    v_mul_f32 v240, v240, v44
    v_mul_f32 v241, v241, v44
    v_mul_f32 v242, v242, v44
    v_mul_f32 v243, v243, v44
    v_accvgpr_write_b32 a8, v240
    v_accvgpr_write_b32 a9, v241
    v_accvgpr_write_b32 a10, v242
    v_accvgpr_write_b32 a11, v243
    v_accvgpr_read_b32 v240, a12
    v_accvgpr_read_b32 v241, a13
    v_accvgpr_read_b32 v242, a14
    v_accvgpr_read_b32 v243, a15
    v_mul_f32 v240, v240, v44
    v_mul_f32 v241, v241, v44
    v_mul_f32 v242, v242, v44
    v_mul_f32 v243, v243, v44
    v_accvgpr_write_b32 a12, v240
    v_accvgpr_write_b32 a13, v241
    v_accvgpr_write_b32 a14, v242
    v_accvgpr_write_b32 a15, v243
    v_accvgpr_read_b32 v240, a32
    v_accvgpr_read_b32 v241, a33
    v_accvgpr_read_b32 v242, a34
    v_accvgpr_read_b32 v243, a35
    v_mul_f32 v240, v240, v44
    v_mul_f32 v241, v241, v44
    v_mul_f32 v242, v242, v44
    v_mul_f32 v243, v243, v44
    v_accvgpr_write_b32 a32, v240
    v_accvgpr_write_b32 a33, v241
    v_accvgpr_write_b32 a34, v242
    v_accvgpr_write_b32 a35, v243
    v_accvgpr_read_b32 v240, a36
    v_accvgpr_read_b32 v241, a37
    v_accvgpr_read_b32 v242, a38
    v_accvgpr_read_b32 v243, a39
    v_mul_f32 v240, v240, v44
    v_mul_f32 v241, v241, v44
    v_mul_f32 v242, v242, v44
    v_mul_f32 v243, v243, v44
    v_accvgpr_write_b32 a36, v240
    v_accvgpr_write_b32 a37, v241
    v_accvgpr_write_b32 a38, v242
    v_accvgpr_write_b32 a39, v243
    v_accvgpr_read_b32 v240, a40
    v_accvgpr_read_b32 v241, a41
    v_accvgpr_read_b32 v242, a42
    v_accvgpr_read_b32 v243, a43
    v_mul_f32 v240, v240, v44
    v_mul_f32 v241, v241, v44
    v_mul_f32 v242, v242, v44
    v_mul_f32 v243, v243, v44
    v_accvgpr_write_b32 a40, v240
    v_accvgpr_write_b32 a41, v241
    v_accvgpr_write_b32 a42, v242
    v_accvgpr_write_b32 a43, v243
    v_accvgpr_read_b32 v240, a44
    v_accvgpr_read_b32 v241, a45
    v_accvgpr_read_b32 v242, a46
    v_accvgpr_read_b32 v243, a47
    v_mul_f32 v240, v240, v44
    v_mul_f32 v241, v241, v44
    v_mul_f32 v242, v242, v44
    v_mul_f32 v243, v243, v44
    v_accvgpr_write_b32 a44, v240
    v_accvgpr_write_b32 a45, v241
    v_accvgpr_write_b32 a46, v242
    v_accvgpr_write_b32 a47, v243
    v_accvgpr_read_b32 v240, a64
    v_accvgpr_read_b32 v241, a65
    v_accvgpr_read_b32 v242, a66
    v_accvgpr_read_b32 v243, a67
    v_mul_f32 v240, v240, v44
    v_mul_f32 v241, v241, v44
    v_mul_f32 v242, v242, v44
    v_mul_f32 v243, v243, v44
    v_accvgpr_write_b32 a64, v240
    v_accvgpr_write_b32 a65, v241
    v_accvgpr_write_b32 a66, v242
    v_accvgpr_write_b32 a67, v243
    v_accvgpr_read_b32 v240, a68
    v_accvgpr_read_b32 v241, a69
    v_accvgpr_read_b32 v242, a70
    v_accvgpr_read_b32 v243, a71
    v_mul_f32 v240, v240, v44
    v_mul_f32 v241, v241, v44
    v_mul_f32 v242, v242, v44
    v_mul_f32 v243, v243, v44
    v_accvgpr_write_b32 a68, v240
    v_accvgpr_write_b32 a69, v241
    v_accvgpr_write_b32 a70, v242
    v_accvgpr_write_b32 a71, v243
    v_accvgpr_read_b32 v240, a72
    v_accvgpr_read_b32 v241, a73
    v_accvgpr_read_b32 v242, a74
    v_accvgpr_read_b32 v243, a75
    v_mul_f32 v240, v240, v44
    v_mul_f32 v241, v241, v44
    v_mul_f32 v242, v242, v44
    v_mul_f32 v243, v243, v44
    v_accvgpr_write_b32 a72, v240
    v_accvgpr_write_b32 a73, v241
    v_accvgpr_write_b32 a74, v242
    v_accvgpr_write_b32 a75, v243
    v_accvgpr_read_b32 v240, a76
    v_accvgpr_read_b32 v241, a77
    v_accvgpr_read_b32 v242, a78
    v_accvgpr_read_b32 v243, a79
    v_mul_f32 v240, v240, v44
    v_mul_f32 v241, v241, v44
    v_mul_f32 v242, v242, v44
    v_mul_f32 v243, v243, v44
    v_accvgpr_write_b32 a76, v240
    v_accvgpr_write_b32 a77, v241
    v_accvgpr_write_b32 a78, v242
    v_accvgpr_write_b32 a79, v243
    v_accvgpr_read_b32 v240, a96
    v_accvgpr_read_b32 v241, a97
    v_accvgpr_read_b32 v242, a98
    v_accvgpr_read_b32 v243, a99
    v_mul_f32 v240, v240, v44
    v_mul_f32 v241, v241, v44
    v_mul_f32 v242, v242, v44
    v_mul_f32 v243, v243, v44
    v_accvgpr_write_b32 a96, v240
    v_accvgpr_write_b32 a97, v241
    v_accvgpr_write_b32 a98, v242
    v_accvgpr_write_b32 a99, v243
    v_accvgpr_read_b32 v240, a100
    v_accvgpr_read_b32 v241, a101
    v_accvgpr_read_b32 v242, a102
    v_accvgpr_read_b32 v243, a103
    v_mul_f32 v240, v240, v44
    v_mul_f32 v241, v241, v44
    v_mul_f32 v242, v242, v44
    v_mul_f32 v243, v243, v44
    v_accvgpr_write_b32 a100, v240
    v_accvgpr_write_b32 a101, v241
    v_accvgpr_write_b32 a102, v242
    v_accvgpr_write_b32 a103, v243
    v_accvgpr_read_b32 v240, a104
    v_accvgpr_read_b32 v241, a105
    v_accvgpr_read_b32 v242, a106
    v_accvgpr_read_b32 v243, a107
    v_mul_f32 v240, v240, v44
    v_mul_f32 v241, v241, v44
    v_mul_f32 v242, v242, v44
    v_mul_f32 v243, v243, v44
    v_accvgpr_write_b32 a104, v240
    v_accvgpr_write_b32 a105, v241
    v_accvgpr_write_b32 a106, v242
    v_accvgpr_write_b32 a107, v243
    v_accvgpr_read_b32 v240, a108
    v_accvgpr_read_b32 v241, a109
    v_accvgpr_read_b32 v242, a110
    v_accvgpr_read_b32 v243, a111
    v_mul_f32 v240, v240, v44
    v_mul_f32 v241, v241, v44
    v_mul_f32 v242, v242, v44
    v_mul_f32 v243, v243, v44
    v_accvgpr_write_b32 a108, v240
    v_accvgpr_write_b32 a109, v241
    v_accvgpr_write_b32 a110, v242
    v_accvgpr_write_b32 a111, v243
    v_sub_f32 v64, v64, v43
    v_sub_f32 v65, v65, v43
    v_sub_f32 v66, v66, v43
    v_sub_f32 v67, v67, v43
    v_sub_f32 v68, v68, v43
    v_sub_f32 v69, v69, v43
    v_sub_f32 v70, v70, v43
    v_sub_f32 v71, v71, v43
    v_sub_f32 v72, v72, v43
    v_sub_f32 v73, v73, v43
    v_sub_f32 v74, v74, v43
    v_sub_f32 v75, v75, v43
    v_sub_f32 v76, v76, v43
    v_sub_f32 v77, v77, v43
    v_sub_f32 v78, v78, v43
    v_sub_f32 v79, v79, v43
    v_sub_f32 v96, v96, v43
    v_sub_f32 v97, v97, v43
    v_sub_f32 v98, v98, v43
    v_sub_f32 v99, v99, v43
    v_sub_f32 v100, v100, v43
    v_sub_f32 v101, v101, v43
    v_sub_f32 v102, v102, v43
    v_sub_f32 v103, v103, v43
    v_sub_f32 v104, v104, v43
    v_sub_f32 v105, v105, v43
    v_sub_f32 v106, v106, v43
    v_sub_f32 v107, v107, v43
    v_sub_f32 v108, v108, v43
    v_sub_f32 v109, v109, v43
    v_sub_f32 v110, v110, v43
    v_sub_f32 v111, v111, v43
    v_sub_f32 v224, v224, v43
    v_sub_f32 v225, v225, v43
    v_sub_f32 v226, v226, v43
    v_sub_f32 v227, v227, v43
    v_sub_f32 v228, v228, v43
    v_sub_f32 v229, v229, v43
    v_sub_f32 v230, v230, v43
    v_sub_f32 v231, v231, v43
    v_sub_f32 v232, v232, v43
    v_sub_f32 v233, v233, v43
    v_sub_f32 v234, v234, v43
    v_sub_f32 v235, v235, v43
    v_sub_f32 v236, v236, v43
    v_sub_f32 v237, v237, v43
    v_sub_f32 v238, v238, v43
    v_sub_f32 v239, v239, v43
    v_mul_f32 v35, v35, v45
    v_mul_f32 v36, v36, v45
    v_accvgpr_read_b32 v240, a16
    v_accvgpr_read_b32 v241, a17
    v_accvgpr_read_b32 v242, a18
    v_accvgpr_read_b32 v243, a19
    v_mul_f32 v240, v240, v45
    v_mul_f32 v241, v241, v45
    v_mul_f32 v242, v242, v45
    v_mul_f32 v243, v243, v45
    v_accvgpr_write_b32 a16, v240
    v_accvgpr_write_b32 a17, v241
    v_accvgpr_write_b32 a18, v242
    v_accvgpr_write_b32 a19, v243
    v_accvgpr_read_b32 v240, a20
    v_accvgpr_read_b32 v241, a21
    v_accvgpr_read_b32 v242, a22
    v_accvgpr_read_b32 v243, a23
    v_mul_f32 v240, v240, v45
    v_mul_f32 v241, v241, v45
    v_mul_f32 v242, v242, v45
    v_mul_f32 v243, v243, v45
    v_accvgpr_write_b32 a20, v240
    v_accvgpr_write_b32 a21, v241
    v_accvgpr_write_b32 a22, v242
    v_accvgpr_write_b32 a23, v243
    v_accvgpr_read_b32 v240, a24
    v_accvgpr_read_b32 v241, a25
    v_accvgpr_read_b32 v242, a26
    v_accvgpr_read_b32 v243, a27
    v_mul_f32 v240, v240, v45
    v_mul_f32 v241, v241, v45
    v_mul_f32 v242, v242, v45
    v_mul_f32 v243, v243, v45
    v_accvgpr_write_b32 a24, v240
    v_accvgpr_write_b32 a25, v241
    v_accvgpr_write_b32 a26, v242
    v_accvgpr_write_b32 a27, v243
    v_accvgpr_read_b32 v240, a28
    v_accvgpr_read_b32 v241, a29
    v_accvgpr_read_b32 v242, a30
    v_accvgpr_read_b32 v243, a31
    v_mul_f32 v240, v240, v45
    v_mul_f32 v241, v241, v45
    v_mul_f32 v242, v242, v45
    v_mul_f32 v243, v243, v45
    v_accvgpr_write_b32 a28, v240
    v_accvgpr_write_b32 a29, v241
    v_accvgpr_write_b32 a30, v242
    v_accvgpr_write_b32 a31, v243
    v_accvgpr_read_b32 v240, a48
    v_accvgpr_read_b32 v241, a49
    v_accvgpr_read_b32 v242, a50
    v_accvgpr_read_b32 v243, a51
    v_mul_f32 v240, v240, v45
    v_mul_f32 v241, v241, v45
    v_mul_f32 v242, v242, v45
    v_mul_f32 v243, v243, v45
    v_accvgpr_write_b32 a48, v240
    v_accvgpr_write_b32 a49, v241
    v_accvgpr_write_b32 a50, v242
    v_accvgpr_write_b32 a51, v243
    v_accvgpr_read_b32 v240, a52
    v_accvgpr_read_b32 v241, a53
    v_accvgpr_read_b32 v242, a54
    v_accvgpr_read_b32 v243, a55
    v_mul_f32 v240, v240, v45
    v_mul_f32 v241, v241, v45
    v_mul_f32 v242, v242, v45
    v_mul_f32 v243, v243, v45
    v_accvgpr_write_b32 a52, v240
    v_accvgpr_write_b32 a53, v241
    v_accvgpr_write_b32 a54, v242
    v_accvgpr_write_b32 a55, v243
    v_accvgpr_read_b32 v240, a56
    v_accvgpr_read_b32 v241, a57
    v_accvgpr_read_b32 v242, a58
    v_accvgpr_read_b32 v243, a59
    v_mul_f32 v240, v240, v45
    v_mul_f32 v241, v241, v45
    v_mul_f32 v242, v242, v45
    v_mul_f32 v243, v243, v45
    v_accvgpr_write_b32 a56, v240
    v_accvgpr_write_b32 a57, v241
    v_accvgpr_write_b32 a58, v242
    v_accvgpr_write_b32 a59, v243
    v_accvgpr_read_b32 v240, a60
    v_accvgpr_read_b32 v241, a61
    v_accvgpr_read_b32 v242, a62
    v_accvgpr_read_b32 v243, a63
    v_mul_f32 v240, v240, v45
    v_mul_f32 v241, v241, v45
    v_mul_f32 v242, v242, v45
    v_mul_f32 v243, v243, v45
    v_accvgpr_write_b32 a60, v240
    v_accvgpr_write_b32 a61, v241
    v_accvgpr_write_b32 a62, v242
    v_accvgpr_write_b32 a63, v243
    v_accvgpr_read_b32 v240, a80
    v_accvgpr_read_b32 v241, a81
    v_accvgpr_read_b32 v242, a82
    v_accvgpr_read_b32 v243, a83
    v_mul_f32 v240, v240, v45
    v_mul_f32 v241, v241, v45
    v_mul_f32 v242, v242, v45
    v_mul_f32 v243, v243, v45
    v_accvgpr_write_b32 a80, v240
    v_accvgpr_write_b32 a81, v241
    v_accvgpr_write_b32 a82, v242
    v_accvgpr_write_b32 a83, v243
    v_accvgpr_read_b32 v240, a84
    v_accvgpr_read_b32 v241, a85
    v_accvgpr_read_b32 v242, a86
    v_accvgpr_read_b32 v243, a87
    v_mul_f32 v240, v240, v45
    v_mul_f32 v241, v241, v45
    v_mul_f32 v242, v242, v45
    v_mul_f32 v243, v243, v45
    v_accvgpr_write_b32 a84, v240
    v_accvgpr_write_b32 a85, v241
    v_accvgpr_write_b32 a86, v242
    v_accvgpr_write_b32 a87, v243
    v_accvgpr_read_b32 v240, a88
    v_accvgpr_read_b32 v241, a89
    v_accvgpr_read_b32 v242, a90
    v_accvgpr_read_b32 v243, a91
    v_mul_f32 v240, v240, v45
    v_mul_f32 v241, v241, v45
    v_mul_f32 v242, v242, v45
    v_mul_f32 v243, v243, v45
    v_accvgpr_write_b32 a88, v240
    v_accvgpr_write_b32 a89, v241
    v_accvgpr_write_b32 a90, v242
    v_accvgpr_write_b32 a91, v243
    v_accvgpr_read_b32 v240, a92
    v_accvgpr_read_b32 v241, a93
    v_accvgpr_read_b32 v242, a94
    v_accvgpr_read_b32 v243, a95
    v_mul_f32 v240, v240, v45
    v_mul_f32 v241, v241, v45
    v_mul_f32 v242, v242, v45
    v_mul_f32 v243, v243, v45
    v_accvgpr_write_b32 a92, v240
    v_accvgpr_write_b32 a93, v241
    v_accvgpr_write_b32 a94, v242
    v_accvgpr_write_b32 a95, v243
    v_accvgpr_read_b32 v240, a112
    v_accvgpr_read_b32 v241, a113
    v_accvgpr_read_b32 v242, a114
    v_accvgpr_read_b32 v243, a115
    v_mul_f32 v240, v240, v45
    v_mul_f32 v241, v241, v45
    v_mul_f32 v242, v242, v45
    v_mul_f32 v243, v243, v45
    v_accvgpr_write_b32 a112, v240
    v_accvgpr_write_b32 a113, v241
    v_accvgpr_write_b32 a114, v242
    v_accvgpr_write_b32 a115, v243
    v_accvgpr_read_b32 v240, a116
    v_accvgpr_read_b32 v241, a117
    v_accvgpr_read_b32 v242, a118
    v_accvgpr_read_b32 v243, a119
    v_mul_f32 v240, v240, v45
    v_mul_f32 v241, v241, v45
    v_mul_f32 v242, v242, v45
    v_mul_f32 v243, v243, v45
    v_accvgpr_write_b32 a116, v240
    v_accvgpr_write_b32 a117, v241
    v_accvgpr_write_b32 a118, v242
    v_accvgpr_write_b32 a119, v243
    v_accvgpr_read_b32 v240, a120
    v_accvgpr_read_b32 v241, a121
    v_accvgpr_read_b32 v242, a122
    v_accvgpr_read_b32 v243, a123
    v_mul_f32 v240, v240, v45
    v_mul_f32 v241, v241, v45
    v_mul_f32 v242, v242, v45
    v_mul_f32 v243, v243, v45
    v_accvgpr_write_b32 a120, v240
    v_accvgpr_write_b32 a121, v241
    v_accvgpr_write_b32 a122, v242
    v_accvgpr_write_b32 a123, v243
    v_accvgpr_read_b32 v240, a124
    v_accvgpr_read_b32 v241, a125
    v_accvgpr_read_b32 v242, a126
    v_accvgpr_read_b32 v243, a127
    v_mul_f32 v240, v240, v45
    v_mul_f32 v241, v241, v45
    v_mul_f32 v242, v242, v45
    v_mul_f32 v243, v243, v45
    v_accvgpr_write_b32 a124, v240
    v_accvgpr_write_b32 a125, v241
    v_accvgpr_write_b32 a126, v242
    v_accvgpr_write_b32 a127, v243
    s_nop 3
    s_branch attn_kernel_nr3
attn_kernel_done:
    s_endpgm
.section .rodata,"a"
.p2align 6
.amdhsa_kernel attn_kernel
  .amdhsa_next_free_vgpr 512
  .amdhsa_next_free_sgpr 102
  .amdhsa_accum_offset 256
  .amdhsa_group_segment_fixed_size 0
  .amdhsa_kernarg_size 112
  .amdhsa_user_sgpr_count 2
  .amdhsa_user_sgpr_kernarg_segment_ptr 1
  .amdhsa_system_sgpr_workgroup_id_x 1
  .amdhsa_float_denorm_mode_32 3
.end_amdhsa_kernel
.text
.globl oproj_kernel
.p2align 8
.type oproj_kernel,@function
oproj_kernel:
    s_cmp_ge_u32 s2, 256
    s_cbranch_scc1 oproj_kernel_done
    s_load_dwordx2 s[4:5], s[0:1], 104
    s_load_dwordx2 s[6:7], s[0:1], 32
    s_waitcnt lgkmcnt(0)
    s_add_u32 s12, s4, 4194304
    s_addc_u32 s13, s5, 0
    s_and_b32 s13, s13, 0xffff
    s_mov_b32 s14, 16777216
    s_mov_b32 s15, 0x20000
    s_mov_b32 s16, s6
    s_and_b32 s17, s7, 0xffff
    s_mov_b32 s18, 4194304
    s_mov_b32 s19, 0x20000
    s_add_u32 s24, s4, 33554432
    s_addc_u32 s25, s5, 0
    s_and_b32 s25, s25, 0xffff
    s_mov_b32 s26, 8388608
    s_mov_b32 s27, 0x20000
    s_and_b32 s51, s2, 3
    s_lshr_b32 s52, s2, 2
    s_and_b32 s52, s52, 3
    s_lshr_b32 s53, s2, 4
    s_mov_b32 s33, 1024
    s_lshl_b32 s30, s53, 20
    s_lshl_b32 s54, s51, 16
    s_add_u32 s30, s30, s54
    s_lshl_b32 s34, s51, 20
    s_lshl_b32 s54, s52, 8
    s_add_u32 s34, s34, s54
    s_add_u32 s35, s34, 128
    v_lshrrev_b32 v1, 6, v0
    s_nop 0
    v_readfirstlane_b32 s40, v1
    v_and_b32 v2, 63, v0
    v_lshrrev_b32 v3, 3, v2
    v_and_b32 v4, 7, v2
    v_lshrrev_b32 v5, 4, v2
    s_lshl_b32 s42, s40, 3
    v_add_u32 v7, s42, v3
    v_and_b32 v6, 1, v5
    v_lshlrev_b32 v6, 2, v6
    v_xor_b32 v6, v4, v6
    v_lshlrev_b32 v6, 4, v6
    v_mul_lo_u32 v9, v7, s33
    v_add_u32 v9, v9, v6
    v_add_u32 v10, s34, v9
    v_add_u32 v11, s35, v9
    s_lshl_b32 s43, s40, 10
    v_and_b32 v3, 31, v2
    v_lshrrev_b32 v4, 5, v2
    s_mov_b32 s44, s40
    s_mov_b32 s45, 0
    s_mul_i32 s46, s44, 32
    s_mul_i32 s47, s44, 262144
    s_add_u32 s47, s47, s30
    v_lshlrev_b32 v8, 4, v2
    v_add_u32 v8, s47, v8
    v_lshrrev_b32 v5, 4, v2
    v_and_b32 v5, 1, v5
    v_lshrrev_b32 v6, 2, v2
    v_and_b32 v6, 3, v6
    v_and_b32 v7, 3, v2
    v_lshlrev_b32 v20, 3, v4
    v_add_u32 v20, v20, v6
    v_lshlrev_b32 v20, 7, v20
    v_lshl_add_u32 v20, v5, 5, v20
    v_lshl_add_u32 v20, v7, 3, v20
    v_lshrrev_b32 v21, 1, v6
    v_and_b32 v21, 1, v21
    v_xor_b32 v22, 0, v21
    v_lshl_add_u32 v24, v22, 6, v20
    v_add_u32 v26, 0x10000, v24
    v_xor_b32 v22, 1, v21
    v_lshl_add_u32 v25, v22, 6, v20
    v_add_u32 v27, 0x10000, v25
    v_mov_b32 v32, 0
    v_mov_b32 v33, 0
    v_mov_b32 v34, 0
    v_mov_b32 v35, 0
    v_mov_b32 v36, 0
    v_mov_b32 v37, 0
    v_mov_b32 v38, 0
    v_mov_b32 v39, 0
    v_mov_b32 v40, 0
    v_mov_b32 v41, 0
    v_mov_b32 v42, 0
    v_mov_b32 v43, 0
    v_mov_b32 v44, 0
    v_mov_b32 v45, 0
    v_mov_b32 v46, 0
    v_mov_b32 v47, 0
    v_mov_b32 v48, 0
    v_mov_b32 v49, 0
    v_mov_b32 v50, 0
    v_mov_b32 v51, 0
    v_mov_b32 v52, 0
    v_mov_b32 v53, 0
    v_mov_b32 v54, 0
    v_mov_b32 v55, 0
    v_mov_b32 v56, 0
    v_mov_b32 v57, 0
    v_mov_b32 v58, 0
    v_mov_b32 v59, 0
    v_mov_b32 v60, 0
    v_mov_b32 v61, 0
    v_mov_b32 v62, 0
    v_mov_b32 v63, 0
    v_mov_b32 v64, 0
    v_mov_b32 v65, 0
    v_mov_b32 v66, 0
    v_mov_b32 v67, 0
    v_mov_b32 v68, 0
    v_mov_b32 v69, 0
    v_mov_b32 v70, 0
    v_mov_b32 v71, 0
    v_mov_b32 v72, 0
    v_mov_b32 v73, 0
    v_mov_b32 v74, 0
    v_mov_b32 v75, 0
    v_mov_b32 v76, 0
    v_mov_b32 v77, 0
    v_mov_b32 v78, 0
    v_mov_b32 v79, 0
    v_mov_b32 v80, 0
    v_mov_b32 v81, 0
    v_mov_b32 v82, 0
    v_mov_b32 v83, 0
    v_mov_b32 v84, 0
    v_mov_b32 v85, 0
    v_mov_b32 v86, 0
    v_mov_b32 v87, 0
    v_mov_b32 v88, 0
    v_mov_b32 v89, 0
    v_mov_b32 v90, 0
    v_mov_b32 v91, 0
    v_mov_b32 v92, 0
    v_mov_b32 v93, 0
    v_mov_b32 v94, 0
    v_mov_b32 v95, 0
    s_add_u32 m0, s43, 0
    s_mul_i32 s50, s33, 0
    buffer_load_dwordx4 v10, s[16:19], s50 offen lds
    s_add_u32 m0, s43, 4096
    s_mul_i32 s50, s33, 32
    buffer_load_dwordx4 v10, s[16:19], s50 offen lds
    s_add_u32 m0, s43, 8192
    s_mul_i32 s50, s33, 0
    buffer_load_dwordx4 v11, s[16:19], s50 offen lds
    s_add_u32 m0, s43, 12288
    s_mul_i32 s50, s33, 32
    buffer_load_dwordx4 v11, s[16:19], s50 offen lds
    s_mov_b32 s50, 0
    buffer_load_dwordx4 v[128:131], v8, s[12:15], s50 offen offset:0
    buffer_load_dwordx4 v[132:135], v8, s[12:15], s50 offen offset:1024
    buffer_load_dwordx4 v[136:139], v8, s[12:15], s50 offen offset:2048
    buffer_load_dwordx4 v[140:143], v8, s[12:15], s50 offen offset:3072
    s_add_u32 m0, s43, 16384
    s_mul_i32 s50, s33, 64
    buffer_load_dwordx4 v10, s[16:19], s50 offen lds
    s_add_u32 m0, s43, 20480
    s_mul_i32 s50, s33, 96
    buffer_load_dwordx4 v10, s[16:19], s50 offen lds
    s_add_u32 m0, s43, 24576
    s_mul_i32 s50, s33, 64
    buffer_load_dwordx4 v11, s[16:19], s50 offen lds
    s_add_u32 m0, s43, 28672
    s_mul_i32 s50, s33, 96
    buffer_load_dwordx4 v11, s[16:19], s50 offen lds
    s_mov_b32 s50, 4096
    buffer_load_dwordx4 v[144:147], v8, s[12:15], s50 offen offset:0
    buffer_load_dwordx4 v[148:151], v8, s[12:15], s50 offen offset:1024
    buffer_load_dwordx4 v[152:155], v8, s[12:15], s50 offen offset:2048
    buffer_load_dwordx4 v[156:159], v8, s[12:15], s50 offen offset:3072
    s_add_u32 m0, s43, 32768
    s_mul_i32 s50, s33, 128
    buffer_load_dwordx4 v10, s[16:19], s50 offen lds
    s_add_u32 m0, s43, 36864
    s_mul_i32 s50, s33, 160
    buffer_load_dwordx4 v10, s[16:19], s50 offen lds
    s_add_u32 m0, s43, 40960
    s_mul_i32 s50, s33, 128
    buffer_load_dwordx4 v11, s[16:19], s50 offen lds
    s_add_u32 m0, s43, 45056
    s_mul_i32 s50, s33, 160
    buffer_load_dwordx4 v11, s[16:19], s50 offen lds
    s_mov_b32 s50, 8192
    buffer_load_dwordx4 v[160:163], v8, s[12:15], s50 offen offset:0
    buffer_load_dwordx4 v[164:167], v8, s[12:15], s50 offen offset:1024
    buffer_load_dwordx4 v[168:171], v8, s[12:15], s50 offen offset:2048
    buffer_load_dwordx4 v[172:175], v8, s[12:15], s50 offen offset:3072
    s_waitcnt vmcnt(16)
    s_barrier
    ds_read_b64_tr_b16 v[96:97], v24 offset:0
    ds_read_b64_tr_b16 v[98:99], v24 offset:512
    ds_read_b64_tr_b16 v[100:101], v25 offset:0
    ds_read_b64_tr_b16 v[102:103], v25 offset:512
    ds_read_b64_tr_b16 v[104:105], v24 offset:8192
    ds_read_b64_tr_b16 v[106:107], v24 offset:8704
    ds_read_b64_tr_b16 v[108:109], v25 offset:8192
    ds_read_b64_tr_b16 v[110:111], v25 offset:8704
    s_add_u32 m0, s43, 49152
    s_mul_i32 s50, s33, 192
    buffer_load_dwordx4 v10, s[16:19], s50 offen lds
    s_add_u32 m0, s43, 53248
    s_mul_i32 s50, s33, 224
    buffer_load_dwordx4 v10, s[16:19], s50 offen lds
    s_add_u32 m0, s43, 57344
    s_mul_i32 s50, s33, 192
    buffer_load_dwordx4 v11, s[16:19], s50 offen lds
    s_add_u32 m0, s43, 61440
    s_mul_i32 s50, s33, 224
    buffer_load_dwordx4 v11, s[16:19], s50 offen lds
    s_mov_b32 s50, 12288
    buffer_load_dwordx4 v[176:179], v8, s[12:15], s50 offen offset:0
    buffer_load_dwordx4 v[180:183], v8, s[12:15], s50 offen offset:1024
    buffer_load_dwordx4 v[184:187], v8, s[12:15], s50 offen offset:2048
    buffer_load_dwordx4 v[188:191], v8, s[12:15], s50 offen offset:3072
    ds_read_b64_tr_b16 v[112:113], v24 offset:2048
    ds_read_b64_tr_b16 v[114:115], v24 offset:2560
    ds_read_b64_tr_b16 v[116:117], v25 offset:2048
    ds_read_b64_tr_b16 v[118:119], v25 offset:2560
    ds_read_b64_tr_b16 v[120:121], v24 offset:10240
    ds_read_b64_tr_b16 v[122:123], v24 offset:10752
    ds_read_b64_tr_b16 v[124:125], v25 offset:10240
    ds_read_b64_tr_b16 v[126:127], v25 offset:10752
    s_waitcnt lgkmcnt(8)
    v_mfma_f32_32x32x16_bf16 v[32:47], v[96:99], v[128:131], v[32:47]
    v_mfma_f32_32x32x16_bf16 v[48:63], v[100:103], v[128:131], v[48:63]
    v_mfma_f32_32x32x16_bf16 v[64:79], v[104:107], v[128:131], v[64:79]
    v_mfma_f32_32x32x16_bf16 v[80:95], v[108:111], v[128:131], v[80:95]
    ds_read_b64_tr_b16 v[96:97], v24 offset:4096
    ds_read_b64_tr_b16 v[98:99], v24 offset:4608
    ds_read_b64_tr_b16 v[100:101], v25 offset:4096
    ds_read_b64_tr_b16 v[102:103], v25 offset:4608
    ds_read_b64_tr_b16 v[104:105], v24 offset:12288
    ds_read_b64_tr_b16 v[106:107], v24 offset:12800
    ds_read_b64_tr_b16 v[108:109], v25 offset:12288
    ds_read_b64_tr_b16 v[110:111], v25 offset:12800
    s_waitcnt lgkmcnt(8)
    v_mfma_f32_32x32x16_bf16 v[32:47], v[112:115], v[132:135], v[32:47]
    v_mfma_f32_32x32x16_bf16 v[48:63], v[116:119], v[132:135], v[48:63]
    v_mfma_f32_32x32x16_bf16 v[64:79], v[120:123], v[132:135], v[64:79]
    v_mfma_f32_32x32x16_bf16 v[80:95], v[124:127], v[132:135], v[80:95]
    ds_read_b64_tr_b16 v[112:113], v24 offset:6144
    ds_read_b64_tr_b16 v[114:115], v24 offset:6656
    ds_read_b64_tr_b16 v[116:117], v25 offset:6144
    ds_read_b64_tr_b16 v[118:119], v25 offset:6656
    ds_read_b64_tr_b16 v[120:121], v24 offset:14336
    ds_read_b64_tr_b16 v[122:123], v24 offset:14848
    ds_read_b64_tr_b16 v[124:125], v25 offset:14336
    ds_read_b64_tr_b16 v[126:127], v25 offset:14848
    s_waitcnt lgkmcnt(8)
    v_mfma_f32_32x32x16_bf16 v[32:47], v[96:99], v[136:139], v[32:47]
    v_mfma_f32_32x32x16_bf16 v[48:63], v[100:103], v[136:139], v[48:63]
    v_mfma_f32_32x32x16_bf16 v[64:79], v[104:107], v[136:139], v[64:79]
    v_mfma_f32_32x32x16_bf16 v[80:95], v[108:111], v[136:139], v[80:95]
    s_waitcnt lgkmcnt(0)
    v_mfma_f32_32x32x16_bf16 v[32:47], v[112:115], v[140:143], v[32:47]
    v_mfma_f32_32x32x16_bf16 v[48:63], v[116:119], v[140:143], v[48:63]
    v_mfma_f32_32x32x16_bf16 v[64:79], v[120:123], v[140:143], v[64:79]
    v_mfma_f32_32x32x16_bf16 v[80:95], v[124:127], v[140:143], v[80:95]
    s_waitcnt vmcnt(16)
    s_barrier
    ds_read_b64_tr_b16 v[96:97], v24 offset:16384
    ds_read_b64_tr_b16 v[98:99], v24 offset:16896
    ds_read_b64_tr_b16 v[100:101], v25 offset:16384
    ds_read_b64_tr_b16 v[102:103], v25 offset:16896
    ds_read_b64_tr_b16 v[104:105], v24 offset:24576
    ds_read_b64_tr_b16 v[106:107], v24 offset:25088
    ds_read_b64_tr_b16 v[108:109], v25 offset:24576
    ds_read_b64_tr_b16 v[110:111], v25 offset:25088
    s_add_u32 m0, s43, 0
    s_mul_i32 s50, s33, 256
    buffer_load_dwordx4 v10, s[16:19], s50 offen lds
    s_add_u32 m0, s43, 4096
    s_mul_i32 s50, s33, 288
    buffer_load_dwordx4 v10, s[16:19], s50 offen lds
    s_add_u32 m0, s43, 8192
    s_mul_i32 s50, s33, 256
    buffer_load_dwordx4 v11, s[16:19], s50 offen lds
    s_add_u32 m0, s43, 12288
    s_mul_i32 s50, s33, 288
    buffer_load_dwordx4 v11, s[16:19], s50 offen lds
    s_mov_b32 s50, 16384
    buffer_load_dwordx4 v[128:131], v8, s[12:15], s50 offen offset:0
    buffer_load_dwordx4 v[132:135], v8, s[12:15], s50 offen offset:1024
    buffer_load_dwordx4 v[136:139], v8, s[12:15], s50 offen offset:2048
    buffer_load_dwordx4 v[140:143], v8, s[12:15], s50 offen offset:3072
    ds_read_b64_tr_b16 v[112:113], v24 offset:18432
    ds_read_b64_tr_b16 v[114:115], v24 offset:18944
    ds_read_b64_tr_b16 v[116:117], v25 offset:18432
    ds_read_b64_tr_b16 v[118:119], v25 offset:18944
    ds_read_b64_tr_b16 v[120:121], v24 offset:26624
    ds_read_b64_tr_b16 v[122:123], v24 offset:27136
    ds_read_b64_tr_b16 v[124:125], v25 offset:26624
    ds_read_b64_tr_b16 v[126:127], v25 offset:27136
    s_waitcnt lgkmcnt(8)
    v_mfma_f32_32x32x16_bf16 v[32:47], v[96:99], v[144:147], v[32:47]
    v_mfma_f32_32x32x16_bf16 v[48:63], v[100:103], v[144:147], v[48:63]
    v_mfma_f32_32x32x16_bf16 v[64:79], v[104:107], v[144:147], v[64:79]
    v_mfma_f32_32x32x16_bf16 v[80:95], v[108:111], v[144:147], v[80:95]
    ds_read_b64_tr_b16 v[96:97], v24 offset:20480
    ds_read_b64_tr_b16 v[98:99], v24 offset:20992
    ds_read_b64_tr_b16 v[100:101], v25 offset:20480
    ds_read_b64_tr_b16 v[102:103], v25 offset:20992
    ds_read_b64_tr_b16 v[104:105], v24 offset:28672
    ds_read_b64_tr_b16 v[106:107], v24 offset:29184
    ds_read_b64_tr_b16 v[108:109], v25 offset:28672
    ds_read_b64_tr_b16 v[110:111], v25 offset:29184
    s_waitcnt lgkmcnt(8)
    v_mfma_f32_32x32x16_bf16 v[32:47], v[112:115], v[148:151], v[32:47]
    v_mfma_f32_32x32x16_bf16 v[48:63], v[116:119], v[148:151], v[48:63]
    v_mfma_f32_32x32x16_bf16 v[64:79], v[120:123], v[148:151], v[64:79]
    v_mfma_f32_32x32x16_bf16 v[80:95], v[124:127], v[148:151], v[80:95]
    ds_read_b64_tr_b16 v[112:113], v24 offset:22528
    ds_read_b64_tr_b16 v[114:115], v24 offset:23040
    ds_read_b64_tr_b16 v[116:117], v25 offset:22528
    ds_read_b64_tr_b16 v[118:119], v25 offset:23040
    ds_read_b64_tr_b16 v[120:121], v24 offset:30720
    ds_read_b64_tr_b16 v[122:123], v24 offset:31232
    ds_read_b64_tr_b16 v[124:125], v25 offset:30720
    ds_read_b64_tr_b16 v[126:127], v25 offset:31232
    s_waitcnt lgkmcnt(8)
    v_mfma_f32_32x32x16_bf16 v[32:47], v[96:99], v[152:155], v[32:47]
    v_mfma_f32_32x32x16_bf16 v[48:63], v[100:103], v[152:155], v[48:63]
    v_mfma_f32_32x32x16_bf16 v[64:79], v[104:107], v[152:155], v[64:79]
    v_mfma_f32_32x32x16_bf16 v[80:95], v[108:111], v[152:155], v[80:95]
    s_waitcnt lgkmcnt(0)
    v_mfma_f32_32x32x16_bf16 v[32:47], v[112:115], v[156:159], v[32:47]
    v_mfma_f32_32x32x16_bf16 v[48:63], v[116:119], v[156:159], v[48:63]
    v_mfma_f32_32x32x16_bf16 v[64:79], v[120:123], v[156:159], v[64:79]
    v_mfma_f32_32x32x16_bf16 v[80:95], v[124:127], v[156:159], v[80:95]
    s_waitcnt vmcnt(16)
    s_barrier
    ds_read_b64_tr_b16 v[96:97], v24 offset:32768
    ds_read_b64_tr_b16 v[98:99], v24 offset:33280
    ds_read_b64_tr_b16 v[100:101], v25 offset:32768
    ds_read_b64_tr_b16 v[102:103], v25 offset:33280
    ds_read_b64_tr_b16 v[104:105], v24 offset:40960
    ds_read_b64_tr_b16 v[106:107], v24 offset:41472
    ds_read_b64_tr_b16 v[108:109], v25 offset:40960
    ds_read_b64_tr_b16 v[110:111], v25 offset:41472
    s_add_u32 m0, s43, 16384
    s_mul_i32 s50, s33, 320
    buffer_load_dwordx4 v10, s[16:19], s50 offen lds
    s_add_u32 m0, s43, 20480
    s_mul_i32 s50, s33, 352
    buffer_load_dwordx4 v10, s[16:19], s50 offen lds
    s_add_u32 m0, s43, 24576
    s_mul_i32 s50, s33, 320
    buffer_load_dwordx4 v11, s[16:19], s50 offen lds
    s_add_u32 m0, s43, 28672
    s_mul_i32 s50, s33, 352
    buffer_load_dwordx4 v11, s[16:19], s50 offen lds
    s_mov_b32 s50, 20480
    buffer_load_dwordx4 v[144:147], v8, s[12:15], s50 offen offset:0
    buffer_load_dwordx4 v[148:151], v8, s[12:15], s50 offen offset:1024
    buffer_load_dwordx4 v[152:155], v8, s[12:15], s50 offen offset:2048
    buffer_load_dwordx4 v[156:159], v8, s[12:15], s50 offen offset:3072
    ds_read_b64_tr_b16 v[112:113], v24 offset:34816
    ds_read_b64_tr_b16 v[114:115], v24 offset:35328
    ds_read_b64_tr_b16 v[116:117], v25 offset:34816
    ds_read_b64_tr_b16 v[118:119], v25 offset:35328
    ds_read_b64_tr_b16 v[120:121], v24 offset:43008
    ds_read_b64_tr_b16 v[122:123], v24 offset:43520
    ds_read_b64_tr_b16 v[124:125], v25 offset:43008
    ds_read_b64_tr_b16 v[126:127], v25 offset:43520
    s_waitcnt lgkmcnt(8)
    v_mfma_f32_32x32x16_bf16 v[32:47], v[96:99], v[160:163], v[32:47]
    v_mfma_f32_32x32x16_bf16 v[48:63], v[100:103], v[160:163], v[48:63]
    v_mfma_f32_32x32x16_bf16 v[64:79], v[104:107], v[160:163], v[64:79]
    v_mfma_f32_32x32x16_bf16 v[80:95], v[108:111], v[160:163], v[80:95]
    ds_read_b64_tr_b16 v[96:97], v24 offset:36864
    ds_read_b64_tr_b16 v[98:99], v24 offset:37376
    ds_read_b64_tr_b16 v[100:101], v25 offset:36864
    ds_read_b64_tr_b16 v[102:103], v25 offset:37376
    ds_read_b64_tr_b16 v[104:105], v24 offset:45056
    ds_read_b64_tr_b16 v[106:107], v24 offset:45568
    ds_read_b64_tr_b16 v[108:109], v25 offset:45056
    ds_read_b64_tr_b16 v[110:111], v25 offset:45568
    s_waitcnt lgkmcnt(8)
    v_mfma_f32_32x32x16_bf16 v[32:47], v[112:115], v[164:167], v[32:47]
    v_mfma_f32_32x32x16_bf16 v[48:63], v[116:119], v[164:167], v[48:63]
    v_mfma_f32_32x32x16_bf16 v[64:79], v[120:123], v[164:167], v[64:79]
    v_mfma_f32_32x32x16_bf16 v[80:95], v[124:127], v[164:167], v[80:95]
    ds_read_b64_tr_b16 v[112:113], v24 offset:38912
    ds_read_b64_tr_b16 v[114:115], v24 offset:39424
    ds_read_b64_tr_b16 v[116:117], v25 offset:38912
    ds_read_b64_tr_b16 v[118:119], v25 offset:39424
    ds_read_b64_tr_b16 v[120:121], v24 offset:47104
    ds_read_b64_tr_b16 v[122:123], v24 offset:47616
    ds_read_b64_tr_b16 v[124:125], v25 offset:47104
    ds_read_b64_tr_b16 v[126:127], v25 offset:47616
    s_waitcnt lgkmcnt(8)
    v_mfma_f32_32x32x16_bf16 v[32:47], v[96:99], v[168:171], v[32:47]
    v_mfma_f32_32x32x16_bf16 v[48:63], v[100:103], v[168:171], v[48:63]
    v_mfma_f32_32x32x16_bf16 v[64:79], v[104:107], v[168:171], v[64:79]
    v_mfma_f32_32x32x16_bf16 v[80:95], v[108:111], v[168:171], v[80:95]
    s_waitcnt lgkmcnt(0)
    v_mfma_f32_32x32x16_bf16 v[32:47], v[112:115], v[172:175], v[32:47]
    v_mfma_f32_32x32x16_bf16 v[48:63], v[116:119], v[172:175], v[48:63]
    v_mfma_f32_32x32x16_bf16 v[64:79], v[120:123], v[172:175], v[64:79]
    v_mfma_f32_32x32x16_bf16 v[80:95], v[124:127], v[172:175], v[80:95]
    s_waitcnt vmcnt(16)
    s_barrier
    ds_read_b64_tr_b16 v[96:97], v24 offset:49152
    ds_read_b64_tr_b16 v[98:99], v24 offset:49664
    ds_read_b64_tr_b16 v[100:101], v25 offset:49152
    ds_read_b64_tr_b16 v[102:103], v25 offset:49664
    ds_read_b64_tr_b16 v[104:105], v24 offset:57344
    ds_read_b64_tr_b16 v[106:107], v24 offset:57856
    ds_read_b64_tr_b16 v[108:109], v25 offset:57344
    ds_read_b64_tr_b16 v[110:111], v25 offset:57856
    s_add_u32 m0, s43, 32768
    s_mul_i32 s50, s33, 384
    buffer_load_dwordx4 v10, s[16:19], s50 offen lds
    s_add_u32 m0, s43, 36864
    s_mul_i32 s50, s33, 416
    buffer_load_dwordx4 v10, s[16:19], s50 offen lds
    s_add_u32 m0, s43, 40960
    s_mul_i32 s50, s33, 384
    buffer_load_dwordx4 v11, s[16:19], s50 offen lds
    s_add_u32 m0, s43, 45056
    s_mul_i32 s50, s33, 416
    buffer_load_dwordx4 v11, s[16:19], s50 offen lds
    s_mov_b32 s50, 24576
    buffer_load_dwordx4 v[160:163], v8, s[12:15], s50 offen offset:0
    buffer_load_dwordx4 v[164:167], v8, s[12:15], s50 offen offset:1024
    buffer_load_dwordx4 v[168:171], v8, s[12:15], s50 offen offset:2048
    buffer_load_dwordx4 v[172:175], v8, s[12:15], s50 offen offset:3072
    ds_read_b64_tr_b16 v[112:113], v24 offset:51200
    ds_read_b64_tr_b16 v[114:115], v24 offset:51712
    ds_read_b64_tr_b16 v[116:117], v25 offset:51200
    ds_read_b64_tr_b16 v[118:119], v25 offset:51712
    ds_read_b64_tr_b16 v[120:121], v24 offset:59392
    ds_read_b64_tr_b16 v[122:123], v24 offset:59904
    ds_read_b64_tr_b16 v[124:125], v25 offset:59392
    ds_read_b64_tr_b16 v[126:127], v25 offset:59904
    s_waitcnt lgkmcnt(8)
    v_mfma_f32_32x32x16_bf16 v[32:47], v[96:99], v[176:179], v[32:47]
    v_mfma_f32_32x32x16_bf16 v[48:63], v[100:103], v[176:179], v[48:63]
    v_mfma_f32_32x32x16_bf16 v[64:79], v[104:107], v[176:179], v[64:79]
    v_mfma_f32_32x32x16_bf16 v[80:95], v[108:111], v[176:179], v[80:95]
    ds_read_b64_tr_b16 v[96:97], v24 offset:53248
    ds_read_b64_tr_b16 v[98:99], v24 offset:53760
    ds_read_b64_tr_b16 v[100:101], v25 offset:53248
    ds_read_b64_tr_b16 v[102:103], v25 offset:53760
    ds_read_b64_tr_b16 v[104:105], v24 offset:61440
    ds_read_b64_tr_b16 v[106:107], v24 offset:61952
    ds_read_b64_tr_b16 v[108:109], v25 offset:61440
    ds_read_b64_tr_b16 v[110:111], v25 offset:61952
    s_waitcnt lgkmcnt(8)
    v_mfma_f32_32x32x16_bf16 v[32:47], v[112:115], v[180:183], v[32:47]
    v_mfma_f32_32x32x16_bf16 v[48:63], v[116:119], v[180:183], v[48:63]
    v_mfma_f32_32x32x16_bf16 v[64:79], v[120:123], v[180:183], v[64:79]
    v_mfma_f32_32x32x16_bf16 v[80:95], v[124:127], v[180:183], v[80:95]
    ds_read_b64_tr_b16 v[112:113], v24 offset:55296
    ds_read_b64_tr_b16 v[114:115], v24 offset:55808
    ds_read_b64_tr_b16 v[116:117], v25 offset:55296
    ds_read_b64_tr_b16 v[118:119], v25 offset:55808
    ds_read_b64_tr_b16 v[120:121], v24 offset:63488
    ds_read_b64_tr_b16 v[122:123], v24 offset:64000
    ds_read_b64_tr_b16 v[124:125], v25 offset:63488
    ds_read_b64_tr_b16 v[126:127], v25 offset:64000
    s_waitcnt lgkmcnt(8)
    v_mfma_f32_32x32x16_bf16 v[32:47], v[96:99], v[184:187], v[32:47]
    v_mfma_f32_32x32x16_bf16 v[48:63], v[100:103], v[184:187], v[48:63]
    v_mfma_f32_32x32x16_bf16 v[64:79], v[104:107], v[184:187], v[64:79]
    v_mfma_f32_32x32x16_bf16 v[80:95], v[108:111], v[184:187], v[80:95]
    s_waitcnt lgkmcnt(0)
    v_mfma_f32_32x32x16_bf16 v[32:47], v[112:115], v[188:191], v[32:47]
    v_mfma_f32_32x32x16_bf16 v[48:63], v[116:119], v[188:191], v[48:63]
    v_mfma_f32_32x32x16_bf16 v[64:79], v[120:123], v[188:191], v[64:79]
    v_mfma_f32_32x32x16_bf16 v[80:95], v[124:127], v[188:191], v[80:95]
    s_waitcnt vmcnt(16)
    s_barrier
    ds_read_b64_tr_b16 v[96:97], v24 offset:0
    ds_read_b64_tr_b16 v[98:99], v24 offset:512
    ds_read_b64_tr_b16 v[100:101], v25 offset:0
    ds_read_b64_tr_b16 v[102:103], v25 offset:512
    ds_read_b64_tr_b16 v[104:105], v24 offset:8192
    ds_read_b64_tr_b16 v[106:107], v24 offset:8704
    ds_read_b64_tr_b16 v[108:109], v25 offset:8192
    ds_read_b64_tr_b16 v[110:111], v25 offset:8704
    s_add_u32 m0, s43, 49152
    s_mul_i32 s50, s33, 448
    buffer_load_dwordx4 v10, s[16:19], s50 offen lds
    s_add_u32 m0, s43, 53248
    s_mul_i32 s50, s33, 480
    buffer_load_dwordx4 v10, s[16:19], s50 offen lds
    s_add_u32 m0, s43, 57344
    s_mul_i32 s50, s33, 448
    buffer_load_dwordx4 v11, s[16:19], s50 offen lds
    s_add_u32 m0, s43, 61440
    s_mul_i32 s50, s33, 480
    buffer_load_dwordx4 v11, s[16:19], s50 offen lds
    s_mov_b32 s50, 28672
    buffer_load_dwordx4 v[176:179], v8, s[12:15], s50 offen offset:0
    buffer_load_dwordx4 v[180:183], v8, s[12:15], s50 offen offset:1024
    buffer_load_dwordx4 v[184:187], v8, s[12:15], s50 offen offset:2048
    buffer_load_dwordx4 v[188:191], v8, s[12:15], s50 offen offset:3072
    ds_read_b64_tr_b16 v[112:113], v24 offset:2048
    ds_read_b64_tr_b16 v[114:115], v24 offset:2560
    ds_read_b64_tr_b16 v[116:117], v25 offset:2048
    ds_read_b64_tr_b16 v[118:119], v25 offset:2560
    ds_read_b64_tr_b16 v[120:121], v24 offset:10240
    ds_read_b64_tr_b16 v[122:123], v24 offset:10752
    ds_read_b64_tr_b16 v[124:125], v25 offset:10240
    ds_read_b64_tr_b16 v[126:127], v25 offset:10752
    s_waitcnt lgkmcnt(8)
    v_mfma_f32_32x32x16_bf16 v[32:47], v[96:99], v[128:131], v[32:47]
    v_mfma_f32_32x32x16_bf16 v[48:63], v[100:103], v[128:131], v[48:63]
    v_mfma_f32_32x32x16_bf16 v[64:79], v[104:107], v[128:131], v[64:79]
    v_mfma_f32_32x32x16_bf16 v[80:95], v[108:111], v[128:131], v[80:95]
    ds_read_b64_tr_b16 v[96:97], v24 offset:4096
    ds_read_b64_tr_b16 v[98:99], v24 offset:4608
    ds_read_b64_tr_b16 v[100:101], v25 offset:4096
    ds_read_b64_tr_b16 v[102:103], v25 offset:4608
    ds_read_b64_tr_b16 v[104:105], v24 offset:12288
    ds_read_b64_tr_b16 v[106:107], v24 offset:12800
    ds_read_b64_tr_b16 v[108:109], v25 offset:12288
    ds_read_b64_tr_b16 v[110:111], v25 offset:12800
    s_waitcnt lgkmcnt(8)
    v_mfma_f32_32x32x16_bf16 v[32:47], v[112:115], v[132:135], v[32:47]
    v_mfma_f32_32x32x16_bf16 v[48:63], v[116:119], v[132:135], v[48:63]
    v_mfma_f32_32x32x16_bf16 v[64:79], v[120:123], v[132:135], v[64:79]
    v_mfma_f32_32x32x16_bf16 v[80:95], v[124:127], v[132:135], v[80:95]
    ds_read_b64_tr_b16 v[112:113], v24 offset:6144
    ds_read_b64_tr_b16 v[114:115], v24 offset:6656
    ds_read_b64_tr_b16 v[116:117], v25 offset:6144
    ds_read_b64_tr_b16 v[118:119], v25 offset:6656
    ds_read_b64_tr_b16 v[120:121], v24 offset:14336
    ds_read_b64_tr_b16 v[122:123], v24 offset:14848
    ds_read_b64_tr_b16 v[124:125], v25 offset:14336
    ds_read_b64_tr_b16 v[126:127], v25 offset:14848
    s_waitcnt lgkmcnt(8)
    v_mfma_f32_32x32x16_bf16 v[32:47], v[96:99], v[136:139], v[32:47]
    v_mfma_f32_32x32x16_bf16 v[48:63], v[100:103], v[136:139], v[48:63]
    v_mfma_f32_32x32x16_bf16 v[64:79], v[104:107], v[136:139], v[64:79]
    v_mfma_f32_32x32x16_bf16 v[80:95], v[108:111], v[136:139], v[80:95]
    s_waitcnt lgkmcnt(0)
    v_mfma_f32_32x32x16_bf16 v[32:47], v[112:115], v[140:143], v[32:47]
    v_mfma_f32_32x32x16_bf16 v[48:63], v[116:119], v[140:143], v[48:63]
    v_mfma_f32_32x32x16_bf16 v[64:79], v[120:123], v[140:143], v[64:79]
    v_mfma_f32_32x32x16_bf16 v[80:95], v[124:127], v[140:143], v[80:95]
    s_waitcnt vmcnt(16)
    s_barrier
    ds_read_b64_tr_b16 v[96:97], v24 offset:16384
    ds_read_b64_tr_b16 v[98:99], v24 offset:16896
    ds_read_b64_tr_b16 v[100:101], v25 offset:16384
    ds_read_b64_tr_b16 v[102:103], v25 offset:16896
    ds_read_b64_tr_b16 v[104:105], v24 offset:24576
    ds_read_b64_tr_b16 v[106:107], v24 offset:25088
    ds_read_b64_tr_b16 v[108:109], v25 offset:24576
    ds_read_b64_tr_b16 v[110:111], v25 offset:25088
    s_add_u32 m0, s43, 0
    s_mul_i32 s50, s33, 512
    buffer_load_dwordx4 v10, s[16:19], s50 offen lds
    s_add_u32 m0, s43, 4096
    s_mul_i32 s50, s33, 544
    buffer_load_dwordx4 v10, s[16:19], s50 offen lds
    s_add_u32 m0, s43, 8192
    s_mul_i32 s50, s33, 512
    buffer_load_dwordx4 v11, s[16:19], s50 offen lds
    s_add_u32 m0, s43, 12288
    s_mul_i32 s50, s33, 544
    buffer_load_dwordx4 v11, s[16:19], s50 offen lds
    s_mov_b32 s50, 32768
    buffer_load_dwordx4 v[128:131], v8, s[12:15], s50 offen offset:0
    buffer_load_dwordx4 v[132:135], v8, s[12:15], s50 offen offset:1024
    buffer_load_dwordx4 v[136:139], v8, s[12:15], s50 offen offset:2048
    buffer_load_dwordx4 v[140:143], v8, s[12:15], s50 offen offset:3072
    ds_read_b64_tr_b16 v[112:113], v24 offset:18432
    ds_read_b64_tr_b16 v[114:115], v24 offset:18944
    ds_read_b64_tr_b16 v[116:117], v25 offset:18432
    ds_read_b64_tr_b16 v[118:119], v25 offset:18944
    ds_read_b64_tr_b16 v[120:121], v24 offset:26624
    ds_read_b64_tr_b16 v[122:123], v24 offset:27136
    ds_read_b64_tr_b16 v[124:125], v25 offset:26624
    ds_read_b64_tr_b16 v[126:127], v25 offset:27136
    s_waitcnt lgkmcnt(8)
    v_mfma_f32_32x32x16_bf16 v[32:47], v[96:99], v[144:147], v[32:47]
    v_mfma_f32_32x32x16_bf16 v[48:63], v[100:103], v[144:147], v[48:63]
    v_mfma_f32_32x32x16_bf16 v[64:79], v[104:107], v[144:147], v[64:79]
    v_mfma_f32_32x32x16_bf16 v[80:95], v[108:111], v[144:147], v[80:95]
    ds_read_b64_tr_b16 v[96:97], v24 offset:20480
    ds_read_b64_tr_b16 v[98:99], v24 offset:20992
    ds_read_b64_tr_b16 v[100:101], v25 offset:20480
    ds_read_b64_tr_b16 v[102:103], v25 offset:20992
    ds_read_b64_tr_b16 v[104:105], v24 offset:28672
    ds_read_b64_tr_b16 v[106:107], v24 offset:29184
    ds_read_b64_tr_b16 v[108:109], v25 offset:28672
    ds_read_b64_tr_b16 v[110:111], v25 offset:29184
    s_waitcnt lgkmcnt(8)
    v_mfma_f32_32x32x16_bf16 v[32:47], v[112:115], v[148:151], v[32:47]
    v_mfma_f32_32x32x16_bf16 v[48:63], v[116:119], v[148:151], v[48:63]
    v_mfma_f32_32x32x16_bf16 v[64:79], v[120:123], v[148:151], v[64:79]
    v_mfma_f32_32x32x16_bf16 v[80:95], v[124:127], v[148:151], v[80:95]
    ds_read_b64_tr_b16 v[112:113], v24 offset:22528
    ds_read_b64_tr_b16 v[114:115], v24 offset:23040
    ds_read_b64_tr_b16 v[116:117], v25 offset:22528
    ds_read_b64_tr_b16 v[118:119], v25 offset:23040
    ds_read_b64_tr_b16 v[120:121], v24 offset:30720
    ds_read_b64_tr_b16 v[122:123], v24 offset:31232
    ds_read_b64_tr_b16 v[124:125], v25 offset:30720
    ds_read_b64_tr_b16 v[126:127], v25 offset:31232
    s_waitcnt lgkmcnt(8)
    v_mfma_f32_32x32x16_bf16 v[32:47], v[96:99], v[152:155], v[32:47]
    v_mfma_f32_32x32x16_bf16 v[48:63], v[100:103], v[152:155], v[48:63]
    v_mfma_f32_32x32x16_bf16 v[64:79], v[104:107], v[152:155], v[64:79]
    v_mfma_f32_32x32x16_bf16 v[80:95], v[108:111], v[152:155], v[80:95]
    s_waitcnt lgkmcnt(0)
    v_mfma_f32_32x32x16_bf16 v[32:47], v[112:115], v[156:159], v[32:47]
    v_mfma_f32_32x32x16_bf16 v[48:63], v[116:119], v[156:159], v[48:63]
    v_mfma_f32_32x32x16_bf16 v[64:79], v[120:123], v[156:159], v[64:79]
    v_mfma_f32_32x32x16_bf16 v[80:95], v[124:127], v[156:159], v[80:95]
    s_waitcnt vmcnt(16)
    s_barrier
    ds_read_b64_tr_b16 v[96:97], v24 offset:32768
    ds_read_b64_tr_b16 v[98:99], v24 offset:33280
    ds_read_b64_tr_b16 v[100:101], v25 offset:32768
    ds_read_b64_tr_b16 v[102:103], v25 offset:33280
    ds_read_b64_tr_b16 v[104:105], v24 offset:40960
    ds_read_b64_tr_b16 v[106:107], v24 offset:41472
    ds_read_b64_tr_b16 v[108:109], v25 offset:40960
    ds_read_b64_tr_b16 v[110:111], v25 offset:41472
    s_add_u32 m0, s43, 16384
    s_mul_i32 s50, s33, 576
    buffer_load_dwordx4 v10, s[16:19], s50 offen lds
    s_add_u32 m0, s43, 20480
    s_mul_i32 s50, s33, 608
    buffer_load_dwordx4 v10, s[16:19], s50 offen lds
    s_add_u32 m0, s43, 24576
    s_mul_i32 s50, s33, 576
    buffer_load_dwordx4 v11, s[16:19], s50 offen lds
    s_add_u32 m0, s43, 28672
    s_mul_i32 s50, s33, 608
    buffer_load_dwordx4 v11, s[16:19], s50 offen lds
    s_mov_b32 s50, 36864
    buffer_load_dwordx4 v[144:147], v8, s[12:15], s50 offen offset:0
    buffer_load_dwordx4 v[148:151], v8, s[12:15], s50 offen offset:1024
    buffer_load_dwordx4 v[152:155], v8, s[12:15], s50 offen offset:2048
    buffer_load_dwordx4 v[156:159], v8, s[12:15], s50 offen offset:3072
    ds_read_b64_tr_b16 v[112:113], v24 offset:34816
    ds_read_b64_tr_b16 v[114:115], v24 offset:35328
    ds_read_b64_tr_b16 v[116:117], v25 offset:34816
    ds_read_b64_tr_b16 v[118:119], v25 offset:35328
    ds_read_b64_tr_b16 v[120:121], v24 offset:43008
    ds_read_b64_tr_b16 v[122:123], v24 offset:43520
    ds_read_b64_tr_b16 v[124:125], v25 offset:43008
    ds_read_b64_tr_b16 v[126:127], v25 offset:43520
    s_waitcnt lgkmcnt(8)
    v_mfma_f32_32x32x16_bf16 v[32:47], v[96:99], v[160:163], v[32:47]
    v_mfma_f32_32x32x16_bf16 v[48:63], v[100:103], v[160:163], v[48:63]
    v_mfma_f32_32x32x16_bf16 v[64:79], v[104:107], v[160:163], v[64:79]
    v_mfma_f32_32x32x16_bf16 v[80:95], v[108:111], v[160:163], v[80:95]
    ds_read_b64_tr_b16 v[96:97], v24 offset:36864
    ds_read_b64_tr_b16 v[98:99], v24 offset:37376
    ds_read_b64_tr_b16 v[100:101], v25 offset:36864
    ds_read_b64_tr_b16 v[102:103], v25 offset:37376
    ds_read_b64_tr_b16 v[104:105], v24 offset:45056
    ds_read_b64_tr_b16 v[106:107], v24 offset:45568
    ds_read_b64_tr_b16 v[108:109], v25 offset:45056
    ds_read_b64_tr_b16 v[110:111], v25 offset:45568
    s_waitcnt lgkmcnt(8)
    v_mfma_f32_32x32x16_bf16 v[32:47], v[112:115], v[164:167], v[32:47]
    v_mfma_f32_32x32x16_bf16 v[48:63], v[116:119], v[164:167], v[48:63]
    v_mfma_f32_32x32x16_bf16 v[64:79], v[120:123], v[164:167], v[64:79]
    v_mfma_f32_32x32x16_bf16 v[80:95], v[124:127], v[164:167], v[80:95]
    ds_read_b64_tr_b16 v[112:113], v24 offset:38912
    ds_read_b64_tr_b16 v[114:115], v24 offset:39424
    ds_read_b64_tr_b16 v[116:117], v25 offset:38912
    ds_read_b64_tr_b16 v[118:119], v25 offset:39424
    ds_read_b64_tr_b16 v[120:121], v24 offset:47104
    ds_read_b64_tr_b16 v[122:123], v24 offset:47616
    ds_read_b64_tr_b16 v[124:125], v25 offset:47104
    ds_read_b64_tr_b16 v[126:127], v25 offset:47616
    s_waitcnt lgkmcnt(8)
    v_mfma_f32_32x32x16_bf16 v[32:47], v[96:99], v[168:171], v[32:47]
    v_mfma_f32_32x32x16_bf16 v[48:63], v[100:103], v[168:171], v[48:63]
    v_mfma_f32_32x32x16_bf16 v[64:79], v[104:107], v[168:171], v[64:79]
    v_mfma_f32_32x32x16_bf16 v[80:95], v[108:111], v[168:171], v[80:95]
    s_waitcnt lgkmcnt(0)
    v_mfma_f32_32x32x16_bf16 v[32:47], v[112:115], v[172:175], v[32:47]
    v_mfma_f32_32x32x16_bf16 v[48:63], v[116:119], v[172:175], v[48:63]
    v_mfma_f32_32x32x16_bf16 v[64:79], v[120:123], v[172:175], v[64:79]
    v_mfma_f32_32x32x16_bf16 v[80:95], v[124:127], v[172:175], v[80:95]
    s_waitcnt vmcnt(16)
    s_barrier
    ds_read_b64_tr_b16 v[96:97], v24 offset:49152
    ds_read_b64_tr_b16 v[98:99], v24 offset:49664
    ds_read_b64_tr_b16 v[100:101], v25 offset:49152
    ds_read_b64_tr_b16 v[102:103], v25 offset:49664
    ds_read_b64_tr_b16 v[104:105], v24 offset:57344
    ds_read_b64_tr_b16 v[106:107], v24 offset:57856
    ds_read_b64_tr_b16 v[108:109], v25 offset:57344
    ds_read_b64_tr_b16 v[110:111], v25 offset:57856
    s_add_u32 m0, s43, 32768
    s_mul_i32 s50, s33, 640
    buffer_load_dwordx4 v10, s[16:19], s50 offen lds
    s_add_u32 m0, s43, 36864
    s_mul_i32 s50, s33, 672
    buffer_load_dwordx4 v10, s[16:19], s50 offen lds
    s_add_u32 m0, s43, 40960
    s_mul_i32 s50, s33, 640
    buffer_load_dwordx4 v11, s[16:19], s50 offen lds
    s_add_u32 m0, s43, 45056
    s_mul_i32 s50, s33, 672
    buffer_load_dwordx4 v11, s[16:19], s50 offen lds
    s_mov_b32 s50, 40960
    buffer_load_dwordx4 v[160:163], v8, s[12:15], s50 offen offset:0
    buffer_load_dwordx4 v[164:167], v8, s[12:15], s50 offen offset:1024
    buffer_load_dwordx4 v[168:171], v8, s[12:15], s50 offen offset:2048
    buffer_load_dwordx4 v[172:175], v8, s[12:15], s50 offen offset:3072
    ds_read_b64_tr_b16 v[112:113], v24 offset:51200
    ds_read_b64_tr_b16 v[114:115], v24 offset:51712
    ds_read_b64_tr_b16 v[116:117], v25 offset:51200
    ds_read_b64_tr_b16 v[118:119], v25 offset:51712
    ds_read_b64_tr_b16 v[120:121], v24 offset:59392
    ds_read_b64_tr_b16 v[122:123], v24 offset:59904
    ds_read_b64_tr_b16 v[124:125], v25 offset:59392
    ds_read_b64_tr_b16 v[126:127], v25 offset:59904
    s_waitcnt lgkmcnt(8)
    v_mfma_f32_32x32x16_bf16 v[32:47], v[96:99], v[176:179], v[32:47]
    v_mfma_f32_32x32x16_bf16 v[48:63], v[100:103], v[176:179], v[48:63]
    v_mfma_f32_32x32x16_bf16 v[64:79], v[104:107], v[176:179], v[64:79]
    v_mfma_f32_32x32x16_bf16 v[80:95], v[108:111], v[176:179], v[80:95]
    ds_read_b64_tr_b16 v[96:97], v24 offset:53248
    ds_read_b64_tr_b16 v[98:99], v24 offset:53760
    ds_read_b64_tr_b16 v[100:101], v25 offset:53248
    ds_read_b64_tr_b16 v[102:103], v25 offset:53760
    ds_read_b64_tr_b16 v[104:105], v24 offset:61440
    ds_read_b64_tr_b16 v[106:107], v24 offset:61952
    ds_read_b64_tr_b16 v[108:109], v25 offset:61440
    ds_read_b64_tr_b16 v[110:111], v25 offset:61952
    s_waitcnt lgkmcnt(8)
    v_mfma_f32_32x32x16_bf16 v[32:47], v[112:115], v[180:183], v[32:47]
    v_mfma_f32_32x32x16_bf16 v[48:63], v[116:119], v[180:183], v[48:63]
    v_mfma_f32_32x32x16_bf16 v[64:79], v[120:123], v[180:183], v[64:79]
    v_mfma_f32_32x32x16_bf16 v[80:95], v[124:127], v[180:183], v[80:95]
    ds_read_b64_tr_b16 v[112:113], v24 offset:55296
    ds_read_b64_tr_b16 v[114:115], v24 offset:55808
    ds_read_b64_tr_b16 v[116:117], v25 offset:55296
    ds_read_b64_tr_b16 v[118:119], v25 offset:55808
    ds_read_b64_tr_b16 v[120:121], v24 offset:63488
    ds_read_b64_tr_b16 v[122:123], v24 offset:64000
    ds_read_b64_tr_b16 v[124:125], v25 offset:63488
    ds_read_b64_tr_b16 v[126:127], v25 offset:64000
    s_waitcnt lgkmcnt(8)
    v_mfma_f32_32x32x16_bf16 v[32:47], v[96:99], v[184:187], v[32:47]
    v_mfma_f32_32x32x16_bf16 v[48:63], v[100:103], v[184:187], v[48:63]
    v_mfma_f32_32x32x16_bf16 v[64:79], v[104:107], v[184:187], v[64:79]
    v_mfma_f32_32x32x16_bf16 v[80:95], v[108:111], v[184:187], v[80:95]
    s_waitcnt lgkmcnt(0)
    v_mfma_f32_32x32x16_bf16 v[32:47], v[112:115], v[188:191], v[32:47]
    v_mfma_f32_32x32x16_bf16 v[48:63], v[116:119], v[188:191], v[48:63]
    v_mfma_f32_32x32x16_bf16 v[64:79], v[120:123], v[188:191], v[64:79]
    v_mfma_f32_32x32x16_bf16 v[80:95], v[124:127], v[188:191], v[80:95]
    s_waitcnt vmcnt(16)
    s_barrier
    ds_read_b64_tr_b16 v[96:97], v24 offset:0
    ds_read_b64_tr_b16 v[98:99], v24 offset:512
    ds_read_b64_tr_b16 v[100:101], v25 offset:0
    ds_read_b64_tr_b16 v[102:103], v25 offset:512
    ds_read_b64_tr_b16 v[104:105], v24 offset:8192
    ds_read_b64_tr_b16 v[106:107], v24 offset:8704
    ds_read_b64_tr_b16 v[108:109], v25 offset:8192
    ds_read_b64_tr_b16 v[110:111], v25 offset:8704
    s_add_u32 m0, s43, 49152
    s_mul_i32 s50, s33, 704
    buffer_load_dwordx4 v10, s[16:19], s50 offen lds
    s_add_u32 m0, s43, 53248
    s_mul_i32 s50, s33, 736
    buffer_load_dwordx4 v10, s[16:19], s50 offen lds
    s_add_u32 m0, s43, 57344
    s_mul_i32 s50, s33, 704
    buffer_load_dwordx4 v11, s[16:19], s50 offen lds
    s_add_u32 m0, s43, 61440
    s_mul_i32 s50, s33, 736
    buffer_load_dwordx4 v11, s[16:19], s50 offen lds
    s_mov_b32 s50, 45056
    buffer_load_dwordx4 v[176:179], v8, s[12:15], s50 offen offset:0
    buffer_load_dwordx4 v[180:183], v8, s[12:15], s50 offen offset:1024
    buffer_load_dwordx4 v[184:187], v8, s[12:15], s50 offen offset:2048
    buffer_load_dwordx4 v[188:191], v8, s[12:15], s50 offen offset:3072
    ds_read_b64_tr_b16 v[112:113], v24 offset:2048
    ds_read_b64_tr_b16 v[114:115], v24 offset:2560
    ds_read_b64_tr_b16 v[116:117], v25 offset:2048
    ds_read_b64_tr_b16 v[118:119], v25 offset:2560
    ds_read_b64_tr_b16 v[120:121], v24 offset:10240
    ds_read_b64_tr_b16 v[122:123], v24 offset:10752
    ds_read_b64_tr_b16 v[124:125], v25 offset:10240
    ds_read_b64_tr_b16 v[126:127], v25 offset:10752
    s_waitcnt lgkmcnt(8)
    v_mfma_f32_32x32x16_bf16 v[32:47], v[96:99], v[128:131], v[32:47]
    v_mfma_f32_32x32x16_bf16 v[48:63], v[100:103], v[128:131], v[48:63]
    v_mfma_f32_32x32x16_bf16 v[64:79], v[104:107], v[128:131], v[64:79]
    v_mfma_f32_32x32x16_bf16 v[80:95], v[108:111], v[128:131], v[80:95]
    ds_read_b64_tr_b16 v[96:97], v24 offset:4096
    ds_read_b64_tr_b16 v[98:99], v24 offset:4608
    ds_read_b64_tr_b16 v[100:101], v25 offset:4096
    ds_read_b64_tr_b16 v[102:103], v25 offset:4608
    ds_read_b64_tr_b16 v[104:105], v24 offset:12288
    ds_read_b64_tr_b16 v[106:107], v24 offset:12800
    ds_read_b64_tr_b16 v[108:109], v25 offset:12288
    ds_read_b64_tr_b16 v[110:111], v25 offset:12800
    s_waitcnt lgkmcnt(8)
    v_mfma_f32_32x32x16_bf16 v[32:47], v[112:115], v[132:135], v[32:47]
    v_mfma_f32_32x32x16_bf16 v[48:63], v[116:119], v[132:135], v[48:63]
    v_mfma_f32_32x32x16_bf16 v[64:79], v[120:123], v[132:135], v[64:79]
    v_mfma_f32_32x32x16_bf16 v[80:95], v[124:127], v[132:135], v[80:95]
    ds_read_b64_tr_b16 v[112:113], v24 offset:6144
    ds_read_b64_tr_b16 v[114:115], v24 offset:6656
    ds_read_b64_tr_b16 v[116:117], v25 offset:6144
    ds_read_b64_tr_b16 v[118:119], v25 offset:6656
    ds_read_b64_tr_b16 v[120:121], v24 offset:14336
    ds_read_b64_tr_b16 v[122:123], v24 offset:14848
    ds_read_b64_tr_b16 v[124:125], v25 offset:14336
    ds_read_b64_tr_b16 v[126:127], v25 offset:14848
    s_waitcnt lgkmcnt(8)
    v_mfma_f32_32x32x16_bf16 v[32:47], v[96:99], v[136:139], v[32:47]
    v_mfma_f32_32x32x16_bf16 v[48:63], v[100:103], v[136:139], v[48:63]
    v_mfma_f32_32x32x16_bf16 v[64:79], v[104:107], v[136:139], v[64:79]
    v_mfma_f32_32x32x16_bf16 v[80:95], v[108:111], v[136:139], v[80:95]
    s_waitcnt lgkmcnt(0)
    v_mfma_f32_32x32x16_bf16 v[32:47], v[112:115], v[140:143], v[32:47]
    v_mfma_f32_32x32x16_bf16 v[48:63], v[116:119], v[140:143], v[48:63]
    v_mfma_f32_32x32x16_bf16 v[64:79], v[120:123], v[140:143], v[64:79]
    v_mfma_f32_32x32x16_bf16 v[80:95], v[124:127], v[140:143], v[80:95]
    s_waitcnt vmcnt(16)
    s_barrier
    ds_read_b64_tr_b16 v[96:97], v24 offset:16384
    ds_read_b64_tr_b16 v[98:99], v24 offset:16896
    ds_read_b64_tr_b16 v[100:101], v25 offset:16384
    ds_read_b64_tr_b16 v[102:103], v25 offset:16896
    ds_read_b64_tr_b16 v[104:105], v24 offset:24576
    ds_read_b64_tr_b16 v[106:107], v24 offset:25088
    ds_read_b64_tr_b16 v[108:109], v25 offset:24576
    ds_read_b64_tr_b16 v[110:111], v25 offset:25088
    s_add_u32 m0, s43, 0
    s_mul_i32 s50, s33, 768
    buffer_load_dwordx4 v10, s[16:19], s50 offen lds
    s_add_u32 m0, s43, 4096
    s_mul_i32 s50, s33, 800
    buffer_load_dwordx4 v10, s[16:19], s50 offen lds
    s_add_u32 m0, s43, 8192
    s_mul_i32 s50, s33, 768
    buffer_load_dwordx4 v11, s[16:19], s50 offen lds
    s_add_u32 m0, s43, 12288
    s_mul_i32 s50, s33, 800
    buffer_load_dwordx4 v11, s[16:19], s50 offen lds
    s_mov_b32 s50, 49152
    buffer_load_dwordx4 v[128:131], v8, s[12:15], s50 offen offset:0
    buffer_load_dwordx4 v[132:135], v8, s[12:15], s50 offen offset:1024
    buffer_load_dwordx4 v[136:139], v8, s[12:15], s50 offen offset:2048
    buffer_load_dwordx4 v[140:143], v8, s[12:15], s50 offen offset:3072
    ds_read_b64_tr_b16 v[112:113], v24 offset:18432
    ds_read_b64_tr_b16 v[114:115], v24 offset:18944
    ds_read_b64_tr_b16 v[116:117], v25 offset:18432
    ds_read_b64_tr_b16 v[118:119], v25 offset:18944
    ds_read_b64_tr_b16 v[120:121], v24 offset:26624
    ds_read_b64_tr_b16 v[122:123], v24 offset:27136
    ds_read_b64_tr_b16 v[124:125], v25 offset:26624
    ds_read_b64_tr_b16 v[126:127], v25 offset:27136
    s_waitcnt lgkmcnt(8)
    v_mfma_f32_32x32x16_bf16 v[32:47], v[96:99], v[144:147], v[32:47]
    v_mfma_f32_32x32x16_bf16 v[48:63], v[100:103], v[144:147], v[48:63]
    v_mfma_f32_32x32x16_bf16 v[64:79], v[104:107], v[144:147], v[64:79]
    v_mfma_f32_32x32x16_bf16 v[80:95], v[108:111], v[144:147], v[80:95]
    ds_read_b64_tr_b16 v[96:97], v24 offset:20480
    ds_read_b64_tr_b16 v[98:99], v24 offset:20992
    ds_read_b64_tr_b16 v[100:101], v25 offset:20480
    ds_read_b64_tr_b16 v[102:103], v25 offset:20992
    ds_read_b64_tr_b16 v[104:105], v24 offset:28672
    ds_read_b64_tr_b16 v[106:107], v24 offset:29184
    ds_read_b64_tr_b16 v[108:109], v25 offset:28672
    ds_read_b64_tr_b16 v[110:111], v25 offset:29184
    s_waitcnt lgkmcnt(8)
    v_mfma_f32_32x32x16_bf16 v[32:47], v[112:115], v[148:151], v[32:47]
    v_mfma_f32_32x32x16_bf16 v[48:63], v[116:119], v[148:151], v[48:63]
    v_mfma_f32_32x32x16_bf16 v[64:79], v[120:123], v[148:151], v[64:79]
    v_mfma_f32_32x32x16_bf16 v[80:95], v[124:127], v[148:151], v[80:95]
    ds_read_b64_tr_b16 v[112:113], v24 offset:22528
    ds_read_b64_tr_b16 v[114:115], v24 offset:23040
    ds_read_b64_tr_b16 v[116:117], v25 offset:22528
    ds_read_b64_tr_b16 v[118:119], v25 offset:23040
    ds_read_b64_tr_b16 v[120:121], v24 offset:30720
    ds_read_b64_tr_b16 v[122:123], v24 offset:31232
    ds_read_b64_tr_b16 v[124:125], v25 offset:30720
    ds_read_b64_tr_b16 v[126:127], v25 offset:31232
    s_waitcnt lgkmcnt(8)
    v_mfma_f32_32x32x16_bf16 v[32:47], v[96:99], v[152:155], v[32:47]
    v_mfma_f32_32x32x16_bf16 v[48:63], v[100:103], v[152:155], v[48:63]
    v_mfma_f32_32x32x16_bf16 v[64:79], v[104:107], v[152:155], v[64:79]
    v_mfma_f32_32x32x16_bf16 v[80:95], v[108:111], v[152:155], v[80:95]
    s_waitcnt lgkmcnt(0)
    v_mfma_f32_32x32x16_bf16 v[32:47], v[112:115], v[156:159], v[32:47]
    v_mfma_f32_32x32x16_bf16 v[48:63], v[116:119], v[156:159], v[48:63]
    v_mfma_f32_32x32x16_bf16 v[64:79], v[120:123], v[156:159], v[64:79]
    v_mfma_f32_32x32x16_bf16 v[80:95], v[124:127], v[156:159], v[80:95]
    s_waitcnt vmcnt(16)
    s_barrier
    ds_read_b64_tr_b16 v[96:97], v24 offset:32768
    ds_read_b64_tr_b16 v[98:99], v24 offset:33280
    ds_read_b64_tr_b16 v[100:101], v25 offset:32768
    ds_read_b64_tr_b16 v[102:103], v25 offset:33280
    ds_read_b64_tr_b16 v[104:105], v24 offset:40960
    ds_read_b64_tr_b16 v[106:107], v24 offset:41472
    ds_read_b64_tr_b16 v[108:109], v25 offset:40960
    ds_read_b64_tr_b16 v[110:111], v25 offset:41472
    s_add_u32 m0, s43, 16384
    s_mul_i32 s50, s33, 832
    buffer_load_dwordx4 v10, s[16:19], s50 offen lds
    s_add_u32 m0, s43, 20480
    s_mul_i32 s50, s33, 864
    buffer_load_dwordx4 v10, s[16:19], s50 offen lds
    s_add_u32 m0, s43, 24576
    s_mul_i32 s50, s33, 832
    buffer_load_dwordx4 v11, s[16:19], s50 offen lds
    s_add_u32 m0, s43, 28672
    s_mul_i32 s50, s33, 864
    buffer_load_dwordx4 v11, s[16:19], s50 offen lds
    s_mov_b32 s50, 53248
    buffer_load_dwordx4 v[144:147], v8, s[12:15], s50 offen offset:0
    buffer_load_dwordx4 v[148:151], v8, s[12:15], s50 offen offset:1024
    buffer_load_dwordx4 v[152:155], v8, s[12:15], s50 offen offset:2048
    buffer_load_dwordx4 v[156:159], v8, s[12:15], s50 offen offset:3072
    ds_read_b64_tr_b16 v[112:113], v24 offset:34816
    ds_read_b64_tr_b16 v[114:115], v24 offset:35328
    ds_read_b64_tr_b16 v[116:117], v25 offset:34816
    ds_read_b64_tr_b16 v[118:119], v25 offset:35328
    ds_read_b64_tr_b16 v[120:121], v24 offset:43008
    ds_read_b64_tr_b16 v[122:123], v24 offset:43520
    ds_read_b64_tr_b16 v[124:125], v25 offset:43008
    ds_read_b64_tr_b16 v[126:127], v25 offset:43520
    s_waitcnt lgkmcnt(8)
    v_mfma_f32_32x32x16_bf16 v[32:47], v[96:99], v[160:163], v[32:47]
    v_mfma_f32_32x32x16_bf16 v[48:63], v[100:103], v[160:163], v[48:63]
    v_mfma_f32_32x32x16_bf16 v[64:79], v[104:107], v[160:163], v[64:79]
    v_mfma_f32_32x32x16_bf16 v[80:95], v[108:111], v[160:163], v[80:95]
    ds_read_b64_tr_b16 v[96:97], v24 offset:36864
    ds_read_b64_tr_b16 v[98:99], v24 offset:37376
    ds_read_b64_tr_b16 v[100:101], v25 offset:36864
    ds_read_b64_tr_b16 v[102:103], v25 offset:37376
    ds_read_b64_tr_b16 v[104:105], v24 offset:45056
    ds_read_b64_tr_b16 v[106:107], v24 offset:45568
    ds_read_b64_tr_b16 v[108:109], v25 offset:45056
    ds_read_b64_tr_b16 v[110:111], v25 offset:45568
    s_waitcnt lgkmcnt(8)
    v_mfma_f32_32x32x16_bf16 v[32:47], v[112:115], v[164:167], v[32:47]
    v_mfma_f32_32x32x16_bf16 v[48:63], v[116:119], v[164:167], v[48:63]
    v_mfma_f32_32x32x16_bf16 v[64:79], v[120:123], v[164:167], v[64:79]
    v_mfma_f32_32x32x16_bf16 v[80:95], v[124:127], v[164:167], v[80:95]
    ds_read_b64_tr_b16 v[112:113], v24 offset:38912
    ds_read_b64_tr_b16 v[114:115], v24 offset:39424
    ds_read_b64_tr_b16 v[116:117], v25 offset:38912
    ds_read_b64_tr_b16 v[118:119], v25 offset:39424
    ds_read_b64_tr_b16 v[120:121], v24 offset:47104
    ds_read_b64_tr_b16 v[122:123], v24 offset:47616
    ds_read_b64_tr_b16 v[124:125], v25 offset:47104
    ds_read_b64_tr_b16 v[126:127], v25 offset:47616
    s_waitcnt lgkmcnt(8)
    v_mfma_f32_32x32x16_bf16 v[32:47], v[96:99], v[168:171], v[32:47]
    v_mfma_f32_32x32x16_bf16 v[48:63], v[100:103], v[168:171], v[48:63]
    v_mfma_f32_32x32x16_bf16 v[64:79], v[104:107], v[168:171], v[64:79]
    v_mfma_f32_32x32x16_bf16 v[80:95], v[108:111], v[168:171], v[80:95]
    s_waitcnt lgkmcnt(0)
    v_mfma_f32_32x32x16_bf16 v[32:47], v[112:115], v[172:175], v[32:47]
    v_mfma_f32_32x32x16_bf16 v[48:63], v[116:119], v[172:175], v[48:63]
    v_mfma_f32_32x32x16_bf16 v[64:79], v[120:123], v[172:175], v[64:79]
    v_mfma_f32_32x32x16_bf16 v[80:95], v[124:127], v[172:175], v[80:95]
    s_waitcnt vmcnt(16)
    s_barrier
    ds_read_b64_tr_b16 v[96:97], v24 offset:49152
    ds_read_b64_tr_b16 v[98:99], v24 offset:49664
    ds_read_b64_tr_b16 v[100:101], v25 offset:49152
    ds_read_b64_tr_b16 v[102:103], v25 offset:49664
    ds_read_b64_tr_b16 v[104:105], v24 offset:57344
    ds_read_b64_tr_b16 v[106:107], v24 offset:57856
    ds_read_b64_tr_b16 v[108:109], v25 offset:57344
    ds_read_b64_tr_b16 v[110:111], v25 offset:57856
    s_add_u32 m0, s43, 32768
    s_mul_i32 s50, s33, 896
    buffer_load_dwordx4 v10, s[16:19], s50 offen lds
    s_add_u32 m0, s43, 36864
    s_mul_i32 s50, s33, 928
    buffer_load_dwordx4 v10, s[16:19], s50 offen lds
    s_add_u32 m0, s43, 40960
    s_mul_i32 s50, s33, 896
    buffer_load_dwordx4 v11, s[16:19], s50 offen lds
    s_add_u32 m0, s43, 45056
    s_mul_i32 s50, s33, 928
    buffer_load_dwordx4 v11, s[16:19], s50 offen lds
    s_mov_b32 s50, 57344
    buffer_load_dwordx4 v[160:163], v8, s[12:15], s50 offen offset:0
    buffer_load_dwordx4 v[164:167], v8, s[12:15], s50 offen offset:1024
    buffer_load_dwordx4 v[168:171], v8, s[12:15], s50 offen offset:2048
    buffer_load_dwordx4 v[172:175], v8, s[12:15], s50 offen offset:3072
    ds_read_b64_tr_b16 v[112:113], v24 offset:51200
    ds_read_b64_tr_b16 v[114:115], v24 offset:51712
    ds_read_b64_tr_b16 v[116:117], v25 offset:51200
    ds_read_b64_tr_b16 v[118:119], v25 offset:51712
    ds_read_b64_tr_b16 v[120:121], v24 offset:59392
    ds_read_b64_tr_b16 v[122:123], v24 offset:59904
    ds_read_b64_tr_b16 v[124:125], v25 offset:59392
    ds_read_b64_tr_b16 v[126:127], v25 offset:59904
    s_waitcnt lgkmcnt(8)
    v_mfma_f32_32x32x16_bf16 v[32:47], v[96:99], v[176:179], v[32:47]
    v_mfma_f32_32x32x16_bf16 v[48:63], v[100:103], v[176:179], v[48:63]
    v_mfma_f32_32x32x16_bf16 v[64:79], v[104:107], v[176:179], v[64:79]
    v_mfma_f32_32x32x16_bf16 v[80:95], v[108:111], v[176:179], v[80:95]
    ds_read_b64_tr_b16 v[96:97], v24 offset:53248
    ds_read_b64_tr_b16 v[98:99], v24 offset:53760
    ds_read_b64_tr_b16 v[100:101], v25 offset:53248
    ds_read_b64_tr_b16 v[102:103], v25 offset:53760
    ds_read_b64_tr_b16 v[104:105], v24 offset:61440
    ds_read_b64_tr_b16 v[106:107], v24 offset:61952
    ds_read_b64_tr_b16 v[108:109], v25 offset:61440
    ds_read_b64_tr_b16 v[110:111], v25 offset:61952
    s_waitcnt lgkmcnt(8)
    v_mfma_f32_32x32x16_bf16 v[32:47], v[112:115], v[180:183], v[32:47]
    v_mfma_f32_32x32x16_bf16 v[48:63], v[116:119], v[180:183], v[48:63]
    v_mfma_f32_32x32x16_bf16 v[64:79], v[120:123], v[180:183], v[64:79]
    v_mfma_f32_32x32x16_bf16 v[80:95], v[124:127], v[180:183], v[80:95]
    ds_read_b64_tr_b16 v[112:113], v24 offset:55296
    ds_read_b64_tr_b16 v[114:115], v24 offset:55808
    ds_read_b64_tr_b16 v[116:117], v25 offset:55296
    ds_read_b64_tr_b16 v[118:119], v25 offset:55808
    ds_read_b64_tr_b16 v[120:121], v24 offset:63488
    ds_read_b64_tr_b16 v[122:123], v24 offset:64000
    ds_read_b64_tr_b16 v[124:125], v25 offset:63488
    ds_read_b64_tr_b16 v[126:127], v25 offset:64000
    s_waitcnt lgkmcnt(8)
    v_mfma_f32_32x32x16_bf16 v[32:47], v[96:99], v[184:187], v[32:47]
    v_mfma_f32_32x32x16_bf16 v[48:63], v[100:103], v[184:187], v[48:63]
    v_mfma_f32_32x32x16_bf16 v[64:79], v[104:107], v[184:187], v[64:79]
    v_mfma_f32_32x32x16_bf16 v[80:95], v[108:111], v[184:187], v[80:95]
    s_waitcnt lgkmcnt(0)
    v_mfma_f32_32x32x16_bf16 v[32:47], v[112:115], v[188:191], v[32:47]
    v_mfma_f32_32x32x16_bf16 v[48:63], v[116:119], v[188:191], v[48:63]
    v_mfma_f32_32x32x16_bf16 v[64:79], v[120:123], v[188:191], v[64:79]
    v_mfma_f32_32x32x16_bf16 v[80:95], v[124:127], v[188:191], v[80:95]
    s_waitcnt vmcnt(16)
    s_barrier
    ds_read_b64_tr_b16 v[96:97], v24 offset:0
    ds_read_b64_tr_b16 v[98:99], v24 offset:512
    ds_read_b64_tr_b16 v[100:101], v25 offset:0
    ds_read_b64_tr_b16 v[102:103], v25 offset:512
    ds_read_b64_tr_b16 v[104:105], v24 offset:8192
    ds_read_b64_tr_b16 v[106:107], v24 offset:8704
    ds_read_b64_tr_b16 v[108:109], v25 offset:8192
    ds_read_b64_tr_b16 v[110:111], v25 offset:8704
    s_add_u32 m0, s43, 49152
    s_mul_i32 s50, s33, 960
    buffer_load_dwordx4 v10, s[16:19], s50 offen lds
    s_add_u32 m0, s43, 53248
    s_mul_i32 s50, s33, 992
    buffer_load_dwordx4 v10, s[16:19], s50 offen lds
    s_add_u32 m0, s43, 57344
    s_mul_i32 s50, s33, 960
    buffer_load_dwordx4 v11, s[16:19], s50 offen lds
    s_add_u32 m0, s43, 61440
    s_mul_i32 s50, s33, 992
    buffer_load_dwordx4 v11, s[16:19], s50 offen lds
    s_mov_b32 s50, 61440
    buffer_load_dwordx4 v[176:179], v8, s[12:15], s50 offen offset:0
    buffer_load_dwordx4 v[180:183], v8, s[12:15], s50 offen offset:1024
    buffer_load_dwordx4 v[184:187], v8, s[12:15], s50 offen offset:2048
    buffer_load_dwordx4 v[188:191], v8, s[12:15], s50 offen offset:3072
    ds_read_b64_tr_b16 v[112:113], v24 offset:2048
    ds_read_b64_tr_b16 v[114:115], v24 offset:2560
    ds_read_b64_tr_b16 v[116:117], v25 offset:2048
    ds_read_b64_tr_b16 v[118:119], v25 offset:2560
    ds_read_b64_tr_b16 v[120:121], v24 offset:10240
    ds_read_b64_tr_b16 v[122:123], v24 offset:10752
    ds_read_b64_tr_b16 v[124:125], v25 offset:10240
    ds_read_b64_tr_b16 v[126:127], v25 offset:10752
    s_waitcnt lgkmcnt(8)
    v_mfma_f32_32x32x16_bf16 v[32:47], v[96:99], v[128:131], v[32:47]
    v_mfma_f32_32x32x16_bf16 v[48:63], v[100:103], v[128:131], v[48:63]
    v_mfma_f32_32x32x16_bf16 v[64:79], v[104:107], v[128:131], v[64:79]
    v_mfma_f32_32x32x16_bf16 v[80:95], v[108:111], v[128:131], v[80:95]
    ds_read_b64_tr_b16 v[96:97], v24 offset:4096
    ds_read_b64_tr_b16 v[98:99], v24 offset:4608
    ds_read_b64_tr_b16 v[100:101], v25 offset:4096
    ds_read_b64_tr_b16 v[102:103], v25 offset:4608
    ds_read_b64_tr_b16 v[104:105], v24 offset:12288
    ds_read_b64_tr_b16 v[106:107], v24 offset:12800
    ds_read_b64_tr_b16 v[108:109], v25 offset:12288
    ds_read_b64_tr_b16 v[110:111], v25 offset:12800
    s_waitcnt lgkmcnt(8)
    v_mfma_f32_32x32x16_bf16 v[32:47], v[112:115], v[132:135], v[32:47]
    v_mfma_f32_32x32x16_bf16 v[48:63], v[116:119], v[132:135], v[48:63]
    v_mfma_f32_32x32x16_bf16 v[64:79], v[120:123], v[132:135], v[64:79]
    v_mfma_f32_32x32x16_bf16 v[80:95], v[124:127], v[132:135], v[80:95]
    ds_read_b64_tr_b16 v[112:113], v24 offset:6144
    ds_read_b64_tr_b16 v[114:115], v24 offset:6656
    ds_read_b64_tr_b16 v[116:117], v25 offset:6144
    ds_read_b64_tr_b16 v[118:119], v25 offset:6656
    ds_read_b64_tr_b16 v[120:121], v24 offset:14336
    ds_read_b64_tr_b16 v[122:123], v24 offset:14848
    ds_read_b64_tr_b16 v[124:125], v25 offset:14336
    ds_read_b64_tr_b16 v[126:127], v25 offset:14848
    s_waitcnt lgkmcnt(8)
    v_mfma_f32_32x32x16_bf16 v[32:47], v[96:99], v[136:139], v[32:47]
    v_mfma_f32_32x32x16_bf16 v[48:63], v[100:103], v[136:139], v[48:63]
    v_mfma_f32_32x32x16_bf16 v[64:79], v[104:107], v[136:139], v[64:79]
    v_mfma_f32_32x32x16_bf16 v[80:95], v[108:111], v[136:139], v[80:95]
    s_waitcnt lgkmcnt(0)
    v_mfma_f32_32x32x16_bf16 v[32:47], v[112:115], v[140:143], v[32:47]
    v_mfma_f32_32x32x16_bf16 v[48:63], v[116:119], v[140:143], v[48:63]
    v_mfma_f32_32x32x16_bf16 v[64:79], v[120:123], v[140:143], v[64:79]
    v_mfma_f32_32x32x16_bf16 v[80:95], v[124:127], v[140:143], v[80:95]
    s_waitcnt vmcnt(16)
    s_barrier
    ds_read_b64_tr_b16 v[96:97], v24 offset:16384
    ds_read_b64_tr_b16 v[98:99], v24 offset:16896
    ds_read_b64_tr_b16 v[100:101], v25 offset:16384
    ds_read_b64_tr_b16 v[102:103], v25 offset:16896
    ds_read_b64_tr_b16 v[104:105], v24 offset:24576
    ds_read_b64_tr_b16 v[106:107], v24 offset:25088
    ds_read_b64_tr_b16 v[108:109], v25 offset:24576
    ds_read_b64_tr_b16 v[110:111], v25 offset:25088
    ds_read_b64_tr_b16 v[112:113], v24 offset:18432
    ds_read_b64_tr_b16 v[114:115], v24 offset:18944
    ds_read_b64_tr_b16 v[116:117], v25 offset:18432
    ds_read_b64_tr_b16 v[118:119], v25 offset:18944
    ds_read_b64_tr_b16 v[120:121], v24 offset:26624
    ds_read_b64_tr_b16 v[122:123], v24 offset:27136
    ds_read_b64_tr_b16 v[124:125], v25 offset:26624
    ds_read_b64_tr_b16 v[126:127], v25 offset:27136
    s_waitcnt lgkmcnt(8)
    v_mfma_f32_32x32x16_bf16 v[32:47], v[96:99], v[144:147], v[32:47]
    v_mfma_f32_32x32x16_bf16 v[48:63], v[100:103], v[144:147], v[48:63]
    v_mfma_f32_32x32x16_bf16 v[64:79], v[104:107], v[144:147], v[64:79]
    v_mfma_f32_32x32x16_bf16 v[80:95], v[108:111], v[144:147], v[80:95]
    ds_read_b64_tr_b16 v[96:97], v24 offset:20480
    ds_read_b64_tr_b16 v[98:99], v24 offset:20992
    ds_read_b64_tr_b16 v[100:101], v25 offset:20480
    ds_read_b64_tr_b16 v[102:103], v25 offset:20992
    ds_read_b64_tr_b16 v[104:105], v24 offset:28672
    ds_read_b64_tr_b16 v[106:107], v24 offset:29184
    ds_read_b64_tr_b16 v[108:109], v25 offset:28672
    ds_read_b64_tr_b16 v[110:111], v25 offset:29184
    s_waitcnt lgkmcnt(8)
    v_mfma_f32_32x32x16_bf16 v[32:47], v[112:115], v[148:151], v[32:47]
    v_mfma_f32_32x32x16_bf16 v[48:63], v[116:119], v[148:151], v[48:63]
    v_mfma_f32_32x32x16_bf16 v[64:79], v[120:123], v[148:151], v[64:79]
    v_mfma_f32_32x32x16_bf16 v[80:95], v[124:127], v[148:151], v[80:95]
    ds_read_b64_tr_b16 v[112:113], v24 offset:22528
    ds_read_b64_tr_b16 v[114:115], v24 offset:23040
    ds_read_b64_tr_b16 v[116:117], v25 offset:22528
    ds_read_b64_tr_b16 v[118:119], v25 offset:23040
    ds_read_b64_tr_b16 v[120:121], v24 offset:30720
    ds_read_b64_tr_b16 v[122:123], v24 offset:31232
    ds_read_b64_tr_b16 v[124:125], v25 offset:30720
    ds_read_b64_tr_b16 v[126:127], v25 offset:31232
    s_waitcnt lgkmcnt(8)
    v_mfma_f32_32x32x16_bf16 v[32:47], v[96:99], v[152:155], v[32:47]
    v_mfma_f32_32x32x16_bf16 v[48:63], v[100:103], v[152:155], v[48:63]
    v_mfma_f32_32x32x16_bf16 v[64:79], v[104:107], v[152:155], v[64:79]
    v_mfma_f32_32x32x16_bf16 v[80:95], v[108:111], v[152:155], v[80:95]
    s_waitcnt lgkmcnt(0)
    v_mfma_f32_32x32x16_bf16 v[32:47], v[112:115], v[156:159], v[32:47]
    v_mfma_f32_32x32x16_bf16 v[48:63], v[116:119], v[156:159], v[48:63]
    v_mfma_f32_32x32x16_bf16 v[64:79], v[120:123], v[156:159], v[64:79]
    v_mfma_f32_32x32x16_bf16 v[80:95], v[124:127], v[156:159], v[80:95]
    s_waitcnt vmcnt(8)
    s_barrier
    ds_read_b64_tr_b16 v[96:97], v24 offset:32768
    ds_read_b64_tr_b16 v[98:99], v24 offset:33280
    ds_read_b64_tr_b16 v[100:101], v25 offset:32768
    ds_read_b64_tr_b16 v[102:103], v25 offset:33280
    ds_read_b64_tr_b16 v[104:105], v24 offset:40960
    ds_read_b64_tr_b16 v[106:107], v24 offset:41472
    ds_read_b64_tr_b16 v[108:109], v25 offset:40960
    ds_read_b64_tr_b16 v[110:111], v25 offset:41472
    ds_read_b64_tr_b16 v[112:113], v24 offset:34816
    ds_read_b64_tr_b16 v[114:115], v24 offset:35328
    ds_read_b64_tr_b16 v[116:117], v25 offset:34816
    ds_read_b64_tr_b16 v[118:119], v25 offset:35328
    ds_read_b64_tr_b16 v[120:121], v24 offset:43008
    ds_read_b64_tr_b16 v[122:123], v24 offset:43520
    ds_read_b64_tr_b16 v[124:125], v25 offset:43008
    ds_read_b64_tr_b16 v[126:127], v25 offset:43520
    s_waitcnt lgkmcnt(8)
    v_mfma_f32_32x32x16_bf16 v[32:47], v[96:99], v[160:163], v[32:47]
    v_mfma_f32_32x32x16_bf16 v[48:63], v[100:103], v[160:163], v[48:63]
    v_mfma_f32_32x32x16_bf16 v[64:79], v[104:107], v[160:163], v[64:79]
    v_mfma_f32_32x32x16_bf16 v[80:95], v[108:111], v[160:163], v[80:95]
    ds_read_b64_tr_b16 v[96:97], v24 offset:36864
    ds_read_b64_tr_b16 v[98:99], v24 offset:37376
    ds_read_b64_tr_b16 v[100:101], v25 offset:36864
    ds_read_b64_tr_b16 v[102:103], v25 offset:37376
    ds_read_b64_tr_b16 v[104:105], v24 offset:45056
    ds_read_b64_tr_b16 v[106:107], v24 offset:45568
    ds_read_b64_tr_b16 v[108:109], v25 offset:45056
    ds_read_b64_tr_b16 v[110:111], v25 offset:45568
    s_waitcnt lgkmcnt(8)
    v_mfma_f32_32x32x16_bf16 v[32:47], v[112:115], v[164:167], v[32:47]
    v_mfma_f32_32x32x16_bf16 v[48:63], v[116:119], v[164:167], v[48:63]
    v_mfma_f32_32x32x16_bf16 v[64:79], v[120:123], v[164:167], v[64:79]
    v_mfma_f32_32x32x16_bf16 v[80:95], v[124:127], v[164:167], v[80:95]
    ds_read_b64_tr_b16 v[112:113], v24 offset:38912
    ds_read_b64_tr_b16 v[114:115], v24 offset:39424
    ds_read_b64_tr_b16 v[116:117], v25 offset:38912
    ds_read_b64_tr_b16 v[118:119], v25 offset:39424
    ds_read_b64_tr_b16 v[120:121], v24 offset:47104
    ds_read_b64_tr_b16 v[122:123], v24 offset:47616
    ds_read_b64_tr_b16 v[124:125], v25 offset:47104
    ds_read_b64_tr_b16 v[126:127], v25 offset:47616
    s_waitcnt lgkmcnt(8)
    v_mfma_f32_32x32x16_bf16 v[32:47], v[96:99], v[168:171], v[32:47]
    v_mfma_f32_32x32x16_bf16 v[48:63], v[100:103], v[168:171], v[48:63]
    v_mfma_f32_32x32x16_bf16 v[64:79], v[104:107], v[168:171], v[64:79]
    v_mfma_f32_32x32x16_bf16 v[80:95], v[108:111], v[168:171], v[80:95]
    s_waitcnt lgkmcnt(0)
    v_mfma_f32_32x32x16_bf16 v[32:47], v[112:115], v[172:175], v[32:47]
    v_mfma_f32_32x32x16_bf16 v[48:63], v[116:119], v[172:175], v[48:63]
    v_mfma_f32_32x32x16_bf16 v[64:79], v[120:123], v[172:175], v[64:79]
    v_mfma_f32_32x32x16_bf16 v[80:95], v[124:127], v[172:175], v[80:95]
    s_waitcnt vmcnt(0)
    s_barrier
    ds_read_b64_tr_b16 v[96:97], v24 offset:49152
    ds_read_b64_tr_b16 v[98:99], v24 offset:49664
    ds_read_b64_tr_b16 v[100:101], v25 offset:49152
    ds_read_b64_tr_b16 v[102:103], v25 offset:49664
    ds_read_b64_tr_b16 v[104:105], v24 offset:57344
    ds_read_b64_tr_b16 v[106:107], v24 offset:57856
    ds_read_b64_tr_b16 v[108:109], v25 offset:57344
    ds_read_b64_tr_b16 v[110:111], v25 offset:57856
    ds_read_b64_tr_b16 v[112:113], v24 offset:51200
    ds_read_b64_tr_b16 v[114:115], v24 offset:51712
    ds_read_b64_tr_b16 v[116:117], v25 offset:51200
    ds_read_b64_tr_b16 v[118:119], v25 offset:51712
    ds_read_b64_tr_b16 v[120:121], v24 offset:59392
    ds_read_b64_tr_b16 v[122:123], v24 offset:59904
    ds_read_b64_tr_b16 v[124:125], v25 offset:59392
    ds_read_b64_tr_b16 v[126:127], v25 offset:59904
    s_waitcnt lgkmcnt(8)
    v_mfma_f32_32x32x16_bf16 v[32:47], v[96:99], v[176:179], v[32:47]
    v_mfma_f32_32x32x16_bf16 v[48:63], v[100:103], v[176:179], v[48:63]
    v_mfma_f32_32x32x16_bf16 v[64:79], v[104:107], v[176:179], v[64:79]
    v_mfma_f32_32x32x16_bf16 v[80:95], v[108:111], v[176:179], v[80:95]
    ds_read_b64_tr_b16 v[96:97], v24 offset:53248
    ds_read_b64_tr_b16 v[98:99], v24 offset:53760
    ds_read_b64_tr_b16 v[100:101], v25 offset:53248
    ds_read_b64_tr_b16 v[102:103], v25 offset:53760
    ds_read_b64_tr_b16 v[104:105], v24 offset:61440
    ds_read_b64_tr_b16 v[106:107], v24 offset:61952
    ds_read_b64_tr_b16 v[108:109], v25 offset:61440
    ds_read_b64_tr_b16 v[110:111], v25 offset:61952
    s_waitcnt lgkmcnt(8)
    v_mfma_f32_32x32x16_bf16 v[32:47], v[112:115], v[180:183], v[32:47]
    v_mfma_f32_32x32x16_bf16 v[48:63], v[116:119], v[180:183], v[48:63]
    v_mfma_f32_32x32x16_bf16 v[64:79], v[120:123], v[180:183], v[64:79]
    v_mfma_f32_32x32x16_bf16 v[80:95], v[124:127], v[180:183], v[80:95]
    ds_read_b64_tr_b16 v[112:113], v24 offset:55296
    ds_read_b64_tr_b16 v[114:115], v24 offset:55808
    ds_read_b64_tr_b16 v[116:117], v25 offset:55296
    ds_read_b64_tr_b16 v[118:119], v25 offset:55808
    ds_read_b64_tr_b16 v[120:121], v24 offset:63488
    ds_read_b64_tr_b16 v[122:123], v24 offset:64000
    ds_read_b64_tr_b16 v[124:125], v25 offset:63488
    ds_read_b64_tr_b16 v[126:127], v25 offset:64000
    s_waitcnt lgkmcnt(8)
    v_mfma_f32_32x32x16_bf16 v[32:47], v[96:99], v[184:187], v[32:47]
    v_mfma_f32_32x32x16_bf16 v[48:63], v[100:103], v[184:187], v[48:63]
    v_mfma_f32_32x32x16_bf16 v[64:79], v[104:107], v[184:187], v[64:79]
    v_mfma_f32_32x32x16_bf16 v[80:95], v[108:111], v[184:187], v[80:95]
    s_waitcnt lgkmcnt(0)
    v_mfma_f32_32x32x16_bf16 v[32:47], v[112:115], v[188:191], v[32:47]
    v_mfma_f32_32x32x16_bf16 v[48:63], v[116:119], v[188:191], v[48:63]
    v_mfma_f32_32x32x16_bf16 v[64:79], v[120:123], v[188:191], v[64:79]
    v_mfma_f32_32x32x16_bf16 v[80:95], v[124:127], v[188:191], v[80:95]
    s_nop 15
    s_nop 3
    s_lshl_b32 s54, s53, 7
    s_add_u32 s54, s54, s46
    v_add_u32 v5, s54, v3
    v_lshlrev_b32 v5, 10, v5
    s_lshl_b32 s54, s51, 21
    v_add_u32 v5, s54, v5
    s_lshl_b32 s54, s52, 8
    v_add_u32 v5, s54, v5
    v_lshl_add_u32 v5, v4, 4, v5
    v_cvt_pk_bf16_f32 v96, v32, v33
    v_cvt_pk_bf16_f32 v97, v34, v35
    v_cvt_pk_bf16_f32 v98, v36, v37
    v_cvt_pk_bf16_f32 v99, v38, v39
    s_nop 1
    v_permlane32_swap_b32 v96, v98
    v_permlane32_swap_b32 v97, v99
    s_nop 1
    buffer_store_dwordx4 v[96:99], v5, s[24:27], 0 offen offset:0
    v_cvt_pk_bf16_f32 v100, v40, v41
    v_cvt_pk_bf16_f32 v101, v42, v43
    v_cvt_pk_bf16_f32 v102, v44, v45
    v_cvt_pk_bf16_f32 v103, v46, v47
    s_nop 1
    v_permlane32_swap_b32 v100, v102
    v_permlane32_swap_b32 v101, v103
    s_nop 1
    buffer_store_dwordx4 v[100:103], v5, s[24:27], 0 offen offset:32
    v_cvt_pk_bf16_f32 v104, v48, v49
    v_cvt_pk_bf16_f32 v105, v50, v51
    v_cvt_pk_bf16_f32 v106, v52, v53
    v_cvt_pk_bf16_f32 v107, v54, v55
    s_nop 1
    v_permlane32_swap_b32 v104, v106
    v_permlane32_swap_b32 v105, v107
    s_nop 1
    buffer_store_dwordx4 v[104:107], v5, s[24:27], 0 offen offset:64
    v_cvt_pk_bf16_f32 v108, v56, v57
    v_cvt_pk_bf16_f32 v109, v58, v59
    v_cvt_pk_bf16_f32 v110, v60, v61
    v_cvt_pk_bf16_f32 v111, v62, v63
    s_nop 1
    v_permlane32_swap_b32 v108, v110
    v_permlane32_swap_b32 v109, v111
    s_nop 1
    buffer_store_dwordx4 v[108:111], v5, s[24:27], 0 offen offset:96
    v_cvt_pk_bf16_f32 v96, v64, v65
    v_cvt_pk_bf16_f32 v97, v66, v67
    v_cvt_pk_bf16_f32 v98, v68, v69
    v_cvt_pk_bf16_f32 v99, v70, v71
    s_nop 1
    v_permlane32_swap_b32 v96, v98
    v_permlane32_swap_b32 v97, v99
    s_nop 1
    buffer_store_dwordx4 v[96:99], v5, s[24:27], 0 offen offset:128
    v_cvt_pk_bf16_f32 v100, v72, v73
    v_cvt_pk_bf16_f32 v101, v74, v75
    v_cvt_pk_bf16_f32 v102, v76, v77
    v_cvt_pk_bf16_f32 v103, v78, v79
    s_nop 1
    v_permlane32_swap_b32 v100, v102
    v_permlane32_swap_b32 v101, v103
    s_nop 1
    buffer_store_dwordx4 v[100:103], v5, s[24:27], 0 offen offset:160
    v_cvt_pk_bf16_f32 v104, v80, v81
    v_cvt_pk_bf16_f32 v105, v82, v83
    v_cvt_pk_bf16_f32 v106, v84, v85
    v_cvt_pk_bf16_f32 v107, v86, v87
    s_nop 1
    v_permlane32_swap_b32 v104, v106
    v_permlane32_swap_b32 v105, v107
    s_nop 1
    buffer_store_dwordx4 v[104:107], v5, s[24:27], 0 offen offset:192
    v_cvt_pk_bf16_f32 v108, v88, v89
    v_cvt_pk_bf16_f32 v109, v90, v91
    v_cvt_pk_bf16_f32 v110, v92, v93
    v_cvt_pk_bf16_f32 v111, v94, v95
    s_nop 1
    v_permlane32_swap_b32 v108, v110
    v_permlane32_swap_b32 v109, v111
    s_nop 1
    buffer_store_dwordx4 v[108:111], v5, s[24:27], 0 offen offset:224
oproj_kernel_done:
    s_endpgm
.section .rodata,"a"
.p2align 6
.amdhsa_kernel oproj_kernel
  .amdhsa_next_free_vgpr 192
  .amdhsa_next_free_sgpr 102
  .amdhsa_accum_offset 192
  .amdhsa_group_segment_fixed_size 0
  .amdhsa_kernarg_size 112
  .amdhsa_user_sgpr_count 2
  .amdhsa_user_sgpr_kernarg_segment_ptr 1
  .amdhsa_system_sgpr_workgroup_id_x 1
  .amdhsa_float_denorm_mode_32 3
.end_amdhsa_kernel
.text
.globl ln2_kernel
.p2align 8
.type ln2_kernel,@function
ln2_kernel:
    s_cmp_ge_u32 s2, 512
    s_cbranch_scc1 ln2_kernel_done
    s_load_dwordx2 s[4:5], s[0:1], 0
    s_load_dwordx2 s[8:9], s[0:1], 104
    s_waitcnt lgkmcnt(0)
    s_mov_b32 s12, s4
    s_and_b32 s13, s5, 0xffff
    s_mov_b32 s14, 2097152
    s_mov_b32 s15, 0x20000
    s_mov_b32 s16, s8
    s_and_b32 s17, s9, 0xffff
    s_mov_b32 s18, 12288
    s_mov_b32 s19, 0x20000
    s_add_u32 s20, s8, 54525952
    s_addc_u32 s21, s9, 0
    s_and_b32 s21, s21, 0xffff
    s_mov_b32 s22, 2097152
    s_mov_b32 s23, 0x20000
    s_add_u32 s32, s8, 50331648
    s_addc_u32 s33, s9, 0
    s_and_b32 s33, s33, 0xffff
    s_mov_b32 s34, 2097152
    s_mov_b32 s35, 0x20000
    s_add_u32 s36, s8, 33554432
    s_addc_u32 s37, s9, 0
    s_and_b32 s37, s37, 0xffff
    s_mov_b32 s38, 8388608
    s_mov_b32 s39, 0x20000
    s_lshl_b32 s3, s2, 12
    v_lshlrev_b32 v1, 4, v0
    v_add_u32 v1, s3, v1
    v_lshlrev_b32 v2, 1, v1
    buffer_load_dwordx4 v[4:7], v1, s[12:15], 0 offen
    s_mov_b32 s40, 0
    buffer_load_dwordx4 v[104:107], v1, s[36:39], s40 offen
    s_mov_b32 s40, 2097152
    buffer_load_dwordx4 v[108:111], v1, s[36:39], s40 offen
    s_mov_b32 s40, 4194304
    buffer_load_dwordx4 v[112:115], v1, s[36:39], s40 offen
    s_mov_b32 s40, 6291456
    buffer_load_dwordx4 v[116:119], v1, s[36:39], s40 offen
    v_and_b32 v3, 63, v0
    v_lshlrev_b32 v3, 5, v3
    s_mov_b32 s40, 4096
    buffer_load_dwordx4 v[96:99], v3, s[16:19], s40 offen
    buffer_load_dwordx4 v[100:103], v3, s[16:19], s40 offen offset:16
    s_waitcnt vmcnt(0)
    v_lshlrev_b32 v8, 16, v4
    v_and_b32 v9, 0xffff0000, v4
    v_lshlrev_b32 v10, 16, v5
    v_and_b32 v11, 0xffff0000, v5
    v_lshlrev_b32 v12, 16, v6
    v_and_b32 v13, 0xffff0000, v6
    v_lshlrev_b32 v14, 16, v7
    v_and_b32 v15, 0xffff0000, v7
    v_lshlrev_b32 v64, 16, v104
    v_and_b32 v65, 0xffff0000, v104
    v_lshlrev_b32 v66, 16, v105
    v_and_b32 v67, 0xffff0000, v105
    v_lshlrev_b32 v68, 16, v106
    v_and_b32 v69, 0xffff0000, v106
    v_lshlrev_b32 v70, 16, v107
    v_and_b32 v71, 0xffff0000, v107
    v_lshlrev_b32 v72, 16, v108
    v_and_b32 v73, 0xffff0000, v108
    v_lshlrev_b32 v74, 16, v109
    v_and_b32 v75, 0xffff0000, v109
    v_lshlrev_b32 v76, 16, v110
    v_and_b32 v77, 0xffff0000, v110
    v_lshlrev_b32 v78, 16, v111
    v_and_b32 v79, 0xffff0000, v111
    v_lshlrev_b32 v80, 16, v112
    v_and_b32 v81, 0xffff0000, v112
    v_lshlrev_b32 v82, 16, v113
    v_and_b32 v83, 0xffff0000, v113
    v_lshlrev_b32 v84, 16, v114
    v_and_b32 v85, 0xffff0000, v114
    v_lshlrev_b32 v86, 16, v115
    v_and_b32 v87, 0xffff0000, v115
    v_lshlrev_b32 v88, 16, v116
    v_and_b32 v89, 0xffff0000, v116
    v_lshlrev_b32 v90, 16, v117
    v_and_b32 v91, 0xffff0000, v117
    v_lshlrev_b32 v92, 16, v118
    v_and_b32 v93, 0xffff0000, v118
    v_lshlrev_b32 v94, 16, v119
    v_and_b32 v95, 0xffff0000, v119
    v_add_f32 v64, v64, v72
    v_add_f32 v80, v80, v88
    v_add_f32 v64, v64, v80
    v_add_f32 v65, v65, v73
    v_add_f32 v81, v81, v89
    v_add_f32 v65, v65, v81
    v_add_f32 v66, v66, v74
    v_add_f32 v82, v82, v90
    v_add_f32 v66, v66, v82
    v_add_f32 v67, v67, v75
    v_add_f32 v83, v83, v91
    v_add_f32 v67, v67, v83
    v_add_f32 v68, v68, v76
    v_add_f32 v84, v84, v92
    v_add_f32 v68, v68, v84
    v_add_f32 v69, v69, v77
    v_add_f32 v85, v85, v93
    v_add_f32 v69, v69, v85
    v_add_f32 v70, v70, v78
    v_add_f32 v86, v86, v94
    v_add_f32 v70, v70, v86
    v_add_f32 v71, v71, v79
    v_add_f32 v87, v87, v95
    v_add_f32 v71, v71, v87
    v_cvt_pk_bf16_f32 v20, v64, v65
    v_lshlrev_b32 v64, 16, v20
    v_and_b32 v65, 0xffff0000, v20
    v_mul_f32 v64, v64, v96
    v_mul_f32 v65, v65, v97
    v_cvt_pk_bf16_f32 v20, v64, v65
    v_lshlrev_b32 v64, 16, v20
    v_and_b32 v65, 0xffff0000, v20
    v_add_f32 v8, v8, v64
    v_add_f32 v9, v9, v65
    v_cvt_pk_bf16_f32 v4, v8, v9
    v_lshlrev_b32 v8, 16, v4
    v_and_b32 v9, 0xffff0000, v4
    v_cvt_pk_bf16_f32 v20, v66, v67
    v_lshlrev_b32 v66, 16, v20
    v_and_b32 v67, 0xffff0000, v20
    v_mul_f32 v66, v66, v98
    v_mul_f32 v67, v67, v99
    v_cvt_pk_bf16_f32 v20, v66, v67
    v_lshlrev_b32 v66, 16, v20
    v_and_b32 v67, 0xffff0000, v20
    v_add_f32 v10, v10, v66
    v_add_f32 v11, v11, v67
    v_cvt_pk_bf16_f32 v5, v10, v11
    v_lshlrev_b32 v10, 16, v5
    v_and_b32 v11, 0xffff0000, v5
    v_cvt_pk_bf16_f32 v20, v68, v69
    v_lshlrev_b32 v68, 16, v20
    v_and_b32 v69, 0xffff0000, v20
    v_mul_f32 v68, v68, v100
    v_mul_f32 v69, v69, v101
    v_cvt_pk_bf16_f32 v20, v68, v69
    v_lshlrev_b32 v68, 16, v20
    v_and_b32 v69, 0xffff0000, v20
    v_add_f32 v12, v12, v68
    v_add_f32 v13, v13, v69
    v_cvt_pk_bf16_f32 v6, v12, v13
    v_lshlrev_b32 v12, 16, v6
    v_and_b32 v13, 0xffff0000, v6
    v_cvt_pk_bf16_f32 v20, v70, v71
    v_lshlrev_b32 v70, 16, v20
    v_and_b32 v71, 0xffff0000, v20
    v_mul_f32 v70, v70, v102
    v_mul_f32 v71, v71, v103
    v_cvt_pk_bf16_f32 v20, v70, v71
    v_lshlrev_b32 v70, 16, v20
    v_and_b32 v71, 0xffff0000, v20
    v_add_f32 v14, v14, v70
    v_add_f32 v15, v15, v71
    v_cvt_pk_bf16_f32 v7, v14, v15
    v_lshlrev_b32 v14, 16, v7
    v_and_b32 v15, 0xffff0000, v7
    buffer_store_dwordx4 v[4:7], v1, s[32:35], 0 offen
    v_mbcnt_lo_u32_b32 v46, -1, 0
    v_mbcnt_hi_u32_b32 v46, -1, v46
    v_lshlrev_b32 v46, 5, v46
    s_mov_b32 s29, 6144
    s_mov_b32 s30, 8192
    buffer_load_dwordx4 v[28:31], v46, s[16:19], s29 offen
    buffer_load_dwordx4 v[32:35], v46, s[16:19], s29 offen offset:16
    buffer_load_dwordx4 v[36:39], v46, s[16:19], s30 offen
    buffer_load_dwordx4 v[40:43], v46, s[16:19], s30 offen offset:16
    v_add_f32 v24, v8, v9
    v_add_f32 v24, v24, v10
    v_add_f32 v24, v24, v11
    v_add_f32 v24, v24, v12
    v_add_f32 v24, v24, v13
    v_add_f32 v24, v24, v14
    v_add_f32 v24, v24, v15
    s_nop 1
    v_add_f32_dpp v26, v24, v24 quad_perm:[1,0,3,2] row_mask:0xf bank_mask:0xf
    v_mov_b32 v24, v26
    s_nop 1
    v_add_f32_dpp v26, v24, v24 quad_perm:[2,3,0,1] row_mask:0xf bank_mask:0xf
    v_mov_b32 v24, v26
    s_nop 1
    v_add_f32_dpp v26, v24, v24 row_half_mirror row_mask:0xf bank_mask:0xf
    v_mov_b32 v24, v26
    s_nop 1
    v_add_f32_dpp v26, v24, v24 row_mirror row_mask:0xf bank_mask:0xf
    v_mov_b32 v24, v26
    s_nop 1
    v_readlane_b32 s24, v24, 0
    v_readlane_b32 s25, v24, 16
    v_readlane_b32 s26, v24, 32
    v_readlane_b32 s27, v24, 48
    s_nop 1
    v_mov_b32 v24, s24
    v_add_f32 v24, s25, v24
    v_add_f32 v24, s26, v24
    v_add_f32 v24, s27, v24
    v_mul_f32 v24, 0x3b000000, v24
    v_mov_b32 v25, 0
    v_sub_f32 v26, v8, v24
    v_fmac_f32 v25, v26, v26
    v_sub_f32 v26, v9, v24
    v_fmac_f32 v25, v26, v26
    v_sub_f32 v26, v10, v24
    v_fmac_f32 v25, v26, v26
    v_sub_f32 v26, v11, v24
    v_fmac_f32 v25, v26, v26
    v_sub_f32 v26, v12, v24
    v_fmac_f32 v25, v26, v26
    v_sub_f32 v26, v13, v24
    v_fmac_f32 v25, v26, v26
    v_sub_f32 v26, v14, v24
    v_fmac_f32 v25, v26, v26
    v_sub_f32 v26, v15, v24
    v_fmac_f32 v25, v26, v26
    s_nop 1
    v_add_f32_dpp v26, v25, v25 quad_perm:[1,0,3,2] row_mask:0xf bank_mask:0xf
    v_mov_b32 v25, v26
    s_nop 1
    v_add_f32_dpp v26, v25, v25 quad_perm:[2,3,0,1] row_mask:0xf bank_mask:0xf
    v_mov_b32 v25, v26
    s_nop 1
    v_add_f32_dpp v26, v25, v25 row_half_mirror row_mask:0xf bank_mask:0xf
    v_mov_b32 v25, v26
    s_nop 1
    v_add_f32_dpp v26, v25, v25 row_mirror row_mask:0xf bank_mask:0xf
    v_mov_b32 v25, v26
    s_nop 1
    v_readlane_b32 s24, v25, 0
    v_readlane_b32 s25, v25, 16
    v_readlane_b32 s26, v25, 32
    v_readlane_b32 s27, v25, 48
    s_nop 1
    v_mov_b32 v25, s24
    v_add_f32 v25, s25, v25
    v_add_f32 v25, s26, v25
    v_add_f32 v25, s27, v25
    v_mul_f32 v25, 0x3b000000, v25
    v_cvt_pk_bf16_f32 v26, v24, v25
    v_lshlrev_b32 v24, 16, v26
    v_and_b32 v25, 0xffff0000, v26
    v_add_f32 v25, 0x3727c5ac, v25
    v_cvt_pk_bf16_f32 v26, v25, v25
    v_lshlrev_b32 v25, 16, v26
    v_and_b32 v25, 0xffff0000, v26
    v_sqrt_f32 v25, v25
    s_nop 0
    v_cvt_pk_bf16_f32 v26, v25, v25
    v_lshlrev_b32 v25, 16, v26
    v_and_b32 v25, 0xffff0000, v26
    v_rcp_f32 v27, v25
    s_nop 0
    s_waitcnt vmcnt(0)
    v_sub_f32 v8, v8, v24
    v_sub_f32 v9, v9, v24
    v_cvt_pk_bf16_f32 v26, v8, v9
    v_lshlrev_b32 v8, 16, v26
    v_and_b32 v9, 0xffff0000, v26
    v_mul_f32 v44, v8, v27
    v_fma_f32 v45, -v44, v25, v8
    v_fma_f32 v8, v45, v27, v44
    v_mul_f32 v44, v9, v27
    v_fma_f32 v45, -v44, v25, v9
    v_fma_f32 v9, v45, v27, v44
    v_cvt_pk_bf16_f32 v26, v8, v9
    v_lshlrev_b32 v8, 16, v26
    v_and_b32 v9, 0xffff0000, v26
    v_add_f32 v36, 1.0, v36
    v_add_f32 v37, 1.0, v37
    v_cvt_pk_bf16_f32 v26, v36, v37
    v_lshlrev_b32 v36, 16, v26
    v_and_b32 v37, 0xffff0000, v26
    v_mul_f32 v8, v8, v36
    v_mul_f32 v9, v9, v37
    v_cvt_pk_bf16_f32 v26, v8, v9
    v_lshlrev_b32 v8, 16, v26
    v_and_b32 v9, 0xffff0000, v26
    v_add_f32 v8, v8, v28
    v_add_f32 v9, v9, v29
    v_cvt_pk_bf16_f32 v16, v8, v9
    v_sub_f32 v10, v10, v24
    v_sub_f32 v11, v11, v24
    v_cvt_pk_bf16_f32 v26, v10, v11
    v_lshlrev_b32 v10, 16, v26
    v_and_b32 v11, 0xffff0000, v26
    v_mul_f32 v44, v10, v27
    v_fma_f32 v45, -v44, v25, v10
    v_fma_f32 v10, v45, v27, v44
    v_mul_f32 v44, v11, v27
    v_fma_f32 v45, -v44, v25, v11
    v_fma_f32 v11, v45, v27, v44
    v_cvt_pk_bf16_f32 v26, v10, v11
    v_lshlrev_b32 v10, 16, v26
    v_and_b32 v11, 0xffff0000, v26
    v_add_f32 v38, 1.0, v38
    v_add_f32 v39, 1.0, v39
    v_cvt_pk_bf16_f32 v26, v38, v39
    v_lshlrev_b32 v38, 16, v26
    v_and_b32 v39, 0xffff0000, v26
    v_mul_f32 v10, v10, v38
    v_mul_f32 v11, v11, v39
    v_cvt_pk_bf16_f32 v26, v10, v11
    v_lshlrev_b32 v10, 16, v26
    v_and_b32 v11, 0xffff0000, v26
    v_add_f32 v10, v10, v30
    v_add_f32 v11, v11, v31
    v_cvt_pk_bf16_f32 v17, v10, v11
    v_sub_f32 v12, v12, v24
    v_sub_f32 v13, v13, v24
    v_cvt_pk_bf16_f32 v26, v12, v13
    v_lshlrev_b32 v12, 16, v26
    v_and_b32 v13, 0xffff0000, v26
    v_mul_f32 v44, v12, v27
    v_fma_f32 v45, -v44, v25, v12
    v_fma_f32 v12, v45, v27, v44
    v_mul_f32 v44, v13, v27
    v_fma_f32 v45, -v44, v25, v13
    v_fma_f32 v13, v45, v27, v44
    v_cvt_pk_bf16_f32 v26, v12, v13
    v_lshlrev_b32 v12, 16, v26
    v_and_b32 v13, 0xffff0000, v26
    v_add_f32 v40, 1.0, v40
    v_add_f32 v41, 1.0, v41
    v_cvt_pk_bf16_f32 v26, v40, v41
    v_lshlrev_b32 v40, 16, v26
    v_and_b32 v41, 0xffff0000, v26
    v_mul_f32 v12, v12, v40
    v_mul_f32 v13, v13, v41
    v_cvt_pk_bf16_f32 v26, v12, v13
    v_lshlrev_b32 v12, 16, v26
    v_and_b32 v13, 0xffff0000, v26
    v_add_f32 v12, v12, v32
    v_add_f32 v13, v13, v33
    v_cvt_pk_bf16_f32 v18, v12, v13
    v_sub_f32 v14, v14, v24
    v_sub_f32 v15, v15, v24
    v_cvt_pk_bf16_f32 v26, v14, v15
    v_lshlrev_b32 v14, 16, v26
    v_and_b32 v15, 0xffff0000, v26
    v_mul_f32 v44, v14, v27
    v_fma_f32 v45, -v44, v25, v14
    v_fma_f32 v14, v45, v27, v44
    v_mul_f32 v44, v15, v27
    v_fma_f32 v45, -v44, v25, v15
    v_fma_f32 v15, v45, v27, v44
    v_cvt_pk_bf16_f32 v26, v14, v15
    v_lshlrev_b32 v14, 16, v26
    v_and_b32 v15, 0xffff0000, v26
    v_add_f32 v42, 1.0, v42
    v_add_f32 v43, 1.0, v43
    v_cvt_pk_bf16_f32 v26, v42, v43
    v_lshlrev_b32 v42, 16, v26
    v_and_b32 v43, 0xffff0000, v26
    v_mul_f32 v14, v14, v42
    v_mul_f32 v15, v15, v43
    v_cvt_pk_bf16_f32 v26, v14, v15
    v_lshlrev_b32 v14, 16, v26
    v_and_b32 v15, 0xffff0000, v26
    v_add_f32 v14, v14, v34
    v_add_f32 v15, v15, v35
    v_cvt_pk_bf16_f32 v19, v14, v15
    v_lshrrev_b32 v50, 6, v0
    s_lshl_b32 s41, s2, 2
    v_add_u32 v50, s41, v50
    v_lshrrev_b32 v2, 5, v50
    v_lshlrev_b32 v2, 15, v2
    v_and_b32 v50, 31, v50
    v_lshl_add_u32 v2, v50, 4, v2
    v_and_b32 v50, 63, v0
    v_lshrrev_b32 v51, 1, v50
    v_lshl_add_u32 v2, v51, 10, v2
    v_and_b32 v50, 1, v50
    v_lshl_add_u32 v2, v50, 9, v2
    buffer_store_dwordx4 v[16:19], v2, s[20:23], 0 offen
ln2_kernel_done:
    s_endpgm
.section .rodata,"a"
.p2align 6
.amdhsa_kernel ln2_kernel
  .amdhsa_next_free_vgpr 128
  .amdhsa_next_free_sgpr 102
  .amdhsa_accum_offset 128
  .amdhsa_group_segment_fixed_size 0
  .amdhsa_kernarg_size 112
  .amdhsa_user_sgpr_count 2
  .amdhsa_user_sgpr_kernarg_segment_ptr 1
  .amdhsa_system_sgpr_workgroup_id_x 1
  .amdhsa_float_denorm_mode_32 3
.end_amdhsa_kernel
.text
.globl gateup_kernel
.p2align 8
.type gateup_kernel,@function
gateup_kernel:
    s_cmp_ge_u32 s2, 352
    s_cbranch_scc1 gateup_kernel_done
    s_load_dwordx2 s[4:5], s[0:1], 104
    s_load_dwordx2 s[6:7], s[0:1], 48
    s_load_dwordx2 s[8:9], s[0:1], 56
    s_waitcnt lgkmcnt(0)
    s_add_u32 s12, s4, 54525952
    s_addc_u32 s13, s5, 0
    s_and_b32 s13, s13, 0xffff
    s_mov_b32 s14, 2097152
    s_mov_b32 s15, 0x20000
    s_mov_b32 s16, s6
    s_and_b32 s17, s7, 0xffff
    s_mov_b32 s18, 1409024
    s_mov_b32 s19, 0x20000
    s_mov_b32 s20, s8
    s_and_b32 s21, s9, 0xffff
    s_mov_b32 s22, 1409024
    s_mov_b32 s23, 0x20000
    s_add_u32 s24, s4, 58720256
    s_addc_u32 s25, s5, 0
    s_and_b32 s25, s25, 0xffff
    s_mov_b32 s26, 5636096
    s_mov_b32 s27, 0x20000
    s_mul_hi_u32 s53, s2, 0x0ba2e8bb
    s_mul_i32 s54, s53, 22
    s_sub_u32 s52, s2, s54
    s_mov_b32 s33, 2752
    s_lshl_b32 s30, s53, 17
    s_lshl_b32 s34, s52, 7
    s_mov_b32 s35, s34
    s_mov_b32 s60, 0x3d372713
    s_mov_b32 s61, 0x40135761
    v_lshrrev_b32 v1, 6, v0
    s_nop 0
    v_readfirstlane_b32 s40, v1
    v_and_b32 v2, 63, v0
    v_lshrrev_b32 v3, 3, v2
    v_and_b32 v4, 7, v2
    v_lshrrev_b32 v5, 4, v2
    s_lshl_b32 s42, s40, 3
    v_add_u32 v7, s42, v3
    v_and_b32 v6, 1, v5
    v_lshlrev_b32 v6, 2, v6
    v_xor_b32 v6, v4, v6
    v_lshlrev_b32 v6, 4, v6
    v_mul_lo_u32 v9, v7, s33
    v_add_u32 v9, v9, v6
    v_add_u32 v10, s34, v9
    v_add_u32 v11, s35, v9
    s_lshl_b32 s43, s40, 10
    v_and_b32 v3, 31, v2
    v_lshrrev_b32 v4, 5, v2
    s_mov_b32 s44, s40
    s_mov_b32 s45, 0
    s_mul_i32 s46, s44, 32
    s_mul_i32 s47, s44, 32768
    s_add_u32 s47, s47, s30
    v_lshlrev_b32 v8, 4, v2
    v_add_u32 v8, s47, v8
    v_lshrrev_b32 v5, 4, v2
    v_and_b32 v5, 1, v5
    v_lshrrev_b32 v6, 2, v2
    v_and_b32 v6, 3, v6
    v_and_b32 v7, 3, v2
    v_lshlrev_b32 v20, 3, v4
    v_add_u32 v20, v20, v6
    v_lshlrev_b32 v20, 7, v20
    v_lshl_add_u32 v20, v5, 5, v20
    v_lshl_add_u32 v20, v7, 3, v20
    v_lshrrev_b32 v21, 1, v6
    v_and_b32 v21, 1, v21
    v_xor_b32 v22, 0, v21
    v_lshl_add_u32 v24, v22, 6, v20
    v_add_u32 v26, 0x10000, v24
    v_xor_b32 v22, 1, v21
    v_lshl_add_u32 v25, v22, 6, v20
    v_add_u32 v27, 0x10000, v25
    v_mov_b32 v32, 0
    v_mov_b32 v33, 0
    v_mov_b32 v34, 0
    v_mov_b32 v35, 0
    v_mov_b32 v36, 0
    v_mov_b32 v37, 0
    v_mov_b32 v38, 0
    v_mov_b32 v39, 0
    v_mov_b32 v40, 0
    v_mov_b32 v41, 0
    v_mov_b32 v42, 0
    v_mov_b32 v43, 0
    v_mov_b32 v44, 0
    v_mov_b32 v45, 0
    v_mov_b32 v46, 0
    v_mov_b32 v47, 0
    v_mov_b32 v48, 0
    v_mov_b32 v49, 0
    v_mov_b32 v50, 0
    v_mov_b32 v51, 0
    v_mov_b32 v52, 0
    v_mov_b32 v53, 0
    v_mov_b32 v54, 0
    v_mov_b32 v55, 0
    v_mov_b32 v56, 0
    v_mov_b32 v57, 0
    v_mov_b32 v58, 0
    v_mov_b32 v59, 0
    v_mov_b32 v60, 0
    v_mov_b32 v61, 0
    v_mov_b32 v62, 0
    v_mov_b32 v63, 0
    v_mov_b32 v64, 0
    v_mov_b32 v65, 0
    v_mov_b32 v66, 0
    v_mov_b32 v67, 0
    v_mov_b32 v68, 0
    v_mov_b32 v69, 0
    v_mov_b32 v70, 0
    v_mov_b32 v71, 0
    v_mov_b32 v72, 0
    v_mov_b32 v73, 0
    v_mov_b32 v74, 0
    v_mov_b32 v75, 0
    v_mov_b32 v76, 0
    v_mov_b32 v77, 0
    v_mov_b32 v78, 0
    v_mov_b32 v79, 0
    v_mov_b32 v80, 0
    v_mov_b32 v81, 0
    v_mov_b32 v82, 0
    v_mov_b32 v83, 0
    v_mov_b32 v84, 0
    v_mov_b32 v85, 0
    v_mov_b32 v86, 0
    v_mov_b32 v87, 0
    v_mov_b32 v88, 0
    v_mov_b32 v89, 0
    v_mov_b32 v90, 0
    v_mov_b32 v91, 0
    v_mov_b32 v92, 0
    v_mov_b32 v93, 0
    v_mov_b32 v94, 0
    v_mov_b32 v95, 0
    s_add_u32 m0, s43, 0
    s_mul_i32 s50, s33, 0
    buffer_load_dwordx4 v10, s[16:19], s50 offen lds
    s_add_u32 m0, s43, 4096
    s_mul_i32 s50, s33, 32
    buffer_load_dwordx4 v10, s[16:19], s50 offen lds
    s_add_u32 m0, s43, 8192
    s_mul_i32 s50, s33, 0
    buffer_load_dwordx4 v11, s[20:23], s50 offen lds
    s_add_u32 m0, s43, 12288
    s_mul_i32 s50, s33, 32
    buffer_load_dwordx4 v11, s[20:23], s50 offen lds
    s_mov_b32 s50, 0
    buffer_load_dwordx4 v[128:131], v8, s[12:15], s50 offen offset:0
    buffer_load_dwordx4 v[132:135], v8, s[12:15], s50 offen offset:1024
    buffer_load_dwordx4 v[136:139], v8, s[12:15], s50 offen offset:2048
    buffer_load_dwordx4 v[140:143], v8, s[12:15], s50 offen offset:3072
    s_add_u32 m0, s43, 16384
    s_mul_i32 s50, s33, 64
    buffer_load_dwordx4 v10, s[16:19], s50 offen lds
    s_add_u32 m0, s43, 20480
    s_mul_i32 s50, s33, 96
    buffer_load_dwordx4 v10, s[16:19], s50 offen lds
    s_add_u32 m0, s43, 24576
    s_mul_i32 s50, s33, 64
    buffer_load_dwordx4 v11, s[20:23], s50 offen lds
    s_add_u32 m0, s43, 28672
    s_mul_i32 s50, s33, 96
    buffer_load_dwordx4 v11, s[20:23], s50 offen lds
    s_mov_b32 s50, 4096
    buffer_load_dwordx4 v[144:147], v8, s[12:15], s50 offen offset:0
    buffer_load_dwordx4 v[148:151], v8, s[12:15], s50 offen offset:1024
    buffer_load_dwordx4 v[152:155], v8, s[12:15], s50 offen offset:2048
    buffer_load_dwordx4 v[156:159], v8, s[12:15], s50 offen offset:3072
    s_waitcnt vmcnt(8)
    s_barrier
    ds_read_b64_tr_b16 v[96:97], v24 offset:0
    ds_read_b64_tr_b16 v[98:99], v24 offset:512
    ds_read_b64_tr_b16 v[100:101], v25 offset:0
    ds_read_b64_tr_b16 v[102:103], v25 offset:512
    ds_read_b64_tr_b16 v[104:105], v24 offset:8192
    ds_read_b64_tr_b16 v[106:107], v24 offset:8704
    ds_read_b64_tr_b16 v[108:109], v25 offset:8192
    ds_read_b64_tr_b16 v[110:111], v25 offset:8704
    s_add_u32 m0, s43, 32768
    s_mul_i32 s50, s33, 128
    buffer_load_dwordx4 v10, s[16:19], s50 offen lds
    s_add_u32 m0, s43, 36864
    s_mul_i32 s50, s33, 160
    buffer_load_dwordx4 v10, s[16:19], s50 offen lds
    s_add_u32 m0, s43, 40960
    s_mul_i32 s50, s33, 128
    buffer_load_dwordx4 v11, s[20:23], s50 offen lds
    s_add_u32 m0, s43, 45056
    s_mul_i32 s50, s33, 160
    buffer_load_dwordx4 v11, s[20:23], s50 offen lds
    s_mov_b32 s50, 8192
    buffer_load_dwordx4 v[160:163], v8, s[12:15], s50 offen offset:0
    buffer_load_dwordx4 v[164:167], v8, s[12:15], s50 offen offset:1024
    buffer_load_dwordx4 v[168:171], v8, s[12:15], s50 offen offset:2048
    buffer_load_dwordx4 v[172:175], v8, s[12:15], s50 offen offset:3072
    ds_read_b64_tr_b16 v[112:113], v24 offset:2048
    ds_read_b64_tr_b16 v[114:115], v24 offset:2560
    ds_read_b64_tr_b16 v[116:117], v25 offset:2048
    ds_read_b64_tr_b16 v[118:119], v25 offset:2560
    ds_read_b64_tr_b16 v[120:121], v24 offset:10240
    ds_read_b64_tr_b16 v[122:123], v24 offset:10752
    ds_read_b64_tr_b16 v[124:125], v25 offset:10240
    ds_read_b64_tr_b16 v[126:127], v25 offset:10752
    s_waitcnt lgkmcnt(8)
    v_mfma_f32_32x32x16_bf16 v[32:47], v[96:99], v[128:131], v[32:47]
    v_mfma_f32_32x32x16_bf16 v[48:63], v[100:103], v[128:131], v[48:63]
    v_mfma_f32_32x32x16_bf16 v[64:79], v[104:107], v[128:131], v[64:79]
    v_mfma_f32_32x32x16_bf16 v[80:95], v[108:111], v[128:131], v[80:95]
    ds_read_b64_tr_b16 v[96:97], v24 offset:4096
    ds_read_b64_tr_b16 v[98:99], v24 offset:4608
    ds_read_b64_tr_b16 v[100:101], v25 offset:4096
    ds_read_b64_tr_b16 v[102:103], v25 offset:4608
    ds_read_b64_tr_b16 v[104:105], v24 offset:12288
    ds_read_b64_tr_b16 v[106:107], v24 offset:12800
    ds_read_b64_tr_b16 v[108:109], v25 offset:12288
    ds_read_b64_tr_b16 v[110:111], v25 offset:12800
    s_waitcnt lgkmcnt(8)
    v_mfma_f32_32x32x16_bf16 v[32:47], v[112:115], v[132:135], v[32:47]
    v_mfma_f32_32x32x16_bf16 v[48:63], v[116:119], v[132:135], v[48:63]
    v_mfma_f32_32x32x16_bf16 v[64:79], v[120:123], v[132:135], v[64:79]
    v_mfma_f32_32x32x16_bf16 v[80:95], v[124:127], v[132:135], v[80:95]
    ds_read_b64_tr_b16 v[112:113], v24 offset:6144
    ds_read_b64_tr_b16 v[114:115], v24 offset:6656
    ds_read_b64_tr_b16 v[116:117], v25 offset:6144
    ds_read_b64_tr_b16 v[118:119], v25 offset:6656
    ds_read_b64_tr_b16 v[120:121], v24 offset:14336
    ds_read_b64_tr_b16 v[122:123], v24 offset:14848
    ds_read_b64_tr_b16 v[124:125], v25 offset:14336
    ds_read_b64_tr_b16 v[126:127], v25 offset:14848
    s_waitcnt lgkmcnt(8)
    v_mfma_f32_32x32x16_bf16 v[32:47], v[96:99], v[136:139], v[32:47]
    v_mfma_f32_32x32x16_bf16 v[48:63], v[100:103], v[136:139], v[48:63]
    v_mfma_f32_32x32x16_bf16 v[64:79], v[104:107], v[136:139], v[64:79]
    v_mfma_f32_32x32x16_bf16 v[80:95], v[108:111], v[136:139], v[80:95]
    s_waitcnt lgkmcnt(0)
    v_mfma_f32_32x32x16_bf16 v[32:47], v[112:115], v[140:143], v[32:47]
    v_mfma_f32_32x32x16_bf16 v[48:63], v[116:119], v[140:143], v[48:63]
    v_mfma_f32_32x32x16_bf16 v[64:79], v[120:123], v[140:143], v[64:79]
    v_mfma_f32_32x32x16_bf16 v[80:95], v[124:127], v[140:143], v[80:95]
    s_waitcnt vmcnt(8)
    s_barrier
    ds_read_b64_tr_b16 v[96:97], v24 offset:16384
    ds_read_b64_tr_b16 v[98:99], v24 offset:16896
    ds_read_b64_tr_b16 v[100:101], v25 offset:16384
    ds_read_b64_tr_b16 v[102:103], v25 offset:16896
    ds_read_b64_tr_b16 v[104:105], v24 offset:24576
    ds_read_b64_tr_b16 v[106:107], v24 offset:25088
    ds_read_b64_tr_b16 v[108:109], v25 offset:24576
    ds_read_b64_tr_b16 v[110:111], v25 offset:25088
    s_add_u32 m0, s43, 0
    s_mul_i32 s50, s33, 192
    buffer_load_dwordx4 v10, s[16:19], s50 offen lds
    s_add_u32 m0, s43, 4096
    s_mul_i32 s50, s33, 224
    buffer_load_dwordx4 v10, s[16:19], s50 offen lds
    s_add_u32 m0, s43, 8192
    s_mul_i32 s50, s33, 192
    buffer_load_dwordx4 v11, s[20:23], s50 offen lds
    s_add_u32 m0, s43, 12288
    s_mul_i32 s50, s33, 224
    buffer_load_dwordx4 v11, s[20:23], s50 offen lds
    s_mov_b32 s50, 12288
    buffer_load_dwordx4 v[128:131], v8, s[12:15], s50 offen offset:0
    buffer_load_dwordx4 v[132:135], v8, s[12:15], s50 offen offset:1024
    buffer_load_dwordx4 v[136:139], v8, s[12:15], s50 offen offset:2048
    buffer_load_dwordx4 v[140:143], v8, s[12:15], s50 offen offset:3072
    ds_read_b64_tr_b16 v[112:113], v24 offset:18432
    ds_read_b64_tr_b16 v[114:115], v24 offset:18944
    ds_read_b64_tr_b16 v[116:117], v25 offset:18432
    ds_read_b64_tr_b16 v[118:119], v25 offset:18944
    ds_read_b64_tr_b16 v[120:121], v24 offset:26624
    ds_read_b64_tr_b16 v[122:123], v24 offset:27136
    ds_read_b64_tr_b16 v[124:125], v25 offset:26624
    ds_read_b64_tr_b16 v[126:127], v25 offset:27136
    s_waitcnt lgkmcnt(8)
    v_mfma_f32_32x32x16_bf16 v[32:47], v[96:99], v[144:147], v[32:47]
    v_mfma_f32_32x32x16_bf16 v[48:63], v[100:103], v[144:147], v[48:63]
    v_mfma_f32_32x32x16_bf16 v[64:79], v[104:107], v[144:147], v[64:79]
    v_mfma_f32_32x32x16_bf16 v[80:95], v[108:111], v[144:147], v[80:95]
    ds_read_b64_tr_b16 v[96:97], v24 offset:20480
    ds_read_b64_tr_b16 v[98:99], v24 offset:20992
    ds_read_b64_tr_b16 v[100:101], v25 offset:20480
    ds_read_b64_tr_b16 v[102:103], v25 offset:20992
    ds_read_b64_tr_b16 v[104:105], v24 offset:28672
    ds_read_b64_tr_b16 v[106:107], v24 offset:29184
    ds_read_b64_tr_b16 v[108:109], v25 offset:28672
    ds_read_b64_tr_b16 v[110:111], v25 offset:29184
    s_waitcnt lgkmcnt(8)
    v_mfma_f32_32x32x16_bf16 v[32:47], v[112:115], v[148:151], v[32:47]
    v_mfma_f32_32x32x16_bf16 v[48:63], v[116:119], v[148:151], v[48:63]
    v_mfma_f32_32x32x16_bf16 v[64:79], v[120:123], v[148:151], v[64:79]
    v_mfma_f32_32x32x16_bf16 v[80:95], v[124:127], v[148:151], v[80:95]
    ds_read_b64_tr_b16 v[112:113], v24 offset:22528
    ds_read_b64_tr_b16 v[114:115], v24 offset:23040
    ds_read_b64_tr_b16 v[116:117], v25 offset:22528
    ds_read_b64_tr_b16 v[118:119], v25 offset:23040
    ds_read_b64_tr_b16 v[120:121], v24 offset:30720
    ds_read_b64_tr_b16 v[122:123], v24 offset:31232
    ds_read_b64_tr_b16 v[124:125], v25 offset:30720
    ds_read_b64_tr_b16 v[126:127], v25 offset:31232
    s_waitcnt lgkmcnt(8)
    v_mfma_f32_32x32x16_bf16 v[32:47], v[96:99], v[152:155], v[32:47]
    v_mfma_f32_32x32x16_bf16 v[48:63], v[100:103], v[152:155], v[48:63]
    v_mfma_f32_32x32x16_bf16 v[64:79], v[104:107], v[152:155], v[64:79]
    v_mfma_f32_32x32x16_bf16 v[80:95], v[108:111], v[152:155], v[80:95]
    s_waitcnt lgkmcnt(0)
    v_mfma_f32_32x32x16_bf16 v[32:47], v[112:115], v[156:159], v[32:47]
    v_mfma_f32_32x32x16_bf16 v[48:63], v[116:119], v[156:159], v[48:63]
    v_mfma_f32_32x32x16_bf16 v[64:79], v[120:123], v[156:159], v[64:79]
    v_mfma_f32_32x32x16_bf16 v[80:95], v[124:127], v[156:159], v[80:95]
    s_waitcnt vmcnt(8)
    s_barrier
    ds_read_b64_tr_b16 v[96:97], v24 offset:32768
    ds_read_b64_tr_b16 v[98:99], v24 offset:33280
    ds_read_b64_tr_b16 v[100:101], v25 offset:32768
    ds_read_b64_tr_b16 v[102:103], v25 offset:33280
    ds_read_b64_tr_b16 v[104:105], v24 offset:40960
    ds_read_b64_tr_b16 v[106:107], v24 offset:41472
    ds_read_b64_tr_b16 v[108:109], v25 offset:40960
    ds_read_b64_tr_b16 v[110:111], v25 offset:41472
    s_add_u32 m0, s43, 16384
    s_mul_i32 s50, s33, 256
    buffer_load_dwordx4 v10, s[16:19], s50 offen lds
    s_add_u32 m0, s43, 20480
    s_mul_i32 s50, s33, 288
    buffer_load_dwordx4 v10, s[16:19], s50 offen lds
    s_add_u32 m0, s43, 24576
    s_mul_i32 s50, s33, 256
    buffer_load_dwordx4 v11, s[20:23], s50 offen lds
    s_add_u32 m0, s43, 28672
    s_mul_i32 s50, s33, 288
    buffer_load_dwordx4 v11, s[20:23], s50 offen lds
    s_mov_b32 s50, 16384
    buffer_load_dwordx4 v[144:147], v8, s[12:15], s50 offen offset:0
    buffer_load_dwordx4 v[148:151], v8, s[12:15], s50 offen offset:1024
    buffer_load_dwordx4 v[152:155], v8, s[12:15], s50 offen offset:2048
    buffer_load_dwordx4 v[156:159], v8, s[12:15], s50 offen offset:3072
    ds_read_b64_tr_b16 v[112:113], v24 offset:34816
    ds_read_b64_tr_b16 v[114:115], v24 offset:35328
    ds_read_b64_tr_b16 v[116:117], v25 offset:34816
    ds_read_b64_tr_b16 v[118:119], v25 offset:35328
    ds_read_b64_tr_b16 v[120:121], v24 offset:43008
    ds_read_b64_tr_b16 v[122:123], v24 offset:43520
    ds_read_b64_tr_b16 v[124:125], v25 offset:43008
    ds_read_b64_tr_b16 v[126:127], v25 offset:43520
    s_waitcnt lgkmcnt(8)
    v_mfma_f32_32x32x16_bf16 v[32:47], v[96:99], v[160:163], v[32:47]
    v_mfma_f32_32x32x16_bf16 v[48:63], v[100:103], v[160:163], v[48:63]
    v_mfma_f32_32x32x16_bf16 v[64:79], v[104:107], v[160:163], v[64:79]
    v_mfma_f32_32x32x16_bf16 v[80:95], v[108:111], v[160:163], v[80:95]
    ds_read_b64_tr_b16 v[96:97], v24 offset:36864
    ds_read_b64_tr_b16 v[98:99], v24 offset:37376
    ds_read_b64_tr_b16 v[100:101], v25 offset:36864
    ds_read_b64_tr_b16 v[102:103], v25 offset:37376
    ds_read_b64_tr_b16 v[104:105], v24 offset:45056
    ds_read_b64_tr_b16 v[106:107], v24 offset:45568
    ds_read_b64_tr_b16 v[108:109], v25 offset:45056
    ds_read_b64_tr_b16 v[110:111], v25 offset:45568
    s_waitcnt lgkmcnt(8)
    v_mfma_f32_32x32x16_bf16 v[32:47], v[112:115], v[164:167], v[32:47]
    v_mfma_f32_32x32x16_bf16 v[48:63], v[116:119], v[164:167], v[48:63]
    v_mfma_f32_32x32x16_bf16 v[64:79], v[120:123], v[164:167], v[64:79]
    v_mfma_f32_32x32x16_bf16 v[80:95], v[124:127], v[164:167], v[80:95]
    ds_read_b64_tr_b16 v[112:113], v24 offset:38912
    ds_read_b64_tr_b16 v[114:115], v24 offset:39424
    ds_read_b64_tr_b16 v[116:117], v25 offset:38912
    ds_read_b64_tr_b16 v[118:119], v25 offset:39424
    ds_read_b64_tr_b16 v[120:121], v24 offset:47104
    ds_read_b64_tr_b16 v[122:123], v24 offset:47616
    ds_read_b64_tr_b16 v[124:125], v25 offset:47104
    ds_read_b64_tr_b16 v[126:127], v25 offset:47616
    s_waitcnt lgkmcnt(8)
    v_mfma_f32_32x32x16_bf16 v[32:47], v[96:99], v[168:171], v[32:47]
    v_mfma_f32_32x32x16_bf16 v[48:63], v[100:103], v[168:171], v[48:63]
    v_mfma_f32_32x32x16_bf16 v[64:79], v[104:107], v[168:171], v[64:79]
    v_mfma_f32_32x32x16_bf16 v[80:95], v[108:111], v[168:171], v[80:95]
    s_waitcnt lgkmcnt(0)
    v_mfma_f32_32x32x16_bf16 v[32:47], v[112:115], v[172:175], v[32:47]
    v_mfma_f32_32x32x16_bf16 v[48:63], v[116:119], v[172:175], v[48:63]
    v_mfma_f32_32x32x16_bf16 v[64:79], v[120:123], v[172:175], v[64:79]
    v_mfma_f32_32x32x16_bf16 v[80:95], v[124:127], v[172:175], v[80:95]
    s_waitcnt vmcnt(8)
    s_barrier
    ds_read_b64_tr_b16 v[96:97], v24 offset:0
    ds_read_b64_tr_b16 v[98:99], v24 offset:512
    ds_read_b64_tr_b16 v[100:101], v25 offset:0
    ds_read_b64_tr_b16 v[102:103], v25 offset:512
    ds_read_b64_tr_b16 v[104:105], v24 offset:8192
    ds_read_b64_tr_b16 v[106:107], v24 offset:8704
    ds_read_b64_tr_b16 v[108:109], v25 offset:8192
    ds_read_b64_tr_b16 v[110:111], v25 offset:8704
    s_add_u32 m0, s43, 32768
    s_mul_i32 s50, s33, 320
    buffer_load_dwordx4 v10, s[16:19], s50 offen lds
    s_add_u32 m0, s43, 36864
    s_mul_i32 s50, s33, 352
    buffer_load_dwordx4 v10, s[16:19], s50 offen lds
    s_add_u32 m0, s43, 40960
    s_mul_i32 s50, s33, 320
    buffer_load_dwordx4 v11, s[20:23], s50 offen lds
    s_add_u32 m0, s43, 45056
    s_mul_i32 s50, s33, 352
    buffer_load_dwordx4 v11, s[20:23], s50 offen lds
    s_mov_b32 s50, 20480
    buffer_load_dwordx4 v[160:163], v8, s[12:15], s50 offen offset:0
    buffer_load_dwordx4 v[164:167], v8, s[12:15], s50 offen offset:1024
    buffer_load_dwordx4 v[168:171], v8, s[12:15], s50 offen offset:2048
    buffer_load_dwordx4 v[172:175], v8, s[12:15], s50 offen offset:3072
    ds_read_b64_tr_b16 v[112:113], v24 offset:2048
    ds_read_b64_tr_b16 v[114:115], v24 offset:2560
    ds_read_b64_tr_b16 v[116:117], v25 offset:2048
    ds_read_b64_tr_b16 v[118:119], v25 offset:2560
    ds_read_b64_tr_b16 v[120:121], v24 offset:10240
    ds_read_b64_tr_b16 v[122:123], v24 offset:10752
    ds_read_b64_tr_b16 v[124:125], v25 offset:10240
    ds_read_b64_tr_b16 v[126:127], v25 offset:10752
    s_waitcnt lgkmcnt(8)
    v_mfma_f32_32x32x16_bf16 v[32:47], v[96:99], v[128:131], v[32:47]
    v_mfma_f32_32x32x16_bf16 v[48:63], v[100:103], v[128:131], v[48:63]
    v_mfma_f32_32x32x16_bf16 v[64:79], v[104:107], v[128:131], v[64:79]
    v_mfma_f32_32x32x16_bf16 v[80:95], v[108:111], v[128:131], v[80:95]
    ds_read_b64_tr_b16 v[96:97], v24 offset:4096
    ds_read_b64_tr_b16 v[98:99], v24 offset:4608
    ds_read_b64_tr_b16 v[100:101], v25 offset:4096
    ds_read_b64_tr_b16 v[102:103], v25 offset:4608
    ds_read_b64_tr_b16 v[104:105], v24 offset:12288
    ds_read_b64_tr_b16 v[106:107], v24 offset:12800
    ds_read_b64_tr_b16 v[108:109], v25 offset:12288
    ds_read_b64_tr_b16 v[110:111], v25 offset:12800
    s_waitcnt lgkmcnt(8)
    v_mfma_f32_32x32x16_bf16 v[32:47], v[112:115], v[132:135], v[32:47]
    v_mfma_f32_32x32x16_bf16 v[48:63], v[116:119], v[132:135], v[48:63]
    v_mfma_f32_32x32x16_bf16 v[64:79], v[120:123], v[132:135], v[64:79]
    v_mfma_f32_32x32x16_bf16 v[80:95], v[124:127], v[132:135], v[80:95]
    ds_read_b64_tr_b16 v[112:113], v24 offset:6144
    ds_read_b64_tr_b16 v[114:115], v24 offset:6656
    ds_read_b64_tr_b16 v[116:117], v25 offset:6144
    ds_read_b64_tr_b16 v[118:119], v25 offset:6656
    ds_read_b64_tr_b16 v[120:121], v24 offset:14336
    ds_read_b64_tr_b16 v[122:123], v24 offset:14848
    ds_read_b64_tr_b16 v[124:125], v25 offset:14336
    ds_read_b64_tr_b16 v[126:127], v25 offset:14848
    s_waitcnt lgkmcnt(8)
    v_mfma_f32_32x32x16_bf16 v[32:47], v[96:99], v[136:139], v[32:47]
    v_mfma_f32_32x32x16_bf16 v[48:63], v[100:103], v[136:139], v[48:63]
    v_mfma_f32_32x32x16_bf16 v[64:79], v[104:107], v[136:139], v[64:79]
    v_mfma_f32_32x32x16_bf16 v[80:95], v[108:111], v[136:139], v[80:95]
    s_waitcnt lgkmcnt(0)
    v_mfma_f32_32x32x16_bf16 v[32:47], v[112:115], v[140:143], v[32:47]
    v_mfma_f32_32x32x16_bf16 v[48:63], v[116:119], v[140:143], v[48:63]
    v_mfma_f32_32x32x16_bf16 v[64:79], v[120:123], v[140:143], v[64:79]
    v_mfma_f32_32x32x16_bf16 v[80:95], v[124:127], v[140:143], v[80:95]
    s_waitcnt vmcnt(8)
    s_barrier
    ds_read_b64_tr_b16 v[96:97], v24 offset:16384
    ds_read_b64_tr_b16 v[98:99], v24 offset:16896
    ds_read_b64_tr_b16 v[100:101], v25 offset:16384
    ds_read_b64_tr_b16 v[102:103], v25 offset:16896
    ds_read_b64_tr_b16 v[104:105], v24 offset:24576
    ds_read_b64_tr_b16 v[106:107], v24 offset:25088
    ds_read_b64_tr_b16 v[108:109], v25 offset:24576
    ds_read_b64_tr_b16 v[110:111], v25 offset:25088
    s_add_u32 m0, s43, 0
    s_mul_i32 s50, s33, 384
    buffer_load_dwordx4 v10, s[16:19], s50 offen lds
    s_add_u32 m0, s43, 4096
    s_mul_i32 s50, s33, 416
    buffer_load_dwordx4 v10, s[16:19], s50 offen lds
    s_add_u32 m0, s43, 8192
    s_mul_i32 s50, s33, 384
    buffer_load_dwordx4 v11, s[20:23], s50 offen lds
    s_add_u32 m0, s43, 12288
    s_mul_i32 s50, s33, 416
    buffer_load_dwordx4 v11, s[20:23], s50 offen lds
    s_mov_b32 s50, 24576
    buffer_load_dwordx4 v[128:131], v8, s[12:15], s50 offen offset:0
    buffer_load_dwordx4 v[132:135], v8, s[12:15], s50 offen offset:1024
    buffer_load_dwordx4 v[136:139], v8, s[12:15], s50 offen offset:2048
    buffer_load_dwordx4 v[140:143], v8, s[12:15], s50 offen offset:3072
    ds_read_b64_tr_b16 v[112:113], v24 offset:18432
    ds_read_b64_tr_b16 v[114:115], v24 offset:18944
    ds_read_b64_tr_b16 v[116:117], v25 offset:18432
    ds_read_b64_tr_b16 v[118:119], v25 offset:18944
    ds_read_b64_tr_b16 v[120:121], v24 offset:26624
    ds_read_b64_tr_b16 v[122:123], v24 offset:27136
    ds_read_b64_tr_b16 v[124:125], v25 offset:26624
    ds_read_b64_tr_b16 v[126:127], v25 offset:27136
    s_waitcnt lgkmcnt(8)
    v_mfma_f32_32x32x16_bf16 v[32:47], v[96:99], v[144:147], v[32:47]
    v_mfma_f32_32x32x16_bf16 v[48:63], v[100:103], v[144:147], v[48:63]
    v_mfma_f32_32x32x16_bf16 v[64:79], v[104:107], v[144:147], v[64:79]
    v_mfma_f32_32x32x16_bf16 v[80:95], v[108:111], v[144:147], v[80:95]
    ds_read_b64_tr_b16 v[96:97], v24 offset:20480
    ds_read_b64_tr_b16 v[98:99], v24 offset:20992
    ds_read_b64_tr_b16 v[100:101], v25 offset:20480
    ds_read_b64_tr_b16 v[102:103], v25 offset:20992
    ds_read_b64_tr_b16 v[104:105], v24 offset:28672
    ds_read_b64_tr_b16 v[106:107], v24 offset:29184
    ds_read_b64_tr_b16 v[108:109], v25 offset:28672
    ds_read_b64_tr_b16 v[110:111], v25 offset:29184
    s_waitcnt lgkmcnt(8)
    v_mfma_f32_32x32x16_bf16 v[32:47], v[112:115], v[148:151], v[32:47]
    v_mfma_f32_32x32x16_bf16 v[48:63], v[116:119], v[148:151], v[48:63]
    v_mfma_f32_32x32x16_bf16 v[64:79], v[120:123], v[148:151], v[64:79]
    v_mfma_f32_32x32x16_bf16 v[80:95], v[124:127], v[148:151], v[80:95]
    ds_read_b64_tr_b16 v[112:113], v24 offset:22528
    ds_read_b64_tr_b16 v[114:115], v24 offset:23040
    ds_read_b64_tr_b16 v[116:117], v25 offset:22528
    ds_read_b64_tr_b16 v[118:119], v25 offset:23040
    ds_read_b64_tr_b16 v[120:121], v24 offset:30720
    ds_read_b64_tr_b16 v[122:123], v24 offset:31232
    ds_read_b64_tr_b16 v[124:125], v25 offset:30720
    ds_read_b64_tr_b16 v[126:127], v25 offset:31232
    s_waitcnt lgkmcnt(8)
    v_mfma_f32_32x32x16_bf16 v[32:47], v[96:99], v[152:155], v[32:47]
    v_mfma_f32_32x32x16_bf16 v[48:63], v[100:103], v[152:155], v[48:63]
    v_mfma_f32_32x32x16_bf16 v[64:79], v[104:107], v[152:155], v[64:79]
    v_mfma_f32_32x32x16_bf16 v[80:95], v[108:111], v[152:155], v[80:95]
    s_waitcnt lgkmcnt(0)
    v_mfma_f32_32x32x16_bf16 v[32:47], v[112:115], v[156:159], v[32:47]
    v_mfma_f32_32x32x16_bf16 v[48:63], v[116:119], v[156:159], v[48:63]
    v_mfma_f32_32x32x16_bf16 v[64:79], v[120:123], v[156:159], v[64:79]
    v_mfma_f32_32x32x16_bf16 v[80:95], v[124:127], v[156:159], v[80:95]
    s_waitcnt vmcnt(8)
    s_barrier
    ds_read_b64_tr_b16 v[96:97], v24 offset:32768
    ds_read_b64_tr_b16 v[98:99], v24 offset:33280
    ds_read_b64_tr_b16 v[100:101], v25 offset:32768
    ds_read_b64_tr_b16 v[102:103], v25 offset:33280
    ds_read_b64_tr_b16 v[104:105], v24 offset:40960
    ds_read_b64_tr_b16 v[106:107], v24 offset:41472
    ds_read_b64_tr_b16 v[108:109], v25 offset:40960
    ds_read_b64_tr_b16 v[110:111], v25 offset:41472
    s_add_u32 m0, s43, 16384
    s_mul_i32 s50, s33, 448
    buffer_load_dwordx4 v10, s[16:19], s50 offen lds
    s_add_u32 m0, s43, 20480
    s_mul_i32 s50, s33, 480
    buffer_load_dwordx4 v10, s[16:19], s50 offen lds
    s_add_u32 m0, s43, 24576
    s_mul_i32 s50, s33, 448
    buffer_load_dwordx4 v11, s[20:23], s50 offen lds
    s_add_u32 m0, s43, 28672
    s_mul_i32 s50, s33, 480
    buffer_load_dwordx4 v11, s[20:23], s50 offen lds
    s_mov_b32 s50, 28672
    buffer_load_dwordx4 v[144:147], v8, s[12:15], s50 offen offset:0
    buffer_load_dwordx4 v[148:151], v8, s[12:15], s50 offen offset:1024
    buffer_load_dwordx4 v[152:155], v8, s[12:15], s50 offen offset:2048
    buffer_load_dwordx4 v[156:159], v8, s[12:15], s50 offen offset:3072
    ds_read_b64_tr_b16 v[112:113], v24 offset:34816
    ds_read_b64_tr_b16 v[114:115], v24 offset:35328
    ds_read_b64_tr_b16 v[116:117], v25 offset:34816
    ds_read_b64_tr_b16 v[118:119], v25 offset:35328
    ds_read_b64_tr_b16 v[120:121], v24 offset:43008
    ds_read_b64_tr_b16 v[122:123], v24 offset:43520
    ds_read_b64_tr_b16 v[124:125], v25 offset:43008
    ds_read_b64_tr_b16 v[126:127], v25 offset:43520
    s_waitcnt lgkmcnt(8)
    v_mfma_f32_32x32x16_bf16 v[32:47], v[96:99], v[160:163], v[32:47]
    v_mfma_f32_32x32x16_bf16 v[48:63], v[100:103], v[160:163], v[48:63]
    v_mfma_f32_32x32x16_bf16 v[64:79], v[104:107], v[160:163], v[64:79]
    v_mfma_f32_32x32x16_bf16 v[80:95], v[108:111], v[160:163], v[80:95]
    ds_read_b64_tr_b16 v[96:97], v24 offset:36864
    ds_read_b64_tr_b16 v[98:99], v24 offset:37376
    ds_read_b64_tr_b16 v[100:101], v25 offset:36864
    ds_read_b64_tr_b16 v[102:103], v25 offset:37376
    ds_read_b64_tr_b16 v[104:105], v24 offset:45056
    ds_read_b64_tr_b16 v[106:107], v24 offset:45568
    ds_read_b64_tr_b16 v[108:109], v25 offset:45056
    ds_read_b64_tr_b16 v[110:111], v25 offset:45568
    s_waitcnt lgkmcnt(8)
    v_mfma_f32_32x32x16_bf16 v[32:47], v[112:115], v[164:167], v[32:47]
    v_mfma_f32_32x32x16_bf16 v[48:63], v[116:119], v[164:167], v[48:63]
    v_mfma_f32_32x32x16_bf16 v[64:79], v[120:123], v[164:167], v[64:79]
    v_mfma_f32_32x32x16_bf16 v[80:95], v[124:127], v[164:167], v[80:95]
    ds_read_b64_tr_b16 v[112:113], v24 offset:38912
    ds_read_b64_tr_b16 v[114:115], v24 offset:39424
    ds_read_b64_tr_b16 v[116:117], v25 offset:38912
    ds_read_b64_tr_b16 v[118:119], v25 offset:39424
    ds_read_b64_tr_b16 v[120:121], v24 offset:47104
    ds_read_b64_tr_b16 v[122:123], v24 offset:47616
    ds_read_b64_tr_b16 v[124:125], v25 offset:47104
    ds_read_b64_tr_b16 v[126:127], v25 offset:47616
    s_waitcnt lgkmcnt(8)
    v_mfma_f32_32x32x16_bf16 v[32:47], v[96:99], v[168:171], v[32:47]
    v_mfma_f32_32x32x16_bf16 v[48:63], v[100:103], v[168:171], v[48:63]
    v_mfma_f32_32x32x16_bf16 v[64:79], v[104:107], v[168:171], v[64:79]
    v_mfma_f32_32x32x16_bf16 v[80:95], v[108:111], v[168:171], v[80:95]
    s_waitcnt lgkmcnt(0)
    v_mfma_f32_32x32x16_bf16 v[32:47], v[112:115], v[172:175], v[32:47]
    v_mfma_f32_32x32x16_bf16 v[48:63], v[116:119], v[172:175], v[48:63]
    v_mfma_f32_32x32x16_bf16 v[64:79], v[120:123], v[172:175], v[64:79]
    v_mfma_f32_32x32x16_bf16 v[80:95], v[124:127], v[172:175], v[80:95]
    s_waitcnt vmcnt(8)
    s_barrier
    ds_read_b64_tr_b16 v[96:97], v24 offset:0
    ds_read_b64_tr_b16 v[98:99], v24 offset:512
    ds_read_b64_tr_b16 v[100:101], v25 offset:0
    ds_read_b64_tr_b16 v[102:103], v25 offset:512
    ds_read_b64_tr_b16 v[104:105], v24 offset:8192
    ds_read_b64_tr_b16 v[106:107], v24 offset:8704
    ds_read_b64_tr_b16 v[108:109], v25 offset:8192
    ds_read_b64_tr_b16 v[110:111], v25 offset:8704
    ds_read_b64_tr_b16 v[112:113], v24 offset:2048
    ds_read_b64_tr_b16 v[114:115], v24 offset:2560
    ds_read_b64_tr_b16 v[116:117], v25 offset:2048
    ds_read_b64_tr_b16 v[118:119], v25 offset:2560
    ds_read_b64_tr_b16 v[120:121], v24 offset:10240
    ds_read_b64_tr_b16 v[122:123], v24 offset:10752
    ds_read_b64_tr_b16 v[124:125], v25 offset:10240
    ds_read_b64_tr_b16 v[126:127], v25 offset:10752
    s_waitcnt lgkmcnt(8)
    v_mfma_f32_32x32x16_bf16 v[32:47], v[96:99], v[128:131], v[32:47]
    v_mfma_f32_32x32x16_bf16 v[48:63], v[100:103], v[128:131], v[48:63]
    v_mfma_f32_32x32x16_bf16 v[64:79], v[104:107], v[128:131], v[64:79]
    v_mfma_f32_32x32x16_bf16 v[80:95], v[108:111], v[128:131], v[80:95]
    ds_read_b64_tr_b16 v[96:97], v24 offset:4096
    ds_read_b64_tr_b16 v[98:99], v24 offset:4608
    ds_read_b64_tr_b16 v[100:101], v25 offset:4096
    ds_read_b64_tr_b16 v[102:103], v25 offset:4608
    ds_read_b64_tr_b16 v[104:105], v24 offset:12288
    ds_read_b64_tr_b16 v[106:107], v24 offset:12800
    ds_read_b64_tr_b16 v[108:109], v25 offset:12288
    ds_read_b64_tr_b16 v[110:111], v25 offset:12800
    s_waitcnt lgkmcnt(8)
    v_mfma_f32_32x32x16_bf16 v[32:47], v[112:115], v[132:135], v[32:47]
    v_mfma_f32_32x32x16_bf16 v[48:63], v[116:119], v[132:135], v[48:63]
    v_mfma_f32_32x32x16_bf16 v[64:79], v[120:123], v[132:135], v[64:79]
    v_mfma_f32_32x32x16_bf16 v[80:95], v[124:127], v[132:135], v[80:95]
    ds_read_b64_tr_b16 v[112:113], v24 offset:6144
    ds_read_b64_tr_b16 v[114:115], v24 offset:6656
    ds_read_b64_tr_b16 v[116:117], v25 offset:6144
    ds_read_b64_tr_b16 v[118:119], v25 offset:6656
    ds_read_b64_tr_b16 v[120:121], v24 offset:14336
    ds_read_b64_tr_b16 v[122:123], v24 offset:14848
    ds_read_b64_tr_b16 v[124:125], v25 offset:14336
    ds_read_b64_tr_b16 v[126:127], v25 offset:14848
    s_waitcnt lgkmcnt(8)
    v_mfma_f32_32x32x16_bf16 v[32:47], v[96:99], v[136:139], v[32:47]
    v_mfma_f32_32x32x16_bf16 v[48:63], v[100:103], v[136:139], v[48:63]
    v_mfma_f32_32x32x16_bf16 v[64:79], v[104:107], v[136:139], v[64:79]
    v_mfma_f32_32x32x16_bf16 v[80:95], v[108:111], v[136:139], v[80:95]
    s_waitcnt lgkmcnt(0)
    v_mfma_f32_32x32x16_bf16 v[32:47], v[112:115], v[140:143], v[32:47]
    v_mfma_f32_32x32x16_bf16 v[48:63], v[116:119], v[140:143], v[48:63]
    v_mfma_f32_32x32x16_bf16 v[64:79], v[120:123], v[140:143], v[64:79]
    v_mfma_f32_32x32x16_bf16 v[80:95], v[124:127], v[140:143], v[80:95]
    s_waitcnt vmcnt(0)
    s_barrier
    ds_read_b64_tr_b16 v[96:97], v24 offset:16384
    ds_read_b64_tr_b16 v[98:99], v24 offset:16896
    ds_read_b64_tr_b16 v[100:101], v25 offset:16384
    ds_read_b64_tr_b16 v[102:103], v25 offset:16896
    ds_read_b64_tr_b16 v[104:105], v24 offset:24576
    ds_read_b64_tr_b16 v[106:107], v24 offset:25088
    ds_read_b64_tr_b16 v[108:109], v25 offset:24576
    ds_read_b64_tr_b16 v[110:111], v25 offset:25088
    ds_read_b64_tr_b16 v[112:113], v24 offset:18432
    ds_read_b64_tr_b16 v[114:115], v24 offset:18944
    ds_read_b64_tr_b16 v[116:117], v25 offset:18432
    ds_read_b64_tr_b16 v[118:119], v25 offset:18944
    ds_read_b64_tr_b16 v[120:121], v24 offset:26624
    ds_read_b64_tr_b16 v[122:123], v24 offset:27136
    ds_read_b64_tr_b16 v[124:125], v25 offset:26624
    ds_read_b64_tr_b16 v[126:127], v25 offset:27136
    s_waitcnt lgkmcnt(8)
    v_mfma_f32_32x32x16_bf16 v[32:47], v[96:99], v[144:147], v[32:47]
    v_mfma_f32_32x32x16_bf16 v[48:63], v[100:103], v[144:147], v[48:63]
    v_mfma_f32_32x32x16_bf16 v[64:79], v[104:107], v[144:147], v[64:79]
    v_mfma_f32_32x32x16_bf16 v[80:95], v[108:111], v[144:147], v[80:95]
    ds_read_b64_tr_b16 v[96:97], v24 offset:20480
    ds_read_b64_tr_b16 v[98:99], v24 offset:20992
    ds_read_b64_tr_b16 v[100:101], v25 offset:20480
    ds_read_b64_tr_b16 v[102:103], v25 offset:20992
    ds_read_b64_tr_b16 v[104:105], v24 offset:28672
    ds_read_b64_tr_b16 v[106:107], v24 offset:29184
    ds_read_b64_tr_b16 v[108:109], v25 offset:28672
    ds_read_b64_tr_b16 v[110:111], v25 offset:29184
    s_waitcnt lgkmcnt(8)
    v_mfma_f32_32x32x16_bf16 v[32:47], v[112:115], v[148:151], v[32:47]
    v_mfma_f32_32x32x16_bf16 v[48:63], v[116:119], v[148:151], v[48:63]
    v_mfma_f32_32x32x16_bf16 v[64:79], v[120:123], v[148:151], v[64:79]
    v_mfma_f32_32x32x16_bf16 v[80:95], v[124:127], v[148:151], v[80:95]
    ds_read_b64_tr_b16 v[112:113], v24 offset:22528
    ds_read_b64_tr_b16 v[114:115], v24 offset:23040
    ds_read_b64_tr_b16 v[116:117], v25 offset:22528
    ds_read_b64_tr_b16 v[118:119], v25 offset:23040
    ds_read_b64_tr_b16 v[120:121], v24 offset:30720
    ds_read_b64_tr_b16 v[122:123], v24 offset:31232
    ds_read_b64_tr_b16 v[124:125], v25 offset:30720
    ds_read_b64_tr_b16 v[126:127], v25 offset:31232
    s_waitcnt lgkmcnt(8)
    v_mfma_f32_32x32x16_bf16 v[32:47], v[96:99], v[152:155], v[32:47]
    v_mfma_f32_32x32x16_bf16 v[48:63], v[100:103], v[152:155], v[48:63]
    v_mfma_f32_32x32x16_bf16 v[64:79], v[104:107], v[152:155], v[64:79]
    v_mfma_f32_32x32x16_bf16 v[80:95], v[108:111], v[152:155], v[80:95]
    s_waitcnt lgkmcnt(0)
    v_mfma_f32_32x32x16_bf16 v[32:47], v[112:115], v[156:159], v[32:47]
    v_mfma_f32_32x32x16_bf16 v[48:63], v[116:119], v[156:159], v[48:63]
    v_mfma_f32_32x32x16_bf16 v[64:79], v[120:123], v[156:159], v[64:79]
    v_mfma_f32_32x32x16_bf16 v[80:95], v[124:127], v[156:159], v[80:95]
    s_nop 15
    s_nop 3
    s_lshl_b32 s55, s53, 2
    s_add_u32 s55, s55, s44
    s_mul_i32 s55, s55, 86
    s_lshl_b32 s54, s52, 2
    s_add_u32 s55, s55, s54
    s_lshl_b32 s55, s55, 10
    v_lshlrev_b32 v5, 4, v2
    v_add_u32 v5, s55, v5
    v_cvt_pk_bf16_f32 v96, v32, v33
    v_lshlrev_b32 v32, 16, v96
    v_and_b32 v33, 0xffff0000, v96
    v_cvt_pk_bf16_f32 v96, v64, v65
    v_lshlrev_b32 v64, 16, v96
    v_and_b32 v65, 0xffff0000, v96
    v_mul_f32 v97, v32, v32
    v_mul_f32 v97, v97, v32
    v_fma_f32 v97, v97, s60, v32
    v_mul_f32 v97, s61, v97
    v_exp_f32 v97, v97
    s_nop 0
    v_add_f32 v97, 1.0, v97
    v_rcp_f32 v97, v97
    s_nop 0
    v_fma_f32 v32, -v32, v97, v32
    v_mul_f32 v97, v33, v33
    v_mul_f32 v97, v97, v33
    v_fma_f32 v97, v97, s60, v33
    v_mul_f32 v97, s61, v97
    v_exp_f32 v97, v97
    s_nop 0
    v_add_f32 v97, 1.0, v97
    v_rcp_f32 v97, v97
    s_nop 0
    v_fma_f32 v33, -v33, v97, v33
    v_cvt_pk_bf16_f32 v96, v32, v33
    v_lshlrev_b32 v32, 16, v96
    v_and_b32 v33, 0xffff0000, v96
    v_mul_f32 v32, v32, v64
    v_mul_f32 v33, v33, v65
    v_cvt_pk_bf16_f32 v64, v32, v33
    v_cvt_pk_bf16_f32 v96, v34, v35
    v_lshlrev_b32 v34, 16, v96
    v_and_b32 v35, 0xffff0000, v96
    v_cvt_pk_bf16_f32 v96, v66, v67
    v_lshlrev_b32 v66, 16, v96
    v_and_b32 v67, 0xffff0000, v96
    v_mul_f32 v97, v34, v34
    v_mul_f32 v97, v97, v34
    v_fma_f32 v97, v97, s60, v34
    v_mul_f32 v97, s61, v97
    v_exp_f32 v97, v97
    s_nop 0
    v_add_f32 v97, 1.0, v97
    v_rcp_f32 v97, v97
    s_nop 0
    v_fma_f32 v34, -v34, v97, v34
    v_mul_f32 v97, v35, v35
    v_mul_f32 v97, v97, v35
    v_fma_f32 v97, v97, s60, v35
    v_mul_f32 v97, s61, v97
    v_exp_f32 v97, v97
    s_nop 0
    v_add_f32 v97, 1.0, v97
    v_rcp_f32 v97, v97
    s_nop 0
    v_fma_f32 v35, -v35, v97, v35
    v_cvt_pk_bf16_f32 v96, v34, v35
    v_lshlrev_b32 v34, 16, v96
    v_and_b32 v35, 0xffff0000, v96
    v_mul_f32 v34, v34, v66
    v_mul_f32 v35, v35, v67
    v_cvt_pk_bf16_f32 v65, v34, v35
    v_cvt_pk_bf16_f32 v96, v36, v37
    v_lshlrev_b32 v36, 16, v96
    v_and_b32 v37, 0xffff0000, v96
    v_cvt_pk_bf16_f32 v96, v68, v69
    v_lshlrev_b32 v68, 16, v96
    v_and_b32 v69, 0xffff0000, v96
    v_mul_f32 v97, v36, v36
    v_mul_f32 v97, v97, v36
    v_fma_f32 v97, v97, s60, v36
    v_mul_f32 v97, s61, v97
    v_exp_f32 v97, v97
    s_nop 0
    v_add_f32 v97, 1.0, v97
    v_rcp_f32 v97, v97
    s_nop 0
    v_fma_f32 v36, -v36, v97, v36
    v_mul_f32 v97, v37, v37
    v_mul_f32 v97, v97, v37
    v_fma_f32 v97, v97, s60, v37
    v_mul_f32 v97, s61, v97
    v_exp_f32 v97, v97
    s_nop 0
    v_add_f32 v97, 1.0, v97
    v_rcp_f32 v97, v97
    s_nop 0
    v_fma_f32 v37, -v37, v97, v37
    v_cvt_pk_bf16_f32 v96, v36, v37
    v_lshlrev_b32 v36, 16, v96
    v_and_b32 v37, 0xffff0000, v96
    v_mul_f32 v36, v36, v68
    v_mul_f32 v37, v37, v69
    v_cvt_pk_bf16_f32 v66, v36, v37
    v_cvt_pk_bf16_f32 v96, v38, v39
    v_lshlrev_b32 v38, 16, v96
    v_and_b32 v39, 0xffff0000, v96
    v_cvt_pk_bf16_f32 v96, v70, v71
    v_lshlrev_b32 v70, 16, v96
    v_and_b32 v71, 0xffff0000, v96
    v_mul_f32 v97, v38, v38
    v_mul_f32 v97, v97, v38
    v_fma_f32 v97, v97, s60, v38
    v_mul_f32 v97, s61, v97
    v_exp_f32 v97, v97
    s_nop 0
    v_add_f32 v97, 1.0, v97
    v_rcp_f32 v97, v97
    s_nop 0
    v_fma_f32 v38, -v38, v97, v38
    v_mul_f32 v97, v39, v39
    v_mul_f32 v97, v97, v39
    v_fma_f32 v97, v97, s60, v39
    v_mul_f32 v97, s61, v97
    v_exp_f32 v97, v97
    s_nop 0
    v_add_f32 v97, 1.0, v97
    v_rcp_f32 v97, v97
    s_nop 0
    v_fma_f32 v39, -v39, v97, v39
    v_cvt_pk_bf16_f32 v96, v38, v39
    v_lshlrev_b32 v38, 16, v96
    v_and_b32 v39, 0xffff0000, v96
    v_mul_f32 v38, v38, v70
    v_mul_f32 v39, v39, v71
    v_cvt_pk_bf16_f32 v67, v38, v39
    v_cvt_pk_bf16_f32 v96, v40, v41
    v_lshlrev_b32 v40, 16, v96
    v_and_b32 v41, 0xffff0000, v96
    v_cvt_pk_bf16_f32 v96, v72, v73
    v_lshlrev_b32 v72, 16, v96
    v_and_b32 v73, 0xffff0000, v96
    v_mul_f32 v97, v40, v40
    v_mul_f32 v97, v97, v40
    v_fma_f32 v97, v97, s60, v40
    v_mul_f32 v97, s61, v97
    v_exp_f32 v97, v97
    s_nop 0
    v_add_f32 v97, 1.0, v97
    v_rcp_f32 v97, v97
    s_nop 0
    v_fma_f32 v40, -v40, v97, v40
    v_mul_f32 v97, v41, v41
    v_mul_f32 v97, v97, v41
    v_fma_f32 v97, v97, s60, v41
    v_mul_f32 v97, s61, v97
    v_exp_f32 v97, v97
    s_nop 0
    v_add_f32 v97, 1.0, v97
    v_rcp_f32 v97, v97
    s_nop 0
    v_fma_f32 v41, -v41, v97, v41
    v_cvt_pk_bf16_f32 v96, v40, v41
    v_lshlrev_b32 v40, 16, v96
    v_and_b32 v41, 0xffff0000, v96
    v_mul_f32 v40, v40, v72
    v_mul_f32 v41, v41, v73
    v_cvt_pk_bf16_f32 v68, v40, v41
    v_cvt_pk_bf16_f32 v96, v42, v43
    v_lshlrev_b32 v42, 16, v96
    v_and_b32 v43, 0xffff0000, v96
    v_cvt_pk_bf16_f32 v96, v74, v75
    v_lshlrev_b32 v74, 16, v96
    v_and_b32 v75, 0xffff0000, v96
    v_mul_f32 v97, v42, v42
    v_mul_f32 v97, v97, v42
    v_fma_f32 v97, v97, s60, v42
    v_mul_f32 v97, s61, v97
    v_exp_f32 v97, v97
    s_nop 0
    v_add_f32 v97, 1.0, v97
    v_rcp_f32 v97, v97
    s_nop 0
    v_fma_f32 v42, -v42, v97, v42
    v_mul_f32 v97, v43, v43
    v_mul_f32 v97, v97, v43
    v_fma_f32 v97, v97, s60, v43
    v_mul_f32 v97, s61, v97
    v_exp_f32 v97, v97
    s_nop 0
    v_add_f32 v97, 1.0, v97
    v_rcp_f32 v97, v97
    s_nop 0
    v_fma_f32 v43, -v43, v97, v43
    v_cvt_pk_bf16_f32 v96, v42, v43
    v_lshlrev_b32 v42, 16, v96
    v_and_b32 v43, 0xffff0000, v96
    v_mul_f32 v42, v42, v74
    v_mul_f32 v43, v43, v75
    v_cvt_pk_bf16_f32 v69, v42, v43
    v_cvt_pk_bf16_f32 v96, v44, v45
    v_lshlrev_b32 v44, 16, v96
    v_and_b32 v45, 0xffff0000, v96
    v_cvt_pk_bf16_f32 v96, v76, v77
    v_lshlrev_b32 v76, 16, v96
    v_and_b32 v77, 0xffff0000, v96
    v_mul_f32 v97, v44, v44
    v_mul_f32 v97, v97, v44
    v_fma_f32 v97, v97, s60, v44
    v_mul_f32 v97, s61, v97
    v_exp_f32 v97, v97
    s_nop 0
    v_add_f32 v97, 1.0, v97
    v_rcp_f32 v97, v97
    s_nop 0
    v_fma_f32 v44, -v44, v97, v44
    v_mul_f32 v97, v45, v45
    v_mul_f32 v97, v97, v45
    v_fma_f32 v97, v97, s60, v45
    v_mul_f32 v97, s61, v97
    v_exp_f32 v97, v97
    s_nop 0
    v_add_f32 v97, 1.0, v97
    v_rcp_f32 v97, v97
    s_nop 0
    v_fma_f32 v45, -v45, v97, v45
    v_cvt_pk_bf16_f32 v96, v44, v45
    v_lshlrev_b32 v44, 16, v96
    v_and_b32 v45, 0xffff0000, v96
    v_mul_f32 v44, v44, v76
    v_mul_f32 v45, v45, v77
    v_cvt_pk_bf16_f32 v70, v44, v45
    v_cvt_pk_bf16_f32 v96, v46, v47
    v_lshlrev_b32 v46, 16, v96
    v_and_b32 v47, 0xffff0000, v96
    v_cvt_pk_bf16_f32 v96, v78, v79
    v_lshlrev_b32 v78, 16, v96
    v_and_b32 v79, 0xffff0000, v96
    v_mul_f32 v97, v46, v46
    v_mul_f32 v97, v97, v46
    v_fma_f32 v97, v97, s60, v46
    v_mul_f32 v97, s61, v97
    v_exp_f32 v97, v97
    s_nop 0
    v_add_f32 v97, 1.0, v97
    v_rcp_f32 v97, v97
    s_nop 0
    v_fma_f32 v46, -v46, v97, v46
    v_mul_f32 v97, v47, v47
    v_mul_f32 v97, v97, v47
    v_fma_f32 v97, v97, s60, v47
    v_mul_f32 v97, s61, v97
    v_exp_f32 v97, v97
    s_nop 0
    v_add_f32 v97, 1.0, v97
    v_rcp_f32 v97, v97
    s_nop 0
    v_fma_f32 v47, -v47, v97, v47
    v_cvt_pk_bf16_f32 v96, v46, v47
    v_lshlrev_b32 v46, 16, v96
    v_and_b32 v47, 0xffff0000, v96
    v_mul_f32 v46, v46, v78
    v_mul_f32 v47, v47, v79
    v_cvt_pk_bf16_f32 v71, v46, v47
    s_nop 1
    v_permlane32_swap_b32 v64, v66
    v_permlane32_swap_b32 v65, v67
    v_permlane32_swap_b32 v68, v70
    v_permlane32_swap_b32 v69, v71
    s_nop 1
    buffer_store_dwordx4 v[64:67], v5, s[24:27], 0 offen offset:0
    buffer_store_dwordx4 v[68:71], v5, s[24:27], 0 offen offset:1024
    s_cmp_ge_u32 s52, 21
    s_cbranch_scc1 gateup_kernel_done
    v_cvt_pk_bf16_f32 v96, v48, v49
    v_lshlrev_b32 v48, 16, v96
    v_and_b32 v49, 0xffff0000, v96
    v_cvt_pk_bf16_f32 v96, v80, v81
    v_lshlrev_b32 v80, 16, v96
    v_and_b32 v81, 0xffff0000, v96
    v_mul_f32 v97, v48, v48
    v_mul_f32 v97, v97, v48
    v_fma_f32 v97, v97, s60, v48
    v_mul_f32 v97, s61, v97
    v_exp_f32 v97, v97
    s_nop 0
    v_add_f32 v97, 1.0, v97
    v_rcp_f32 v97, v97
    s_nop 0
    v_fma_f32 v48, -v48, v97, v48
    v_mul_f32 v97, v49, v49
    v_mul_f32 v97, v97, v49
    v_fma_f32 v97, v97, s60, v49
    v_mul_f32 v97, s61, v97
    v_exp_f32 v97, v97
    s_nop 0
    v_add_f32 v97, 1.0, v97
    v_rcp_f32 v97, v97
    s_nop 0
    v_fma_f32 v49, -v49, v97, v49
    v_cvt_pk_bf16_f32 v96, v48, v49
    v_lshlrev_b32 v48, 16, v96
    v_and_b32 v49, 0xffff0000, v96
    v_mul_f32 v48, v48, v80
    v_mul_f32 v49, v49, v81
    v_cvt_pk_bf16_f32 v80, v48, v49
    v_cvt_pk_bf16_f32 v96, v50, v51
    v_lshlrev_b32 v50, 16, v96
    v_and_b32 v51, 0xffff0000, v96
    v_cvt_pk_bf16_f32 v96, v82, v83
    v_lshlrev_b32 v82, 16, v96
    v_and_b32 v83, 0xffff0000, v96
    v_mul_f32 v97, v50, v50
    v_mul_f32 v97, v97, v50
    v_fma_f32 v97, v97, s60, v50
    v_mul_f32 v97, s61, v97
    v_exp_f32 v97, v97
    s_nop 0
    v_add_f32 v97, 1.0, v97
    v_rcp_f32 v97, v97
    s_nop 0
    v_fma_f32 v50, -v50, v97, v50
    v_mul_f32 v97, v51, v51
    v_mul_f32 v97, v97, v51
    v_fma_f32 v97, v97, s60, v51
    v_mul_f32 v97, s61, v97
    v_exp_f32 v97, v97
    s_nop 0
    v_add_f32 v97, 1.0, v97
    v_rcp_f32 v97, v97
    s_nop 0
    v_fma_f32 v51, -v51, v97, v51
    v_cvt_pk_bf16_f32 v96, v50, v51
    v_lshlrev_b32 v50, 16, v96
    v_and_b32 v51, 0xffff0000, v96
    v_mul_f32 v50, v50, v82
    v_mul_f32 v51, v51, v83
    v_cvt_pk_bf16_f32 v81, v50, v51
    v_cvt_pk_bf16_f32 v96, v52, v53
    v_lshlrev_b32 v52, 16, v96
    v_and_b32 v53, 0xffff0000, v96
    v_cvt_pk_bf16_f32 v96, v84, v85
    v_lshlrev_b32 v84, 16, v96
    v_and_b32 v85, 0xffff0000, v96
    v_mul_f32 v97, v52, v52
    v_mul_f32 v97, v97, v52
    v_fma_f32 v97, v97, s60, v52
    v_mul_f32 v97, s61, v97
    v_exp_f32 v97, v97
    s_nop 0
    v_add_f32 v97, 1.0, v97
    v_rcp_f32 v97, v97
    s_nop 0
    v_fma_f32 v52, -v52, v97, v52
    v_mul_f32 v97, v53, v53
    v_mul_f32 v97, v97, v53
    v_fma_f32 v97, v97, s60, v53
    v_mul_f32 v97, s61, v97
    v_exp_f32 v97, v97
    s_nop 0
    v_add_f32 v97, 1.0, v97
    v_rcp_f32 v97, v97
    s_nop 0
    v_fma_f32 v53, -v53, v97, v53
    v_cvt_pk_bf16_f32 v96, v52, v53
    v_lshlrev_b32 v52, 16, v96
    v_and_b32 v53, 0xffff0000, v96
    v_mul_f32 v52, v52, v84
    v_mul_f32 v53, v53, v85
    v_cvt_pk_bf16_f32 v82, v52, v53
    v_cvt_pk_bf16_f32 v96, v54, v55
    v_lshlrev_b32 v54, 16, v96
    v_and_b32 v55, 0xffff0000, v96
    v_cvt_pk_bf16_f32 v96, v86, v87
    v_lshlrev_b32 v86, 16, v96
    v_and_b32 v87, 0xffff0000, v96
    v_mul_f32 v97, v54, v54
    v_mul_f32 v97, v97, v54
    v_fma_f32 v97, v97, s60, v54
    v_mul_f32 v97, s61, v97
    v_exp_f32 v97, v97
    s_nop 0
    v_add_f32 v97, 1.0, v97
    v_rcp_f32 v97, v97
    s_nop 0
    v_fma_f32 v54, -v54, v97, v54
    v_mul_f32 v97, v55, v55
    v_mul_f32 v97, v97, v55
    v_fma_f32 v97, v97, s60, v55
    v_mul_f32 v97, s61, v97
    v_exp_f32 v97, v97
    s_nop 0
    v_add_f32 v97, 1.0, v97
    v_rcp_f32 v97, v97
    s_nop 0
    v_fma_f32 v55, -v55, v97, v55
    v_cvt_pk_bf16_f32 v96, v54, v55
    v_lshlrev_b32 v54, 16, v96
    v_and_b32 v55, 0xffff0000, v96
    v_mul_f32 v54, v54, v86
    v_mul_f32 v55, v55, v87
    v_cvt_pk_bf16_f32 v83, v54, v55
    v_cvt_pk_bf16_f32 v96, v56, v57
    v_lshlrev_b32 v56, 16, v96
    v_and_b32 v57, 0xffff0000, v96
    v_cvt_pk_bf16_f32 v96, v88, v89
    v_lshlrev_b32 v88, 16, v96
    v_and_b32 v89, 0xffff0000, v96
    v_mul_f32 v97, v56, v56
    v_mul_f32 v97, v97, v56
    v_fma_f32 v97, v97, s60, v56
    v_mul_f32 v97, s61, v97
    v_exp_f32 v97, v97
    s_nop 0
    v_add_f32 v97, 1.0, v97
    v_rcp_f32 v97, v97
    s_nop 0
    v_fma_f32 v56, -v56, v97, v56
    v_mul_f32 v97, v57, v57
    v_mul_f32 v97, v97, v57
    v_fma_f32 v97, v97, s60, v57
    v_mul_f32 v97, s61, v97
    v_exp_f32 v97, v97
    s_nop 0
    v_add_f32 v97, 1.0, v97
    v_rcp_f32 v97, v97
    s_nop 0
    v_fma_f32 v57, -v57, v97, v57
    v_cvt_pk_bf16_f32 v96, v56, v57
    v_lshlrev_b32 v56, 16, v96
    v_and_b32 v57, 0xffff0000, v96
    v_mul_f32 v56, v56, v88
    v_mul_f32 v57, v57, v89
    v_cvt_pk_bf16_f32 v84, v56, v57
    v_cvt_pk_bf16_f32 v96, v58, v59
    v_lshlrev_b32 v58, 16, v96
    v_and_b32 v59, 0xffff0000, v96
    v_cvt_pk_bf16_f32 v96, v90, v91
    v_lshlrev_b32 v90, 16, v96
    v_and_b32 v91, 0xffff0000, v96
    v_mul_f32 v97, v58, v58
    v_mul_f32 v97, v97, v58
    v_fma_f32 v97, v97, s60, v58
    v_mul_f32 v97, s61, v97
    v_exp_f32 v97, v97
    s_nop 0
    v_add_f32 v97, 1.0, v97
    v_rcp_f32 v97, v97
    s_nop 0
    v_fma_f32 v58, -v58, v97, v58
    v_mul_f32 v97, v59, v59
    v_mul_f32 v97, v97, v59
    v_fma_f32 v97, v97, s60, v59
    v_mul_f32 v97, s61, v97
    v_exp_f32 v97, v97
    s_nop 0
    v_add_f32 v97, 1.0, v97
    v_rcp_f32 v97, v97
    s_nop 0
    v_fma_f32 v59, -v59, v97, v59
    v_cvt_pk_bf16_f32 v96, v58, v59
    v_lshlrev_b32 v58, 16, v96
    v_and_b32 v59, 0xffff0000, v96
    v_mul_f32 v58, v58, v90
    v_mul_f32 v59, v59, v91
    v_cvt_pk_bf16_f32 v85, v58, v59
    v_cvt_pk_bf16_f32 v96, v60, v61
    v_lshlrev_b32 v60, 16, v96
    v_and_b32 v61, 0xffff0000, v96
    v_cvt_pk_bf16_f32 v96, v92, v93
    v_lshlrev_b32 v92, 16, v96
    v_and_b32 v93, 0xffff0000, v96
    v_mul_f32 v97, v60, v60
    v_mul_f32 v97, v97, v60
    v_fma_f32 v97, v97, s60, v60
    v_mul_f32 v97, s61, v97
    v_exp_f32 v97, v97
    s_nop 0
    v_add_f32 v97, 1.0, v97
    v_rcp_f32 v97, v97
    s_nop 0
    v_fma_f32 v60, -v60, v97, v60
    v_mul_f32 v97, v61, v61
    v_mul_f32 v97, v97, v61
    v_fma_f32 v97, v97, s60, v61
    v_mul_f32 v97, s61, v97
    v_exp_f32 v97, v97
    s_nop 0
    v_add_f32 v97, 1.0, v97
    v_rcp_f32 v97, v97
    s_nop 0
    v_fma_f32 v61, -v61, v97, v61
    v_cvt_pk_bf16_f32 v96, v60, v61
    v_lshlrev_b32 v60, 16, v96
    v_and_b32 v61, 0xffff0000, v96
    v_mul_f32 v60, v60, v92
    v_mul_f32 v61, v61, v93
    v_cvt_pk_bf16_f32 v86, v60, v61
    v_cvt_pk_bf16_f32 v96, v62, v63
    v_lshlrev_b32 v62, 16, v96
    v_and_b32 v63, 0xffff0000, v96
    v_cvt_pk_bf16_f32 v96, v94, v95
    v_lshlrev_b32 v94, 16, v96
    v_and_b32 v95, 0xffff0000, v96
    v_mul_f32 v97, v62, v62
    v_mul_f32 v97, v97, v62
    v_fma_f32 v97, v97, s60, v62
    v_mul_f32 v97, s61, v97
    v_exp_f32 v97, v97
    s_nop 0
    v_add_f32 v97, 1.0, v97
    v_rcp_f32 v97, v97
    s_nop 0
    v_fma_f32 v62, -v62, v97, v62
    v_mul_f32 v97, v63, v63
    v_mul_f32 v97, v97, v63
    v_fma_f32 v97, v97, s60, v63
    v_mul_f32 v97, s61, v97
    v_exp_f32 v97, v97
    s_nop 0
    v_add_f32 v97, 1.0, v97
    v_rcp_f32 v97, v97
    s_nop 0
    v_fma_f32 v63, -v63, v97, v63
    v_cvt_pk_bf16_f32 v96, v62, v63
    v_lshlrev_b32 v62, 16, v96
    v_and_b32 v63, 0xffff0000, v96
    v_mul_f32 v62, v62, v94
    v_mul_f32 v63, v63, v95
    v_cvt_pk_bf16_f32 v87, v62, v63
    s_nop 1
    v_permlane32_swap_b32 v80, v82
    v_permlane32_swap_b32 v81, v83
    v_permlane32_swap_b32 v84, v86
    v_permlane32_swap_b32 v85, v87
    s_nop 1
    buffer_store_dwordx4 v[80:83], v5, s[24:27], 0 offen offset:2048
    buffer_store_dwordx4 v[84:87], v5, s[24:27], 0 offen offset:3072
gateup_kernel_done:
    s_endpgm
.section .rodata,"a"
.p2align 6
.amdhsa_kernel gateup_kernel
  .amdhsa_next_free_vgpr 176
  .amdhsa_next_free_sgpr 102
  .amdhsa_accum_offset 176
  .amdhsa_group_segment_fixed_size 0
  .amdhsa_kernarg_size 112
  .amdhsa_user_sgpr_count 2
  .amdhsa_user_sgpr_kernarg_segment_ptr 1
  .amdhsa_system_sgpr_workgroup_id_x 1
  .amdhsa_float_denorm_mode_32 3
.end_amdhsa_kernel
.text
.globl down_kernel
.p2align 8
.type down_kernel,@function
down_kernel:
    s_cmp_ge_u32 s2, 256
    s_cbranch_scc1 down_kernel_done
    s_load_dwordx2 s[4:5], s[0:1], 104
    s_load_dwordx2 s[6:7], s[0:1], 64
    s_load_dwordx2 s[8:9], s[0:1], 88
    s_waitcnt lgkmcnt(0)
    s_add_u32 s12, s4, 58720256
    s_addc_u32 s13, s5, 0
    s_and_b32 s13, s13, 0xffff
    s_mov_b32 s14, 5636096
    s_mov_b32 s15, 0x20000
    s_mov_b32 s16, s6
    s_and_b32 s17, s7, 0xffff
    s_mov_b32 s18, 1409024
    s_mov_b32 s19, 0x20000
    s_mov_b32 s24, s8
    s_and_b32 s25, s9, 0xffff
    s_mov_b32 s26, 2097152
    s_mov_b32 s27, 0x20000
    s_add_u32 s56, s4, 50331648
    s_addc_u32 s57, s5, 0
    s_and_b32 s57, s57, 0xffff
    s_mov_b32 s58, 2097152
    s_mov_b32 s59, 0x20000
    s_mov_b32 s60, s4
    s_and_b32 s61, s5, 0xffff
    s_mov_b32 s62, 12288
    s_mov_b32 s63, 0x20000
    s_and_b32 s52, s2, 7
    s_lshr_b32 s53, s2, 3
    s_mov_b32 s33, 1024
    s_mul_i32 s30, s53, 2*86*1024
    s_lshl_b32 s34, s52, 7
    v_lshrrev_b32 v1, 6, v0
    s_nop 0
    v_readfirstlane_b32 s40, v1
    v_and_b32 v2, 63, v0
    v_lshrrev_b32 v3, 3, v2
    v_and_b32 v4, 7, v2
    v_lshrrev_b32 v5, 4, v2
    s_lshl_b32 s42, s40, 3
    v_add_u32 v7, s42, v3
    v_and_b32 v6, 1, v5
    v_lshlrev_b32 v6, 2, v6
    v_xor_b32 v6, v4, v6
    v_lshlrev_b32 v6, 4, v6
    v_mul_lo_u32 v9, v7, s33
    v_add_u32 v9, v9, v6
    v_add_u32 v10, s34, v9
    s_lshl_b32 s43, s40, 10
    v_and_b32 v3, 31, v2
    v_lshrrev_b32 v4, 5, v2
    s_lshr_b32 s44, s40, 1
    s_and_b32 s45, s40, 1
    s_mul_i32 s46, s44, 32
    s_mul_i32 s47, s44, 88064
    s_add_u32 s47, s47, s30
    v_lshlrev_b32 v8, 4, v2
    v_add_u32 v8, s47, v8
    v_lshrrev_b32 v5, 4, v2
    v_and_b32 v5, 1, v5
    v_lshrrev_b32 v6, 2, v2
    v_and_b32 v6, 3, v6
    v_and_b32 v7, 3, v2
    v_lshlrev_b32 v20, 3, v4
    v_add_u32 v20, v20, v6
    v_lshlrev_b32 v20, 7, v20
    v_lshl_add_u32 v20, v5, 5, v20
    v_lshl_add_u32 v20, v7, 3, v20
    v_lshrrev_b32 v21, 1, v6
    v_and_b32 v21, 1, v21
    v_xor_b32 v22, 0, v21
    v_lshl_add_u32 v24, v22, 6, v20
    v_add_u32 v26, 0x10000, v24
    v_xor_b32 v22, 1, v21
    v_lshl_add_u32 v25, v22, 6, v20
    v_add_u32 v27, 0x10000, v25
    v_mov_b32 v32, 0
    v_mov_b32 v33, 0
    v_mov_b32 v34, 0
    v_mov_b32 v35, 0
    v_mov_b32 v36, 0
    v_mov_b32 v37, 0
    v_mov_b32 v38, 0
    v_mov_b32 v39, 0
    v_mov_b32 v40, 0
    v_mov_b32 v41, 0
    v_mov_b32 v42, 0
    v_mov_b32 v43, 0
    v_mov_b32 v44, 0
    v_mov_b32 v45, 0
    v_mov_b32 v46, 0
    v_mov_b32 v47, 0
    s_cmp_eq_u32 s45, 0
    s_cselect_b64 s[48:49], -1, 0
    v_cndmask_b32 v28, v25, v24, s[48:49]
    v_cndmask_b32 v29, v27, v26, s[48:49]
    s_add_u32 m0, s43, 0
    s_mul_i32 s50, s33, 0
    buffer_load_dwordx4 v10, s[16:19], s50 offen lds
    s_add_u32 m0, s43, 4096
    s_mul_i32 s50, s33, 32
    buffer_load_dwordx4 v10, s[16:19], s50 offen lds
    s_mov_b32 s50, 0
    buffer_load_dwordx4 v[56:59], v8, s[12:15], s50 offen offset:0
    buffer_load_dwordx4 v[60:63], v8, s[12:15], s50 offen offset:1024
    buffer_load_dwordx4 v[64:67], v8, s[12:15], s50 offen offset:2048
    buffer_load_dwordx4 v[68:71], v8, s[12:15], s50 offen offset:3072
    s_add_u32 m0, s43, 8192
    s_mul_i32 s50, s33, 64
    buffer_load_dwordx4 v10, s[16:19], s50 offen lds
    s_add_u32 m0, s43, 12288
    s_mul_i32 s50, s33, 96
    buffer_load_dwordx4 v10, s[16:19], s50 offen lds
    s_mov_b32 s50, 4096
    buffer_load_dwordx4 v[72:75], v8, s[12:15], s50 offen offset:0
    buffer_load_dwordx4 v[76:79], v8, s[12:15], s50 offen offset:1024
    buffer_load_dwordx4 v[80:83], v8, s[12:15], s50 offen offset:2048
    buffer_load_dwordx4 v[84:87], v8, s[12:15], s50 offen offset:3072
    s_add_u32 m0, s43, 16384
    s_mul_i32 s50, s33, 128
    buffer_load_dwordx4 v10, s[16:19], s50 offen lds
    s_add_u32 m0, s43, 20480
    s_mul_i32 s50, s33, 160
    buffer_load_dwordx4 v10, s[16:19], s50 offen lds
    s_mov_b32 s50, 8192
    buffer_load_dwordx4 v[88:91], v8, s[12:15], s50 offen offset:0
    buffer_load_dwordx4 v[92:95], v8, s[12:15], s50 offen offset:1024
    buffer_load_dwordx4 v[96:99], v8, s[12:15], s50 offen offset:2048
    buffer_load_dwordx4 v[100:103], v8, s[12:15], s50 offen offset:3072
    s_add_u32 m0, s43, 24576
    s_mul_i32 s50, s33, 192
    buffer_load_dwordx4 v10, s[16:19], s50 offen lds
    s_add_u32 m0, s43, 28672
    s_mul_i32 s50, s33, 224
    buffer_load_dwordx4 v10, s[16:19], s50 offen lds
    s_mov_b32 s50, 12288
    buffer_load_dwordx4 v[104:107], v8, s[12:15], s50 offen offset:0
    buffer_load_dwordx4 v[108:111], v8, s[12:15], s50 offen offset:1024
    buffer_load_dwordx4 v[112:115], v8, s[12:15], s50 offen offset:2048
    buffer_load_dwordx4 v[116:119], v8, s[12:15], s50 offen offset:3072
    s_waitcnt vmcnt(18)
    s_barrier
    ds_read_b64_tr_b16 v[48:49], v28 offset:0
    ds_read_b64_tr_b16 v[50:51], v28 offset:512
    s_add_u32 m0, s43, 32768
    s_mul_i32 s50, s33, 256
    buffer_load_dwordx4 v10, s[16:19], s50 offen lds
    s_add_u32 m0, s43, 36864
    s_mul_i32 s50, s33, 288
    buffer_load_dwordx4 v10, s[16:19], s50 offen lds
    s_mov_b32 s50, 16384
    buffer_load_dwordx4 v[120:123], v8, s[12:15], s50 offen offset:0
    buffer_load_dwordx4 v[124:127], v8, s[12:15], s50 offen offset:1024
    buffer_load_dwordx4 v[128:131], v8, s[12:15], s50 offen offset:2048
    buffer_load_dwordx4 v[132:135], v8, s[12:15], s50 offen offset:3072
    ds_read_b64_tr_b16 v[52:53], v28 offset:2048
    ds_read_b64_tr_b16 v[54:55], v28 offset:2560
    s_waitcnt lgkmcnt(2)
    v_mfma_f32_32x32x16_bf16 v[32:47], v[48:51], v[56:59], v[32:47]
    ds_read_b64_tr_b16 v[48:49], v28 offset:4096
    ds_read_b64_tr_b16 v[50:51], v28 offset:4608
    s_waitcnt lgkmcnt(2)
    v_mfma_f32_32x32x16_bf16 v[32:47], v[52:55], v[60:63], v[32:47]
    ds_read_b64_tr_b16 v[52:53], v28 offset:6144
    ds_read_b64_tr_b16 v[54:55], v28 offset:6656
    s_waitcnt lgkmcnt(2)
    v_mfma_f32_32x32x16_bf16 v[32:47], v[48:51], v[64:67], v[32:47]
    s_waitcnt lgkmcnt(0)
    v_mfma_f32_32x32x16_bf16 v[32:47], v[52:55], v[68:71], v[32:47]
    s_waitcnt vmcnt(18)
    s_barrier
    ds_read_b64_tr_b16 v[48:49], v28 offset:8192
    ds_read_b64_tr_b16 v[50:51], v28 offset:8704
    s_add_u32 m0, s43, 0
    s_mul_i32 s50, s33, 320
    buffer_load_dwordx4 v10, s[16:19], s50 offen lds
    s_add_u32 m0, s43, 4096
    s_mul_i32 s50, s33, 352
    buffer_load_dwordx4 v10, s[16:19], s50 offen lds
    s_mov_b32 s50, 20480
    buffer_load_dwordx4 v[56:59], v8, s[12:15], s50 offen offset:0
    buffer_load_dwordx4 v[60:63], v8, s[12:15], s50 offen offset:1024
    buffer_load_dwordx4 v[64:67], v8, s[12:15], s50 offen offset:2048
    buffer_load_dwordx4 v[68:71], v8, s[12:15], s50 offen offset:3072
    ds_read_b64_tr_b16 v[52:53], v28 offset:10240
    ds_read_b64_tr_b16 v[54:55], v28 offset:10752
    s_waitcnt lgkmcnt(2)
    v_mfma_f32_32x32x16_bf16 v[32:47], v[48:51], v[72:75], v[32:47]
    ds_read_b64_tr_b16 v[48:49], v28 offset:12288
    ds_read_b64_tr_b16 v[50:51], v28 offset:12800
    s_waitcnt lgkmcnt(2)
    v_mfma_f32_32x32x16_bf16 v[32:47], v[52:55], v[76:79], v[32:47]
    ds_read_b64_tr_b16 v[52:53], v28 offset:14336
    ds_read_b64_tr_b16 v[54:55], v28 offset:14848
    s_waitcnt lgkmcnt(2)
    v_mfma_f32_32x32x16_bf16 v[32:47], v[48:51], v[80:83], v[32:47]
    s_waitcnt lgkmcnt(0)
    v_mfma_f32_32x32x16_bf16 v[32:47], v[52:55], v[84:87], v[32:47]
    s_waitcnt vmcnt(18)
    s_barrier
    ds_read_b64_tr_b16 v[48:49], v28 offset:16384
    ds_read_b64_tr_b16 v[50:51], v28 offset:16896
    s_add_u32 m0, s43, 8192
    s_mul_i32 s50, s33, 384
    buffer_load_dwordx4 v10, s[16:19], s50 offen lds
    s_add_u32 m0, s43, 12288
    s_mul_i32 s50, s33, 416
    buffer_load_dwordx4 v10, s[16:19], s50 offen lds
    s_mov_b32 s50, 24576
    buffer_load_dwordx4 v[72:75], v8, s[12:15], s50 offen offset:0
    buffer_load_dwordx4 v[76:79], v8, s[12:15], s50 offen offset:1024
    buffer_load_dwordx4 v[80:83], v8, s[12:15], s50 offen offset:2048
    buffer_load_dwordx4 v[84:87], v8, s[12:15], s50 offen offset:3072
    ds_read_b64_tr_b16 v[52:53], v28 offset:18432
    ds_read_b64_tr_b16 v[54:55], v28 offset:18944
    s_waitcnt lgkmcnt(2)
    v_mfma_f32_32x32x16_bf16 v[32:47], v[48:51], v[88:91], v[32:47]
    ds_read_b64_tr_b16 v[48:49], v28 offset:20480
    ds_read_b64_tr_b16 v[50:51], v28 offset:20992
    s_waitcnt lgkmcnt(2)
    v_mfma_f32_32x32x16_bf16 v[32:47], v[52:55], v[92:95], v[32:47]
    ds_read_b64_tr_b16 v[52:53], v28 offset:22528
    ds_read_b64_tr_b16 v[54:55], v28 offset:23040
    s_waitcnt lgkmcnt(2)
    v_mfma_f32_32x32x16_bf16 v[32:47], v[48:51], v[96:99], v[32:47]
    s_waitcnt lgkmcnt(0)
    v_mfma_f32_32x32x16_bf16 v[32:47], v[52:55], v[100:103], v[32:47]
    s_waitcnt vmcnt(18)
    s_barrier
    ds_read_b64_tr_b16 v[48:49], v28 offset:24576
    ds_read_b64_tr_b16 v[50:51], v28 offset:25088
    s_add_u32 m0, s43, 16384
    s_mul_i32 s50, s33, 448
    buffer_load_dwordx4 v10, s[16:19], s50 offen lds
    s_add_u32 m0, s43, 20480
    s_mul_i32 s50, s33, 480
    buffer_load_dwordx4 v10, s[16:19], s50 offen lds
    s_mov_b32 s50, 28672
    buffer_load_dwordx4 v[88:91], v8, s[12:15], s50 offen offset:0
    buffer_load_dwordx4 v[92:95], v8, s[12:15], s50 offen offset:1024
    buffer_load_dwordx4 v[96:99], v8, s[12:15], s50 offen offset:2048
    buffer_load_dwordx4 v[100:103], v8, s[12:15], s50 offen offset:3072
    ds_read_b64_tr_b16 v[52:53], v28 offset:26624
    ds_read_b64_tr_b16 v[54:55], v28 offset:27136
    s_waitcnt lgkmcnt(2)
    v_mfma_f32_32x32x16_bf16 v[32:47], v[48:51], v[104:107], v[32:47]
    ds_read_b64_tr_b16 v[48:49], v28 offset:28672
    ds_read_b64_tr_b16 v[50:51], v28 offset:29184
    s_waitcnt lgkmcnt(2)
    v_mfma_f32_32x32x16_bf16 v[32:47], v[52:55], v[108:111], v[32:47]
    ds_read_b64_tr_b16 v[52:53], v28 offset:30720
    ds_read_b64_tr_b16 v[54:55], v28 offset:31232
    s_waitcnt lgkmcnt(2)
    v_mfma_f32_32x32x16_bf16 v[32:47], v[48:51], v[112:115], v[32:47]
    s_waitcnt lgkmcnt(0)
    v_mfma_f32_32x32x16_bf16 v[32:47], v[52:55], v[116:119], v[32:47]
    s_waitcnt vmcnt(18)
    s_barrier
    ds_read_b64_tr_b16 v[48:49], v28 offset:32768
    ds_read_b64_tr_b16 v[50:51], v28 offset:33280
    s_add_u32 m0, s43, 24576
    s_mul_i32 s50, s33, 512
    buffer_load_dwordx4 v10, s[16:19], s50 offen lds
    s_add_u32 m0, s43, 28672
    s_mul_i32 s50, s33, 544
    buffer_load_dwordx4 v10, s[16:19], s50 offen lds
    s_mov_b32 s50, 32768
    buffer_load_dwordx4 v[104:107], v8, s[12:15], s50 offen offset:0
    buffer_load_dwordx4 v[108:111], v8, s[12:15], s50 offen offset:1024
    buffer_load_dwordx4 v[112:115], v8, s[12:15], s50 offen offset:2048
    buffer_load_dwordx4 v[116:119], v8, s[12:15], s50 offen offset:3072
    ds_read_b64_tr_b16 v[52:53], v28 offset:34816
    ds_read_b64_tr_b16 v[54:55], v28 offset:35328
    s_waitcnt lgkmcnt(2)
    v_mfma_f32_32x32x16_bf16 v[32:47], v[48:51], v[120:123], v[32:47]
    ds_read_b64_tr_b16 v[48:49], v28 offset:36864
    ds_read_b64_tr_b16 v[50:51], v28 offset:37376
    s_waitcnt lgkmcnt(2)
    v_mfma_f32_32x32x16_bf16 v[32:47], v[52:55], v[124:127], v[32:47]
    ds_read_b64_tr_b16 v[52:53], v28 offset:38912
    ds_read_b64_tr_b16 v[54:55], v28 offset:39424
    s_waitcnt lgkmcnt(2)
    v_mfma_f32_32x32x16_bf16 v[32:47], v[48:51], v[128:131], v[32:47]
    s_waitcnt lgkmcnt(0)
    v_mfma_f32_32x32x16_bf16 v[32:47], v[52:55], v[132:135], v[32:47]
    s_waitcnt vmcnt(18)
    s_barrier
    ds_read_b64_tr_b16 v[48:49], v28 offset:0
    ds_read_b64_tr_b16 v[50:51], v28 offset:512
    s_add_u32 m0, s43, 32768
    s_mul_i32 s50, s33, 576
    buffer_load_dwordx4 v10, s[16:19], s50 offen lds
    s_add_u32 m0, s43, 36864
    s_mul_i32 s50, s33, 608
    buffer_load_dwordx4 v10, s[16:19], s50 offen lds
    s_mov_b32 s50, 36864
    buffer_load_dwordx4 v[120:123], v8, s[12:15], s50 offen offset:0
    buffer_load_dwordx4 v[124:127], v8, s[12:15], s50 offen offset:1024
    buffer_load_dwordx4 v[128:131], v8, s[12:15], s50 offen offset:2048
    buffer_load_dwordx4 v[132:135], v8, s[12:15], s50 offen offset:3072
    ds_read_b64_tr_b16 v[52:53], v28 offset:2048
    ds_read_b64_tr_b16 v[54:55], v28 offset:2560
    s_waitcnt lgkmcnt(2)
    v_mfma_f32_32x32x16_bf16 v[32:47], v[48:51], v[56:59], v[32:47]
    ds_read_b64_tr_b16 v[48:49], v28 offset:4096
    ds_read_b64_tr_b16 v[50:51], v28 offset:4608
    s_waitcnt lgkmcnt(2)
    v_mfma_f32_32x32x16_bf16 v[32:47], v[52:55], v[60:63], v[32:47]
    ds_read_b64_tr_b16 v[52:53], v28 offset:6144
    ds_read_b64_tr_b16 v[54:55], v28 offset:6656
    s_waitcnt lgkmcnt(2)
    v_mfma_f32_32x32x16_bf16 v[32:47], v[48:51], v[64:67], v[32:47]
    s_waitcnt lgkmcnt(0)
    v_mfma_f32_32x32x16_bf16 v[32:47], v[52:55], v[68:71], v[32:47]
    s_waitcnt vmcnt(18)
    s_barrier
    ds_read_b64_tr_b16 v[48:49], v28 offset:8192
    ds_read_b64_tr_b16 v[50:51], v28 offset:8704
    s_add_u32 m0, s43, 0
    s_mul_i32 s50, s33, 640
    buffer_load_dwordx4 v10, s[16:19], s50 offen lds
    s_add_u32 m0, s43, 4096
    s_mul_i32 s50, s33, 672
    buffer_load_dwordx4 v10, s[16:19], s50 offen lds
    s_mov_b32 s50, 40960
    buffer_load_dwordx4 v[56:59], v8, s[12:15], s50 offen offset:0
    buffer_load_dwordx4 v[60:63], v8, s[12:15], s50 offen offset:1024
    buffer_load_dwordx4 v[64:67], v8, s[12:15], s50 offen offset:2048
    buffer_load_dwordx4 v[68:71], v8, s[12:15], s50 offen offset:3072
    ds_read_b64_tr_b16 v[52:53], v28 offset:10240
    ds_read_b64_tr_b16 v[54:55], v28 offset:10752
    s_waitcnt lgkmcnt(2)
    v_mfma_f32_32x32x16_bf16 v[32:47], v[48:51], v[72:75], v[32:47]
    ds_read_b64_tr_b16 v[48:49], v28 offset:12288
    ds_read_b64_tr_b16 v[50:51], v28 offset:12800
    s_waitcnt lgkmcnt(2)
    v_mfma_f32_32x32x16_bf16 v[32:47], v[52:55], v[76:79], v[32:47]
    ds_read_b64_tr_b16 v[52:53], v28 offset:14336
    ds_read_b64_tr_b16 v[54:55], v28 offset:14848
    s_waitcnt lgkmcnt(2)
    v_mfma_f32_32x32x16_bf16 v[32:47], v[48:51], v[80:83], v[32:47]
    s_waitcnt lgkmcnt(0)
    v_mfma_f32_32x32x16_bf16 v[32:47], v[52:55], v[84:87], v[32:47]
    s_waitcnt vmcnt(18)
    s_barrier
    ds_read_b64_tr_b16 v[48:49], v28 offset:16384
    ds_read_b64_tr_b16 v[50:51], v28 offset:16896
    s_add_u32 m0, s43, 8192
    s_mul_i32 s50, s33, 704
    buffer_load_dwordx4 v10, s[16:19], s50 offen lds
    s_add_u32 m0, s43, 12288
    s_mul_i32 s50, s33, 736
    buffer_load_dwordx4 v10, s[16:19], s50 offen lds
    s_mov_b32 s50, 45056
    buffer_load_dwordx4 v[72:75], v8, s[12:15], s50 offen offset:0
    buffer_load_dwordx4 v[76:79], v8, s[12:15], s50 offen offset:1024
    buffer_load_dwordx4 v[80:83], v8, s[12:15], s50 offen offset:2048
    buffer_load_dwordx4 v[84:87], v8, s[12:15], s50 offen offset:3072
    ds_read_b64_tr_b16 v[52:53], v28 offset:18432
    ds_read_b64_tr_b16 v[54:55], v28 offset:18944
    s_waitcnt lgkmcnt(2)
    v_mfma_f32_32x32x16_bf16 v[32:47], v[48:51], v[88:91], v[32:47]
    ds_read_b64_tr_b16 v[48:49], v28 offset:20480
    ds_read_b64_tr_b16 v[50:51], v28 offset:20992
    s_waitcnt lgkmcnt(2)
    v_mfma_f32_32x32x16_bf16 v[32:47], v[52:55], v[92:95], v[32:47]
    ds_read_b64_tr_b16 v[52:53], v28 offset:22528
    ds_read_b64_tr_b16 v[54:55], v28 offset:23040
    s_waitcnt lgkmcnt(2)
    v_mfma_f32_32x32x16_bf16 v[32:47], v[48:51], v[96:99], v[32:47]
    s_waitcnt lgkmcnt(0)
    v_mfma_f32_32x32x16_bf16 v[32:47], v[52:55], v[100:103], v[32:47]
    s_waitcnt vmcnt(18)
    s_barrier
    ds_read_b64_tr_b16 v[48:49], v28 offset:24576
    ds_read_b64_tr_b16 v[50:51], v28 offset:25088
    s_add_u32 m0, s43, 16384
    s_mul_i32 s50, s33, 768
    buffer_load_dwordx4 v10, s[16:19], s50 offen lds
    s_add_u32 m0, s43, 20480
    s_mul_i32 s50, s33, 800
    buffer_load_dwordx4 v10, s[16:19], s50 offen lds
    s_mov_b32 s50, 49152
    buffer_load_dwordx4 v[88:91], v8, s[12:15], s50 offen offset:0
    buffer_load_dwordx4 v[92:95], v8, s[12:15], s50 offen offset:1024
    buffer_load_dwordx4 v[96:99], v8, s[12:15], s50 offen offset:2048
    buffer_load_dwordx4 v[100:103], v8, s[12:15], s50 offen offset:3072
    ds_read_b64_tr_b16 v[52:53], v28 offset:26624
    ds_read_b64_tr_b16 v[54:55], v28 offset:27136
    s_waitcnt lgkmcnt(2)
    v_mfma_f32_32x32x16_bf16 v[32:47], v[48:51], v[104:107], v[32:47]
    ds_read_b64_tr_b16 v[48:49], v28 offset:28672
    ds_read_b64_tr_b16 v[50:51], v28 offset:29184
    s_waitcnt lgkmcnt(2)
    v_mfma_f32_32x32x16_bf16 v[32:47], v[52:55], v[108:111], v[32:47]
    ds_read_b64_tr_b16 v[52:53], v28 offset:30720
    ds_read_b64_tr_b16 v[54:55], v28 offset:31232
    s_waitcnt lgkmcnt(2)
    v_mfma_f32_32x32x16_bf16 v[32:47], v[48:51], v[112:115], v[32:47]
    s_waitcnt lgkmcnt(0)
    v_mfma_f32_32x32x16_bf16 v[32:47], v[52:55], v[116:119], v[32:47]
    s_waitcnt vmcnt(18)
    s_barrier
    ds_read_b64_tr_b16 v[48:49], v28 offset:32768
    ds_read_b64_tr_b16 v[50:51], v28 offset:33280
    s_add_u32 m0, s43, 24576
    s_mul_i32 s50, s33, 832
    buffer_load_dwordx4 v10, s[16:19], s50 offen lds
    s_add_u32 m0, s43, 28672
    s_mul_i32 s50, s33, 864
    buffer_load_dwordx4 v10, s[16:19], s50 offen lds
    s_mov_b32 s50, 53248
    buffer_load_dwordx4 v[104:107], v8, s[12:15], s50 offen offset:0
    buffer_load_dwordx4 v[108:111], v8, s[12:15], s50 offen offset:1024
    buffer_load_dwordx4 v[112:115], v8, s[12:15], s50 offen offset:2048
    buffer_load_dwordx4 v[116:119], v8, s[12:15], s50 offen offset:3072
    ds_read_b64_tr_b16 v[52:53], v28 offset:34816
    ds_read_b64_tr_b16 v[54:55], v28 offset:35328
    s_waitcnt lgkmcnt(2)
    v_mfma_f32_32x32x16_bf16 v[32:47], v[48:51], v[120:123], v[32:47]
    ds_read_b64_tr_b16 v[48:49], v28 offset:36864
    ds_read_b64_tr_b16 v[50:51], v28 offset:37376
    s_waitcnt lgkmcnt(2)
    v_mfma_f32_32x32x16_bf16 v[32:47], v[52:55], v[124:127], v[32:47]
    ds_read_b64_tr_b16 v[52:53], v28 offset:38912
    ds_read_b64_tr_b16 v[54:55], v28 offset:39424
    s_waitcnt lgkmcnt(2)
    v_mfma_f32_32x32x16_bf16 v[32:47], v[48:51], v[128:131], v[32:47]
    s_waitcnt lgkmcnt(0)
    v_mfma_f32_32x32x16_bf16 v[32:47], v[52:55], v[132:135], v[32:47]
    s_waitcnt vmcnt(18)
    s_barrier
    ds_read_b64_tr_b16 v[48:49], v28 offset:0
    ds_read_b64_tr_b16 v[50:51], v28 offset:512
    s_add_u32 m0, s43, 32768
    s_mul_i32 s50, s33, 896
    buffer_load_dwordx4 v10, s[16:19], s50 offen lds
    s_add_u32 m0, s43, 36864
    s_mul_i32 s50, s33, 928
    buffer_load_dwordx4 v10, s[16:19], s50 offen lds
    s_mov_b32 s50, 57344
    buffer_load_dwordx4 v[120:123], v8, s[12:15], s50 offen offset:0
    buffer_load_dwordx4 v[124:127], v8, s[12:15], s50 offen offset:1024
    buffer_load_dwordx4 v[128:131], v8, s[12:15], s50 offen offset:2048
    buffer_load_dwordx4 v[132:135], v8, s[12:15], s50 offen offset:3072
    ds_read_b64_tr_b16 v[52:53], v28 offset:2048
    ds_read_b64_tr_b16 v[54:55], v28 offset:2560
    s_waitcnt lgkmcnt(2)
    v_mfma_f32_32x32x16_bf16 v[32:47], v[48:51], v[56:59], v[32:47]
    ds_read_b64_tr_b16 v[48:49], v28 offset:4096
    ds_read_b64_tr_b16 v[50:51], v28 offset:4608
    s_waitcnt lgkmcnt(2)
    v_mfma_f32_32x32x16_bf16 v[32:47], v[52:55], v[60:63], v[32:47]
    ds_read_b64_tr_b16 v[52:53], v28 offset:6144
    ds_read_b64_tr_b16 v[54:55], v28 offset:6656
    s_waitcnt lgkmcnt(2)
    v_mfma_f32_32x32x16_bf16 v[32:47], v[48:51], v[64:67], v[32:47]
    s_waitcnt lgkmcnt(0)
    v_mfma_f32_32x32x16_bf16 v[32:47], v[52:55], v[68:71], v[32:47]
    s_waitcnt vmcnt(18)
    s_barrier
    ds_read_b64_tr_b16 v[48:49], v28 offset:8192
    ds_read_b64_tr_b16 v[50:51], v28 offset:8704
    s_add_u32 m0, s43, 0
    s_mul_i32 s50, s33, 960
    buffer_load_dwordx4 v10, s[16:19], s50 offen lds
    s_add_u32 m0, s43, 4096
    s_mul_i32 s50, s33, 992
    buffer_load_dwordx4 v10, s[16:19], s50 offen lds
    s_mov_b32 s50, 61440
    buffer_load_dwordx4 v[56:59], v8, s[12:15], s50 offen offset:0
    buffer_load_dwordx4 v[60:63], v8, s[12:15], s50 offen offset:1024
    buffer_load_dwordx4 v[64:67], v8, s[12:15], s50 offen offset:2048
    buffer_load_dwordx4 v[68:71], v8, s[12:15], s50 offen offset:3072
    ds_read_b64_tr_b16 v[52:53], v28 offset:10240
    ds_read_b64_tr_b16 v[54:55], v28 offset:10752
    s_waitcnt lgkmcnt(2)
    v_mfma_f32_32x32x16_bf16 v[32:47], v[48:51], v[72:75], v[32:47]
    ds_read_b64_tr_b16 v[48:49], v28 offset:12288
    ds_read_b64_tr_b16 v[50:51], v28 offset:12800
    s_waitcnt lgkmcnt(2)
    v_mfma_f32_32x32x16_bf16 v[32:47], v[52:55], v[76:79], v[32:47]
    ds_read_b64_tr_b16 v[52:53], v28 offset:14336
    ds_read_b64_tr_b16 v[54:55], v28 offset:14848
    s_waitcnt lgkmcnt(2)
    v_mfma_f32_32x32x16_bf16 v[32:47], v[48:51], v[80:83], v[32:47]
    s_waitcnt lgkmcnt(0)
    v_mfma_f32_32x32x16_bf16 v[32:47], v[52:55], v[84:87], v[32:47]
    s_waitcnt vmcnt(18)
    s_barrier
    ds_read_b64_tr_b16 v[48:49], v28 offset:16384
    ds_read_b64_tr_b16 v[50:51], v28 offset:16896
    s_add_u32 m0, s43, 8192
    s_mul_i32 s50, s33, 1024
    buffer_load_dwordx4 v10, s[16:19], s50 offen lds
    s_add_u32 m0, s43, 12288
    s_mul_i32 s50, s33, 1056
    buffer_load_dwordx4 v10, s[16:19], s50 offen lds
    s_mov_b32 s50, 65536
    buffer_load_dwordx4 v[72:75], v8, s[12:15], s50 offen offset:0
    buffer_load_dwordx4 v[76:79], v8, s[12:15], s50 offen offset:1024
    buffer_load_dwordx4 v[80:83], v8, s[12:15], s50 offen offset:2048
    buffer_load_dwordx4 v[84:87], v8, s[12:15], s50 offen offset:3072
    ds_read_b64_tr_b16 v[52:53], v28 offset:18432
    ds_read_b64_tr_b16 v[54:55], v28 offset:18944
    s_waitcnt lgkmcnt(2)
    v_mfma_f32_32x32x16_bf16 v[32:47], v[48:51], v[88:91], v[32:47]
    ds_read_b64_tr_b16 v[48:49], v28 offset:20480
    ds_read_b64_tr_b16 v[50:51], v28 offset:20992
    s_waitcnt lgkmcnt(2)
    v_mfma_f32_32x32x16_bf16 v[32:47], v[52:55], v[92:95], v[32:47]
    ds_read_b64_tr_b16 v[52:53], v28 offset:22528
    ds_read_b64_tr_b16 v[54:55], v28 offset:23040
    s_waitcnt lgkmcnt(2)
    v_mfma_f32_32x32x16_bf16 v[32:47], v[48:51], v[96:99], v[32:47]
    s_waitcnt lgkmcnt(0)
    v_mfma_f32_32x32x16_bf16 v[32:47], v[52:55], v[100:103], v[32:47]
    s_waitcnt vmcnt(18)
    s_barrier
    ds_read_b64_tr_b16 v[48:49], v28 offset:24576
    ds_read_b64_tr_b16 v[50:51], v28 offset:25088
    s_add_u32 m0, s43, 16384
    s_mul_i32 s50, s33, 1088
    buffer_load_dwordx4 v10, s[16:19], s50 offen lds
    s_add_u32 m0, s43, 20480
    s_mul_i32 s50, s33, 1120
    buffer_load_dwordx4 v10, s[16:19], s50 offen lds
    s_mov_b32 s50, 69632
    buffer_load_dwordx4 v[88:91], v8, s[12:15], s50 offen offset:0
    buffer_load_dwordx4 v[92:95], v8, s[12:15], s50 offen offset:1024
    buffer_load_dwordx4 v[96:99], v8, s[12:15], s50 offen offset:2048
    buffer_load_dwordx4 v[100:103], v8, s[12:15], s50 offen offset:3072
    ds_read_b64_tr_b16 v[52:53], v28 offset:26624
    ds_read_b64_tr_b16 v[54:55], v28 offset:27136
    s_waitcnt lgkmcnt(2)
    v_mfma_f32_32x32x16_bf16 v[32:47], v[48:51], v[104:107], v[32:47]
    ds_read_b64_tr_b16 v[48:49], v28 offset:28672
    ds_read_b64_tr_b16 v[50:51], v28 offset:29184
    s_waitcnt lgkmcnt(2)
    v_mfma_f32_32x32x16_bf16 v[32:47], v[52:55], v[108:111], v[32:47]
    ds_read_b64_tr_b16 v[52:53], v28 offset:30720
    ds_read_b64_tr_b16 v[54:55], v28 offset:31232
    s_waitcnt lgkmcnt(2)
    v_mfma_f32_32x32x16_bf16 v[32:47], v[48:51], v[112:115], v[32:47]
    s_waitcnt lgkmcnt(0)
    v_mfma_f32_32x32x16_bf16 v[32:47], v[52:55], v[116:119], v[32:47]
    s_waitcnt vmcnt(18)
    s_barrier
    ds_read_b64_tr_b16 v[48:49], v28 offset:32768
    ds_read_b64_tr_b16 v[50:51], v28 offset:33280
    s_add_u32 m0, s43, 24576
    s_mul_i32 s50, s33, 1152
    buffer_load_dwordx4 v10, s[16:19], s50 offen lds
    s_add_u32 m0, s43, 28672
    s_mul_i32 s50, s33, 1184
    buffer_load_dwordx4 v10, s[16:19], s50 offen lds
    s_mov_b32 s50, 73728
    buffer_load_dwordx4 v[104:107], v8, s[12:15], s50 offen offset:0
    buffer_load_dwordx4 v[108:111], v8, s[12:15], s50 offen offset:1024
    buffer_load_dwordx4 v[112:115], v8, s[12:15], s50 offen offset:2048
    buffer_load_dwordx4 v[116:119], v8, s[12:15], s50 offen offset:3072
    ds_read_b64_tr_b16 v[52:53], v28 offset:34816
    ds_read_b64_tr_b16 v[54:55], v28 offset:35328
    s_waitcnt lgkmcnt(2)
    v_mfma_f32_32x32x16_bf16 v[32:47], v[48:51], v[120:123], v[32:47]
    ds_read_b64_tr_b16 v[48:49], v28 offset:36864
    ds_read_b64_tr_b16 v[50:51], v28 offset:37376
    s_waitcnt lgkmcnt(2)
    v_mfma_f32_32x32x16_bf16 v[32:47], v[52:55], v[124:127], v[32:47]
    ds_read_b64_tr_b16 v[52:53], v28 offset:38912
    ds_read_b64_tr_b16 v[54:55], v28 offset:39424
    s_waitcnt lgkmcnt(2)
    v_mfma_f32_32x32x16_bf16 v[32:47], v[48:51], v[128:131], v[32:47]
    s_waitcnt lgkmcnt(0)
    v_mfma_f32_32x32x16_bf16 v[32:47], v[52:55], v[132:135], v[32:47]
    s_waitcnt vmcnt(18)
    s_barrier
    ds_read_b64_tr_b16 v[48:49], v28 offset:0
    ds_read_b64_tr_b16 v[50:51], v28 offset:512
    s_add_u32 m0, s43, 32768
    s_mul_i32 s50, s33, 1216
    buffer_load_dwordx4 v10, s[16:19], s50 offen lds
    s_add_u32 m0, s43, 36864
    s_mul_i32 s50, s33, 1248
    buffer_load_dwordx4 v10, s[16:19], s50 offen lds
    s_mov_b32 s50, 77824
    buffer_load_dwordx4 v[120:123], v8, s[12:15], s50 offen offset:0
    buffer_load_dwordx4 v[124:127], v8, s[12:15], s50 offen offset:1024
    buffer_load_dwordx4 v[128:131], v8, s[12:15], s50 offen offset:2048
    buffer_load_dwordx4 v[132:135], v8, s[12:15], s50 offen offset:3072
    ds_read_b64_tr_b16 v[52:53], v28 offset:2048
    ds_read_b64_tr_b16 v[54:55], v28 offset:2560
    s_waitcnt lgkmcnt(2)
    v_mfma_f32_32x32x16_bf16 v[32:47], v[48:51], v[56:59], v[32:47]
    ds_read_b64_tr_b16 v[48:49], v28 offset:4096
    ds_read_b64_tr_b16 v[50:51], v28 offset:4608
    s_waitcnt lgkmcnt(2)
    v_mfma_f32_32x32x16_bf16 v[32:47], v[52:55], v[60:63], v[32:47]
    ds_read_b64_tr_b16 v[52:53], v28 offset:6144
    ds_read_b64_tr_b16 v[54:55], v28 offset:6656
    s_waitcnt lgkmcnt(2)
    v_mfma_f32_32x32x16_bf16 v[32:47], v[48:51], v[64:67], v[32:47]
    s_waitcnt lgkmcnt(0)
    v_mfma_f32_32x32x16_bf16 v[32:47], v[52:55], v[68:71], v[32:47]
    s_waitcnt vmcnt(18)
    s_barrier
    ds_read_b64_tr_b16 v[48:49], v28 offset:8192
    ds_read_b64_tr_b16 v[50:51], v28 offset:8704
    s_add_u32 m0, s43, 0
    s_mul_i32 s50, s33, 1280
    buffer_load_dwordx4 v10, s[16:19], s50 offen lds
    s_add_u32 m0, s43, 4096
    s_mul_i32 s50, s33, 1312
    buffer_load_dwordx4 v10, s[16:19], s50 offen lds
    s_mov_b32 s50, 81920
    buffer_load_dwordx4 v[56:59], v8, s[12:15], s50 offen offset:0
    buffer_load_dwordx4 v[60:63], v8, s[12:15], s50 offen offset:1024
    buffer_load_dwordx4 v[64:67], v8, s[12:15], s50 offen offset:2048
    buffer_load_dwordx4 v[68:71], v8, s[12:15], s50 offen offset:3072
    ds_read_b64_tr_b16 v[52:53], v28 offset:10240
    ds_read_b64_tr_b16 v[54:55], v28 offset:10752
    s_waitcnt lgkmcnt(2)
    v_mfma_f32_32x32x16_bf16 v[32:47], v[48:51], v[72:75], v[32:47]
    ds_read_b64_tr_b16 v[48:49], v28 offset:12288
    ds_read_b64_tr_b16 v[50:51], v28 offset:12800
    s_waitcnt lgkmcnt(2)
    v_mfma_f32_32x32x16_bf16 v[32:47], v[52:55], v[76:79], v[32:47]
    ds_read_b64_tr_b16 v[52:53], v28 offset:14336
    ds_read_b64_tr_b16 v[54:55], v28 offset:14848
    s_waitcnt lgkmcnt(2)
    v_mfma_f32_32x32x16_bf16 v[32:47], v[48:51], v[80:83], v[32:47]
    s_waitcnt lgkmcnt(0)
    v_mfma_f32_32x32x16_bf16 v[32:47], v[52:55], v[84:87], v[32:47]
    s_waitcnt vmcnt(18)
    s_barrier
    ds_read_b64_tr_b16 v[48:49], v28 offset:16384
    ds_read_b64_tr_b16 v[50:51], v28 offset:16896
    s_add_u32 m0, s43, 8192
    s_mul_i32 s50, s33, 1344
    buffer_load_dwordx4 v10, s[16:19], s50 offen lds
    s_add_u32 m0, s43, 12288
    s_mul_i32 s50, s33, 1376
    buffer_load_dwordx4 v10, s[16:19], s50 offen lds
    s_mov_b32 s50, 86016
    buffer_load_dwordx4 v[72:75], v8, s[12:15], s50 offen offset:0
    buffer_load_dwordx4 v[76:79], v8, s[12:15], s50 offen offset:1024
    ds_read_b64_tr_b16 v[52:53], v28 offset:18432
    ds_read_b64_tr_b16 v[54:55], v28 offset:18944
    s_waitcnt lgkmcnt(2)
    v_mfma_f32_32x32x16_bf16 v[32:47], v[48:51], v[88:91], v[32:47]
    ds_read_b64_tr_b16 v[48:49], v28 offset:20480
    ds_read_b64_tr_b16 v[50:51], v28 offset:20992
    s_waitcnt lgkmcnt(2)
    v_mfma_f32_32x32x16_bf16 v[32:47], v[52:55], v[92:95], v[32:47]
    ds_read_b64_tr_b16 v[52:53], v28 offset:22528
    ds_read_b64_tr_b16 v[54:55], v28 offset:23040
    s_waitcnt lgkmcnt(2)
    v_mfma_f32_32x32x16_bf16 v[32:47], v[48:51], v[96:99], v[32:47]
    s_waitcnt lgkmcnt(0)
    v_mfma_f32_32x32x16_bf16 v[32:47], v[52:55], v[100:103], v[32:47]
    s_waitcnt vmcnt(16)
    s_barrier
    ds_read_b64_tr_b16 v[48:49], v28 offset:24576
    ds_read_b64_tr_b16 v[50:51], v28 offset:25088
    ds_read_b64_tr_b16 v[52:53], v28 offset:26624
    ds_read_b64_tr_b16 v[54:55], v28 offset:27136
    s_waitcnt lgkmcnt(2)
    v_mfma_f32_32x32x16_bf16 v[32:47], v[48:51], v[104:107], v[32:47]
    ds_read_b64_tr_b16 v[48:49], v28 offset:28672
    ds_read_b64_tr_b16 v[50:51], v28 offset:29184
    s_waitcnt lgkmcnt(2)
    v_mfma_f32_32x32x16_bf16 v[32:47], v[52:55], v[108:111], v[32:47]
    ds_read_b64_tr_b16 v[52:53], v28 offset:30720
    ds_read_b64_tr_b16 v[54:55], v28 offset:31232
    s_waitcnt lgkmcnt(2)
    v_mfma_f32_32x32x16_bf16 v[32:47], v[48:51], v[112:115], v[32:47]
    s_waitcnt lgkmcnt(0)
    v_mfma_f32_32x32x16_bf16 v[32:47], v[52:55], v[116:119], v[32:47]
    s_waitcnt vmcnt(10)
    s_barrier
    ds_read_b64_tr_b16 v[48:49], v28 offset:32768
    ds_read_b64_tr_b16 v[50:51], v28 offset:33280
    ds_read_b64_tr_b16 v[52:53], v28 offset:34816
    ds_read_b64_tr_b16 v[54:55], v28 offset:35328
    s_waitcnt lgkmcnt(2)
    v_mfma_f32_32x32x16_bf16 v[32:47], v[48:51], v[120:123], v[32:47]
    ds_read_b64_tr_b16 v[48:49], v28 offset:36864
    ds_read_b64_tr_b16 v[50:51], v28 offset:37376
    s_waitcnt lgkmcnt(2)
    v_mfma_f32_32x32x16_bf16 v[32:47], v[52:55], v[124:127], v[32:47]
    ds_read_b64_tr_b16 v[52:53], v28 offset:38912
    ds_read_b64_tr_b16 v[54:55], v28 offset:39424
    s_waitcnt lgkmcnt(2)
    v_mfma_f32_32x32x16_bf16 v[32:47], v[48:51], v[128:131], v[32:47]
    s_waitcnt lgkmcnt(0)
    v_mfma_f32_32x32x16_bf16 v[32:47], v[52:55], v[132:135], v[32:47]
    s_waitcnt vmcnt(4)
    s_barrier
    ds_read_b64_tr_b16 v[48:49], v28 offset:0
    ds_read_b64_tr_b16 v[50:51], v28 offset:512
    ds_read_b64_tr_b16 v[52:53], v28 offset:2048
    ds_read_b64_tr_b16 v[54:55], v28 offset:2560
    s_waitcnt lgkmcnt(2)
    v_mfma_f32_32x32x16_bf16 v[32:47], v[48:51], v[56:59], v[32:47]
    ds_read_b64_tr_b16 v[48:49], v28 offset:4096
    ds_read_b64_tr_b16 v[50:51], v28 offset:4608
    s_waitcnt lgkmcnt(2)
    v_mfma_f32_32x32x16_bf16 v[32:47], v[52:55], v[60:63], v[32:47]
    ds_read_b64_tr_b16 v[52:53], v28 offset:6144
    ds_read_b64_tr_b16 v[54:55], v28 offset:6656
    s_waitcnt lgkmcnt(2)
    v_mfma_f32_32x32x16_bf16 v[32:47], v[48:51], v[64:67], v[32:47]
    s_waitcnt lgkmcnt(0)
    v_mfma_f32_32x32x16_bf16 v[32:47], v[52:55], v[68:71], v[32:47]
    s_waitcnt vmcnt(0)
    s_barrier
    ds_read_b64_tr_b16 v[48:49], v28 offset:8192
    ds_read_b64_tr_b16 v[50:51], v28 offset:8704
    ds_read_b64_tr_b16 v[52:53], v28 offset:10240
    ds_read_b64_tr_b16 v[54:55], v28 offset:10752
    s_waitcnt lgkmcnt(2)
    v_mfma_f32_32x32x16_bf16 v[32:47], v[48:51], v[72:75], v[32:47]
    s_waitcnt lgkmcnt(0)
    v_mfma_f32_32x32x16_bf16 v[32:47], v[52:55], v[76:79], v[32:47]
    s_nop 15
    s_nop 3
    s_lshl_b32 s54, s53, 6
    s_add_u32 s54, s54, s46
    v_add_u32 v5, s54, v3
    s_lshl_b32 s54, s52, 6
    s_lshl_b32 s55, s45, 5
    s_add_u32 s54, s54, s55
    v_lshlrev_b32 v6, 2, v4
    v_add_u32 v6, s54, v6
    v_lshlrev_b32 v7, 2, v6
    v_lshlrev_b32 v5, 10, v5
    v_lshl_add_u32 v5, v6, 1, v5
    s_mov_b32 s54, 10240
    buffer_load_dwordx4 v[48:51], v7, s[60:63], s54 offen offset:0
    buffer_load_dwordx2 v[64:65], v5, s[56:59], 0 offen offset:0
    buffer_load_dwordx4 v[52:55], v7, s[60:63], s54 offen offset:32
    buffer_load_dwordx2 v[66:67], v5, s[56:59], 0 offen offset:16
    buffer_load_dwordx4 v[56:59], v7, s[60:63], s54 offen offset:64
    buffer_load_dwordx2 v[68:69], v5, s[56:59], 0 offen offset:32
    buffer_load_dwordx4 v[60:63], v7, s[60:63], s54 offen offset:96
    buffer_load_dwordx2 v[70:71], v5, s[56:59], 0 offen offset:48
    s_waitcnt vmcnt(0)
    v_cvt_pk_bf16_f32 v72, v32, v33
    v_lshlrev_b32 v32, 16, v72
    v_and_b32 v33, 0xffff0000, v72
    v_mul_f32 v32, v32, v48
    v_mul_f32 v33, v33, v49
    v_cvt_pk_bf16_f32 v72, v32, v33
    v_lshlrev_b32 v32, 16, v72
    v_and_b32 v33, 0xffff0000, v72
    v_lshlrev_b32 v73, 16, v64
    v_and_b32 v74, 0xffff0000, v64
    v_add_f32 v32, v32, v73
    v_add_f32 v33, v33, v74
    v_cvt_pk_bf16_f32 v64, v32, v33
    v_cvt_pk_bf16_f32 v72, v34, v35
    v_lshlrev_b32 v34, 16, v72
    v_and_b32 v35, 0xffff0000, v72
    v_mul_f32 v34, v34, v50
    v_mul_f32 v35, v35, v51
    v_cvt_pk_bf16_f32 v72, v34, v35
    v_lshlrev_b32 v34, 16, v72
    v_and_b32 v35, 0xffff0000, v72
    v_lshlrev_b32 v73, 16, v65
    v_and_b32 v74, 0xffff0000, v65
    v_add_f32 v34, v34, v73
    v_add_f32 v35, v35, v74
    v_cvt_pk_bf16_f32 v65, v34, v35
    buffer_store_dwordx2 v[64:65], v5, s[24:27], 0 offen offset:0
    v_cvt_pk_bf16_f32 v72, v36, v37
    v_lshlrev_b32 v36, 16, v72
    v_and_b32 v37, 0xffff0000, v72
    v_mul_f32 v36, v36, v52
    v_mul_f32 v37, v37, v53
    v_cvt_pk_bf16_f32 v72, v36, v37
    v_lshlrev_b32 v36, 16, v72
    v_and_b32 v37, 0xffff0000, v72
    v_lshlrev_b32 v73, 16, v66
    v_and_b32 v74, 0xffff0000, v66
    v_add_f32 v36, v36, v73
    v_add_f32 v37, v37, v74
    v_cvt_pk_bf16_f32 v66, v36, v37
    v_cvt_pk_bf16_f32 v72, v38, v39
    v_lshlrev_b32 v38, 16, v72
    v_and_b32 v39, 0xffff0000, v72
    v_mul_f32 v38, v38, v54
    v_mul_f32 v39, v39, v55
    v_cvt_pk_bf16_f32 v72, v38, v39
    v_lshlrev_b32 v38, 16, v72
    v_and_b32 v39, 0xffff0000, v72
    v_lshlrev_b32 v73, 16, v67
    v_and_b32 v74, 0xffff0000, v67
    v_add_f32 v38, v38, v73
    v_add_f32 v39, v39, v74
    v_cvt_pk_bf16_f32 v67, v38, v39
    buffer_store_dwordx2 v[66:67], v5, s[24:27], 0 offen offset:16
    v_cvt_pk_bf16_f32 v72, v40, v41
    v_lshlrev_b32 v40, 16, v72
    v_and_b32 v41, 0xffff0000, v72
    v_mul_f32 v40, v40, v56
    v_mul_f32 v41, v41, v57
    v_cvt_pk_bf16_f32 v72, v40, v41
    v_lshlrev_b32 v40, 16, v72
    v_and_b32 v41, 0xffff0000, v72
    v_lshlrev_b32 v73, 16, v68
    v_and_b32 v74, 0xffff0000, v68
    v_add_f32 v40, v40, v73
    v_add_f32 v41, v41, v74
    v_cvt_pk_bf16_f32 v68, v40, v41
    v_cvt_pk_bf16_f32 v72, v42, v43
    v_lshlrev_b32 v42, 16, v72
    v_and_b32 v43, 0xffff0000, v72
    v_mul_f32 v42, v42, v58
    v_mul_f32 v43, v43, v59
    v_cvt_pk_bf16_f32 v72, v42, v43
    v_lshlrev_b32 v42, 16, v72
    v_and_b32 v43, 0xffff0000, v72
    v_lshlrev_b32 v73, 16, v69
    v_and_b32 v74, 0xffff0000, v69
    v_add_f32 v42, v42, v73
    v_add_f32 v43, v43, v74
    v_cvt_pk_bf16_f32 v69, v42, v43
    buffer_store_dwordx2 v[68:69], v5, s[24:27], 0 offen offset:32
    v_cvt_pk_bf16_f32 v72, v44, v45
    v_lshlrev_b32 v44, 16, v72
    v_and_b32 v45, 0xffff0000, v72
    v_mul_f32 v44, v44, v60
    v_mul_f32 v45, v45, v61
    v_cvt_pk_bf16_f32 v72, v44, v45
    v_lshlrev_b32 v44, 16, v72
    v_and_b32 v45, 0xffff0000, v72
    v_lshlrev_b32 v73, 16, v70
    v_and_b32 v74, 0xffff0000, v70
    v_add_f32 v44, v44, v73
    v_add_f32 v45, v45, v74
    v_cvt_pk_bf16_f32 v70, v44, v45
    v_cvt_pk_bf16_f32 v72, v46, v47
    v_lshlrev_b32 v46, 16, v72
    v_and_b32 v47, 0xffff0000, v72
    v_mul_f32 v46, v46, v62
    v_mul_f32 v47, v47, v63
    v_cvt_pk_bf16_f32 v72, v46, v47
    v_lshlrev_b32 v46, 16, v72
    v_and_b32 v47, 0xffff0000, v72
    v_lshlrev_b32 v73, 16, v71
    v_and_b32 v74, 0xffff0000, v71
    v_add_f32 v46, v46, v73
    v_add_f32 v47, v47, v74
    v_cvt_pk_bf16_f32 v71, v46, v47
    buffer_store_dwordx2 v[70:71], v5, s[24:27], 0 offen offset:48
down_kernel_done:
    s_endpgm
.section .rodata,"a"
.p2align 6
.amdhsa_kernel down_kernel
  .amdhsa_next_free_vgpr 136
  .amdhsa_next_free_sgpr 102
  .amdhsa_accum_offset 136
  .amdhsa_group_segment_fixed_size 0
  .amdhsa_kernarg_size 112
  .amdhsa_user_sgpr_count 2
  .amdhsa_user_sgpr_kernarg_segment_ptr 1
  .amdhsa_system_sgpr_workgroup_id_x 1
  .amdhsa_float_denorm_mode_32 3
.end_amdhsa_kernel
.text
```
